```python
import torch

def _softmax(x, axis=-1):
    return torch.softmax(x, dim=axis)
def _gelu(x):
    return torch.nn.functional.gelu(x, approximate="tanh")
def _silu(x):
    return torch.nn.functional.silu(x)
def _sigmoid(x):
    return torch.sigmoid(x)
def _layernorm(x, axis=-1, eps=1e-5):
    m = x.mean(dim=axis, keepdim=True)
    v = x.var(dim=axis, keepdim=True, unbiased=False)
    return (x - m) / torch.sqrt(v + eps)
def _scatter_add(tgt, idx, src, axis=0):
    return tgt.clone().index_add_(axis, idx, src)
def _segment_sum(src, seg, n):
    out = torch.zeros((n,) + src.shape[1:], dtype=src.dtype)
    return out.index_add_(0, seg, src)
def _pad(x, pw):
    flat = tuple(v for pair in reversed(pw) for v in pair)
    return torch.nn.functional.pad(x, flat)

kernel_name = 'parallel_sum__sliding_block__glu_gated_bilinear__prompt'

def setup_inputs():

    _w = (lambda a: (lambda t: t.to(torch.bfloat16) if t.is_floating_point() else t)(torch.as_tensor(a)))
    def _A_setup():
        B, S, D = 1, 2048, 640
        return {
            "x": _w((lambda *s: torch.randn(*s, dtype=torch.bfloat16) * 0.05)(B, S, D)),
            "wqkv": _w((lambda *s: torch.randn(*s, dtype=torch.bfloat16) * 0.05)(D, 3 * D)),
            "wo": _w((lambda *s: torch.randn(*s, dtype=torch.bfloat16) * 0.05)(D, D)),
        }
    _A_in = _A_setup()

    def _B_setup():
        B, S, D, F = 1, 2048, 640, 1728
        return {
            "x": _w((lambda *s: torch.randn(*s, dtype=torch.bfloat16) * 0.05)(B, S, D)),
            "w_gate": _w((lambda *s: torch.randn(*s, dtype=torch.bfloat16) * 0.8)(D, F) * (D ** -0.5)),
            "w_up": _w((lambda *s: torch.randn(*s, dtype=torch.bfloat16) * 0.8)(D, F) * (D ** -0.5)),
            "w_down": _w((lambda *s: torch.randn(*s, dtype=torch.bfloat16) * 0.8)(F, D) * (F ** -0.5)),
        }
    _B_in = _B_setup()

    return {
        "A_x": _A_in["x"],
        "A_wqkv": _A_in["wqkv"],
        "A_wo": _A_in["wo"],
        "B_x": _B_in["x"],
        "B_w_gate": _B_in["w_gate"],
        "B_w_up": _B_in["w_up"],
        "B_w_down": _B_in["w_down"],
    }

def reference(A_x, A_wqkv, A_wo, B_x, B_w_gate, B_w_up, B_w_down):
    def _A_ref(x, wqkv, wo):
        B, S, D = x.shape
        H = 32; Dh = D // H; W = 256
        qkv = (lambda x, *d: x.permute(*d))((x @ wqkv).reshape(B, S, 3, H, Dh), 2, 0, 3, 1, 4)
        q, k, v = qkv[0], qkv[1], qkv[2]
        scores = torch.einsum("bhqd,bhkd->bhqk", q, k) * (Dh ** -0.5)
        idx = torch.arange(S)
        mask = (idx[:, None] - idx[None, :] >= 0) & (idx[:, None] - idx[None, :] < W)
        scores = torch.where(mask[None, None], scores, -1e9)
        p = _softmax(scores, axis=-1)
        o = torch.einsum("bhqk,bhkd->bhqd", p, v)
        return (lambda x, *d: x.permute(*d))(o, 0, 2, 1, 3).reshape(B, S, D) @ wo

    def _B_ref(x, w_gate, w_up, w_down):
        g = torch.einsum("bsd,df->bsf", x, w_gate)
        u = torch.einsum("bsd,df->bsf", x, w_up)
        h = g * u
        return torch.einsum("bsf,fd->bsd", h, w_down)

    x = A_x
    xn = _layernorm(x, axis=-1)
    return x + _A_ref(xn, A_wqkv, A_wo) + _B_ref(xn, B_w_gate, B_w_up, B_w_down)
```

```asm
; @launch grid=(256,1,1) block=(256,1,1) lds=163840
.amdgcn_target "amdgcn-amd-amdhsa--gfx950"
.text
.globl parallel_sum__sliding_block__glu_gated_bilinear__prompt_kernel
.p2align 8
.type parallel_sum__sliding_block__glu_gated_bilinear__prompt_kernel,@function
parallel_sum__sliding_block__glu_gated_bilinear__prompt_kernel:
  s_cmp_ge_u32 s2, 256
  s_cbranch_scc1 parallel_sum__sliding_block__glu_gated_bilinear__prompt_kernel_end
  s_load_dwordx16 s[16:31], s[0:1], 0
  s_load_dwordx4 s[32:35], s[0:1], 64
  v_cmp_gt_u32 vcc, 16, v0
  s_and_saveexec_b64 s[96:97], vcc
  s_cbranch_execz ct_1
  s_getpc_b64 s[98:99]
L_pcref:
  s_sub_u32 s98, s98, L_pcref-parallel_sum__sliding_block__glu_gated_bilinear__prompt_kernel
  s_subb_u32 s99, s99, 0
  s_lshr_b32 s3, s2, 3
  s_lshl_b32 s3, s3, 4
  v_add_u32 v254, s3, v0
  v_lshlrev_b32 v254, 7, v254
  v_min_u32 v254, L_codeend-parallel_sum__sliding_block__glu_gated_bilinear__prompt_kernel-4, v254
  global_load_dword v255, v254, s[98:99]
ct_1:
  s_mov_b64 exec, s[96:97]
  s_and_b32 s4, s2, 7
  s_lshr_b32 s5, s2, 3
  v_lshrrev_b32 v4, 6, v0
  v_and_b32 v1, 63, v0
  v_readfirstlane_b32 s6, v4
  v_and_b32 v2, 15, v1
  v_lshrrev_b32 v3, 4, v1
  s_waitcnt lgkmcnt(0)
  s_mov_b32 s36, s16
  s_mov_b32 s37, s17
  s_mov_b32 s38, 2621440
  s_mov_b32 s39, 0x00020000
  s_mov_b32 s40, s18
  s_mov_b32 s41, s19
  s_mov_b32 s42, 2457600
  s_mov_b32 s43, 0x00020000
  s_mov_b32 s44, s24
  s_mov_b32 s45, s25
  s_mov_b32 s46, 2211840
  s_mov_b32 s47, 0x00020000
  s_mov_b32 s48, s26
  s_mov_b32 s49, s27
  s_mov_b32 s50, 2211840
  s_mov_b32 s51, 0x00020000
  s_mov_b32 s52, s34
  s_mov_b32 s53, s35
  s_mov_b32 s54, 23068672
  s_mov_b32 s55, 0x00020000
  s_mov_b32 s56, s28
  s_mov_b32 s57, s29
  s_mov_b32 s58, 2211840
  s_mov_b32 s59, 0x00020000
  s_mov_b32 s60, s20
  s_mov_b32 s61, s21
  s_mov_b32 s62, 819200
  s_mov_b32 s63, 0x00020000
  s_mov_b32 s64, s30
  s_mov_b32 s65, s31
  s_mov_b32 s66, 2621440
  s_mov_b32 s67, 0x00020000
  s_and_b32 s11, s4, 1
  s_lshl_b32 s11, s11, 3
  s_and_b32 s12, s5, 7
  s_add_u32 s9, s11, s12
  s_lshr_b32 s11, s4, 1
  s_lshl_b32 s11, s11, 2
  s_lshr_b32 s13, s5, 3
  s_add_u32 s10, s11, s13
  s_lshr_b32 s7, s6, 1
  s_and_b32 s8, s6, 1
  s_cmp_lt_u32 s6, 2
  s_cbranch_scc1 notouch_2
  s_mov_b32 m0, 139264
  s_cmp_eq_u32 s6, 3
  s_cbranch_scc1 tw3_3
  v_and_b32 v33, 31, v1
  s_and_b32 s11, s4, 1
  s_lshl_b32 s11, s11, 10
  s_lshl_b32 s12, s5, 5
  s_add_u32 s11, s11, s12
  v_add_u32 v33, s11, v33
  v_mul_u32_u24 v33, 1280, v33
  v_lshrrev_b32 v32, 5, v1
  v_lshl_add_u32 v32, v32, 7, v33
  s_movk_i32 s91, 0
  buffer_load_dword v32, s[36:39], s91 offen lds
  s_movk_i32 s91, 256
  buffer_load_dword v32, s[36:39], s91 offen lds
  s_movk_i32 s91, 512
  buffer_load_dword v32, s[36:39], s91 offen lds
  s_movk_i32 s91, 768
  buffer_load_dword v32, s[36:39], s91 offen lds
  s_movk_i32 s91, 1024
  buffer_load_dword v32, s[36:39], s91 offen lds
  s_branch tjoin_4
tw3_3:
  v_and_b32 v32, 7, v1
  v_bfe_u32 v34, v1, 4, 2
  v_lshlrev_b32 v34, 6, v34
  v_bfe_u32 v33, v1, 3, 1
  v_add_u32 v34, v34, v33
  s_lshl_b32 s11, s5, 1
  v_add_u32 v34, s11, v34
  v_mul_u32_u24 v33, 3840, v34
  v_lshl_add_u32 v33, v32, 7, v33
  s_lshr_b32 s11, s4, 1
  s_mul_i32 s12, s11, 1024
  v_add_u32 v32, s12, v33
  s_mov_b32 s91, 0
  buffer_load_dword v32, s[40:43], s91 offen lds
  s_mov_b32 s91, 983040
  buffer_load_dword v32, s[40:43], s91 offen lds
  s_mov_b32 s91, 1966080
  buffer_load_dword v32, s[40:43], s91 offen lds
tjoin_4:
notouch_2:
  v_lshrrev_b32 v32, 3, v1
  v_lshrrev_b32 v33, 1, v32
  v_lshlrev_b32 v33, 5, v33
  v_and_b32 v32, 1, v32
  v_add_u32 v32, v32, v33
  s_lshl_b32 s11, s6, 3
  v_add_u32 v32, s11, v32
  v_mul_u32_u24 v32, 1280, v32
  v_and_b32 v33, 7, v1
  v_lshl_add_u32 v4, v33, 4, v32
  v_add_u32 v5, 1504, v4
  v_add_u32 v6, 1504, v5
  v_add_u32 v7, 1504, v6
  s_lshl_b32 s11, s7, 2
  s_lshl_b32 s12, s8, 3
  s_add_u32 s11, s11, s12
  v_lshlrev_b32 v32, 4, v3
  v_add_u32 v32, s11, v32
  v_mul_u32_u24 v33, 3840, v32
  v_lshl_add_u32 v8, v2, 4, v33
  v_add_u32 v9, 2784, v8
  v_add_u32 v10, 2784, v9
  v_add_u32 v11, 2784, v10
  v_mul_u32_u24 v33, 3456, v32
  v_lshl_add_u32 v12, v2, 4, v33
  v_add_u32 v13, 2400, v12
  v_add_u32 v14, 2400, v13
  v_add_u32 v15, 2400, v14
  s_mul_i32 s82, s9, 163840
  s_lshl_b32 s83, s10, 8
  s_mul_i32 s84, s10, 224
  s_mul_i32 s85, s6, 4224
  s_movk_i32 s12, 1056
  v_mul_lo_u32 v32, v2, s12
  v_lshl_add_u32 v32, v3, 4, v32
  s_lshl_b32 s11, s7, 9
  s_lshl_b32 s13, s8, 8
  s_add_u32 s14, s11, s13
  v_add_u32 v16, s14, v32
  s_sub_u32 s14, s11, s13
  s_add_u32 s14, s14, 256
  v_add_u32 v17, s14, v32
  v_lshrrev_b32 v32, 2, v2
  v_and_b32 v33, 1, v3
  v_lshl_add_u32 v32, v33, 2, v32
  v_mul_lo_u32 v32, v32, s12
  v_lshrrev_b32 v33, 1, v3
  v_lshl_add_u32 v32, v33, 8, v32
  v_and_b32 v33, 3, v2
  v_lshl_add_u32 v34, v33, 3, v32
  s_lshl_b32 s11, s8, 7
  s_add_u32 s11, s11, 16896
  s_lshl_b32 s13, s7, 6
  s_add_u32 s14, s11, s13
  v_add_u32 v20, s14, v34
  s_sub_u32 s14, s11, s13
  s_add_u32 s14, s14, 64
  v_add_u32 v21, s14, v34
  v_mov_b32 v36, 0x3f803f80
  v_mov_b32 v37, 0x3f803f80
  v_mov_b32 v38, 0x3f803f80
  v_mov_b32 v39, 0x3f803f80
  v_and_b32 v32, 3, v2
  v_cmp_eq_u32 s[70:71], 1, v32
  v_cmp_eq_u32 s[72:73], 2, v32
  v_cmp_eq_u32 s[74:75], 3, v32
  v_lshrrev_b32 v33, 2, v2
  v_cmp_eq_u32 s[76:77], v33, v3
  v_cmp_eq_u32 s[78:79], 0, v2
  s_waitcnt vmcnt(2)
  s_barrier
  s_add_u32 s80, s82, 0
  s_add_u32 m0, s85, 0
  s_add_u32 s81, s83, 0
  buffer_load_dwordx4 v4, s[36:39], s80 offen offset:0 lds
  buffer_load_dwordx4 v5, s[36:39], s80 offen offset:1056 lds
  buffer_load_dwordx4 v6, s[36:39], s80 offen offset:2112 lds
  buffer_load_dwordx4 v7, s[36:39], s80 offen offset:3168 lds
  s_add_u32 m0, s85, 16896
  s_nop 0
  buffer_load_dwordx4 v8, s[40:43], s81 offen offset:0 lds
  buffer_load_dwordx4 v9, s[40:43], s81 offen offset:1056 lds
  buffer_load_dwordx4 v10, s[40:43], s81 offen offset:2112 lds
  buffer_load_dwordx4 v11, s[40:43], s81 offen offset:3168 lds
  s_add_u32 s80, s82, 128
  s_add_u32 m0, s85, 33792
  s_add_u32 s81, s83, 245760
  buffer_load_dwordx4 v4, s[36:39], s80 offen offset:0 lds
  buffer_load_dwordx4 v5, s[36:39], s80 offen offset:1056 lds
  buffer_load_dwordx4 v6, s[36:39], s80 offen offset:2112 lds
  buffer_load_dwordx4 v7, s[36:39], s80 offen offset:3168 lds
  s_add_u32 m0, s85, 50688
  s_nop 0
  buffer_load_dwordx4 v8, s[40:43], s81 offen offset:0 lds
  buffer_load_dwordx4 v9, s[40:43], s81 offen offset:1056 lds
  buffer_load_dwordx4 v10, s[40:43], s81 offen offset:2112 lds
  buffer_load_dwordx4 v11, s[40:43], s81 offen offset:3168 lds
  s_waitcnt vmcnt(8)
  s_waitcnt lgkmcnt(0)
  s_barrier
  v_add_u32 v18, 0, v16
  v_add_u32 v19, 0, v17
  v_add_u32 v22, 0, v20
  v_add_u32 v23, 0, v21
  ds_read_b128 a[0:3], v18 offset:0
  ds_read_b128 a[4:7], v18 offset:128
  ds_read_b128 a[8:11], v19 offset:0
  ds_read_b128 a[12:15], v19 offset:128
  ds_read_b64_tr_b16 v[40:41], v22 offset:0
  ds_read_b64_tr_b16 v[42:43], v22 offset:8448
  s_waitcnt lgkmcnt(2)
  s_waitcnt lgkmcnt(0)
  v_mfma_f32_16x16x32_bf16 v[64:67], v[40:43], a[0:3], 0
  ds_read_b64_tr_b16 v[44:45], v22 offset:32
  ds_read_b64_tr_b16 v[46:47], v22 offset:8480
  ds_read_b64_tr_b16 v[48:49], v23 offset:0
  ds_read_b64_tr_b16 v[50:51], v23 offset:8448
  ds_read_b64_tr_b16 v[52:53], v23 offset:32
  ds_read_b64_tr_b16 v[54:55], v23 offset:8480
  ds_read_b128 a[16:19], v18 offset:64
  ds_read_b128 a[20:23], v18 offset:192
  ds_read_b128 a[24:27], v19 offset:64
  ds_read_b128 a[28:31], v19 offset:192
  ds_read_b64_tr_b16 v[56:57], v22 offset:512
  ds_read_b64_tr_b16 v[58:59], v22 offset:8960
  v_mfma_f32_16x16x32_bf16 v[68:71], v[40:43], a[4:7], 0
  s_add_u32 s80, s82, 256
  s_add_u32 m0, s85, 67584
  v_mfma_f32_16x16x32_bf16 v[72:75], v[40:43], a[8:11], 0
  s_add_u32 s81, s83, 491520
  buffer_load_dwordx4 v4, s[36:39], s80 offen offset:0 lds
  v_mfma_f32_16x16x32_bf16 v[76:79], v[40:43], a[12:15], 0
  v_mfma_f32_16x16x32_bf16 v[144:147], v[40:43], v[36:39], 0
  buffer_load_dwordx4 v5, s[36:39], s80 offen offset:1056 lds
  s_waitcnt lgkmcnt(10)
  v_mfma_f32_16x16x32_bf16 v[80:83], v[44:47], a[0:3], 0
  ds_read_b64_tr_b16 v[60:61], v22 offset:544
  ds_read_b64_tr_b16 v[62:63], v22 offset:8992
  v_mfma_f32_16x16x32_bf16 v[84:87], v[44:47], a[4:7], 0
  buffer_load_dwordx4 v6, s[36:39], s80 offen offset:2112 lds
  v_mfma_f32_16x16x32_bf16 v[88:91], v[44:47], a[8:11], 0
  buffer_load_dwordx4 v7, s[36:39], s80 offen offset:3168 lds
  v_mfma_f32_16x16x32_bf16 v[92:95], v[44:47], a[12:15], 0
  v_mfma_f32_16x16x32_bf16 v[148:151], v[44:47], v[36:39], 0
  s_add_u32 m0, s85, 84480
  s_nop 0
  s_waitcnt lgkmcnt(10)
  v_mfma_f32_16x16x32_bf16 v[96:99], v[48:51], a[0:3], 0
  ds_read_b64_tr_b16 v[40:41], v23 offset:512
  ds_read_b64_tr_b16 v[42:43], v23 offset:8960
  v_mfma_f32_16x16x32_bf16 v[100:103], v[48:51], a[4:7], 0
  buffer_load_dwordx4 v8, s[40:43], s81 offen offset:0 lds
  v_mfma_f32_16x16x32_bf16 v[104:107], v[48:51], a[8:11], 0
  buffer_load_dwordx4 v9, s[40:43], s81 offen offset:1056 lds
  v_mfma_f32_16x16x32_bf16 v[108:111], v[48:51], a[12:15], 0
  v_mfma_f32_16x16x32_bf16 v[128:131], v[36:39], a[0:3], 0
  buffer_load_dwordx4 v10, s[40:43], s81 offen offset:2112 lds
  v_mfma_f32_16x16x32_bf16 v[132:135], a[0:3], a[0:3], 0
  buffer_load_dwordx4 v11, s[40:43], s81 offen offset:3168 lds
  s_waitcnt lgkmcnt(10)
  v_mfma_f32_16x16x32_bf16 v[112:115], v[52:55], a[0:3], 0
  ds_read_b64_tr_b16 v[44:45], v23 offset:544
  ds_read_b64_tr_b16 v[46:47], v23 offset:8992
  v_mfma_f32_16x16x32_bf16 v[116:119], v[52:55], a[4:7], 0
  s_add_u32 s80, s82, 384
  s_add_u32 m0, s85, 101376
  v_mfma_f32_16x16x32_bf16 v[120:123], v[52:55], a[8:11], 0
  s_add_u32 s81, s83, 737280
  buffer_load_dwordx4 v4, s[36:39], s80 offen offset:0 lds
  v_mfma_f32_16x16x32_bf16 v[124:127], v[52:55], a[12:15], 0
  v_mfma_f32_16x16x32_bf16 v[136:139], v[36:39], a[4:7], 0
  buffer_load_dwordx4 v5, s[36:39], s80 offen offset:1056 lds
  v_mfma_f32_16x16x32_bf16 v[140:143], a[4:7], a[4:7], 0
  buffer_load_dwordx4 v6, s[36:39], s80 offen offset:2112 lds
  s_waitcnt lgkmcnt(8)
  s_waitcnt lgkmcnt(6)
  v_mfma_f32_16x16x32_bf16 v[64:67], v[56:59], a[16:19], v[64:67]
  v_mfma_f32_16x16x32_bf16 v[68:71], v[56:59], a[20:23], v[68:71]
  buffer_load_dwordx4 v7, s[36:39], s80 offen offset:3168 lds
  v_mfma_f32_16x16x32_bf16 v[72:75], v[56:59], a[24:27], v[72:75]
  s_add_u32 m0, s85, 118272
  s_nop 0
  v_mfma_f32_16x16x32_bf16 v[76:79], v[56:59], a[28:31], v[76:79]
  s_waitcnt vmcnt(12)
  s_waitcnt lgkmcnt(0)
  s_barrier
  v_add_u32 v18, 33792, v16
  v_add_u32 v19, 33792, v17
  v_add_u32 v22, 33792, v20
  v_add_u32 v23, 33792, v21
  ds_read_b128 a[32:35], v18 offset:0
  ds_read_b128 a[36:39], v18 offset:128
  ds_read_b128 a[40:43], v19 offset:0
  ds_read_b128 a[44:47], v19 offset:128
  ds_read_b64_tr_b16 v[48:49], v22 offset:0
  ds_read_b64_tr_b16 v[50:51], v22 offset:8448
  v_mfma_f32_16x16x32_bf16 v[144:147], v[56:59], v[36:39], v[144:147]
  buffer_load_dwordx4 v8, s[40:43], s81 offen offset:0 lds
  v_mfma_f32_16x16x32_bf16 v[80:83], v[60:63], a[16:19], v[80:83]
  ds_read_b64_tr_b16 v[52:53], v22 offset:32
  ds_read_b64_tr_b16 v[54:55], v22 offset:8480
  v_mfma_f32_16x16x32_bf16 v[84:87], v[60:63], a[20:23], v[84:87]
  buffer_load_dwordx4 v9, s[40:43], s81 offen offset:1056 lds
  v_mfma_f32_16x16x32_bf16 v[88:91], v[60:63], a[24:27], v[88:91]
  buffer_load_dwordx4 v10, s[40:43], s81 offen offset:2112 lds
  v_mfma_f32_16x16x32_bf16 v[92:95], v[60:63], a[28:31], v[92:95]
  v_mfma_f32_16x16x32_bf16 v[148:151], v[60:63], v[36:39], v[148:151]
  buffer_load_dwordx4 v11, s[40:43], s81 offen offset:3168 lds
  v_mfma_f32_16x16x32_bf16 v[96:99], v[40:43], a[16:19], v[96:99]
  ds_read_b64_tr_b16 v[56:57], v23 offset:0
  ds_read_b64_tr_b16 v[58:59], v23 offset:8448
  v_mfma_f32_16x16x32_bf16 v[100:103], v[40:43], a[20:23], v[100:103]
  s_add_u32 s80, s82, 512
  s_add_u32 m0, s85, 0
  v_mfma_f32_16x16x32_bf16 v[104:107], v[40:43], a[24:27], v[104:107]
  s_add_u32 s81, s83, 983040
  buffer_load_dwordx4 v4, s[36:39], s80 offen offset:0 lds
  v_mfma_f32_16x16x32_bf16 v[108:111], v[40:43], a[28:31], v[108:111]
  v_mfma_f32_16x16x32_bf16 v[128:131], v[36:39], a[16:19], v[128:131]
  buffer_load_dwordx4 v5, s[36:39], s80 offen offset:1056 lds
  v_mfma_f32_16x16x32_bf16 v[132:135], a[16:19], a[16:19], v[132:135]
  buffer_load_dwordx4 v6, s[36:39], s80 offen offset:2112 lds
  v_mfma_f32_16x16x32_bf16 v[112:115], v[44:47], a[16:19], v[112:115]
  ds_read_b64_tr_b16 v[60:61], v23 offset:32
  ds_read_b64_tr_b16 v[62:63], v23 offset:8480
  v_mfma_f32_16x16x32_bf16 v[116:119], v[44:47], a[20:23], v[116:119]
  buffer_load_dwordx4 v7, s[36:39], s80 offen offset:3168 lds
  v_mfma_f32_16x16x32_bf16 v[120:123], v[44:47], a[24:27], v[120:123]
  s_add_u32 m0, s85, 16896
  s_nop 0
  v_mfma_f32_16x16x32_bf16 v[124:127], v[44:47], a[28:31], v[124:127]
  v_mfma_f32_16x16x32_bf16 v[136:139], v[36:39], a[20:23], v[136:139]
  buffer_load_dwordx4 v8, s[40:43], s81 offen offset:0 lds
  v_mfma_f32_16x16x32_bf16 v[140:143], a[20:23], a[20:23], v[140:143]
  buffer_load_dwordx4 v9, s[40:43], s81 offen offset:1056 lds
  s_waitcnt lgkmcnt(8)
  s_waitcnt lgkmcnt(6)
  v_mfma_f32_16x16x32_bf16 v[64:67], v[48:51], a[32:35], v[64:67]
  ds_read_b128 a[48:51], v18 offset:64
  ds_read_b128 a[52:55], v18 offset:192
  ds_read_b128 a[56:59], v19 offset:64
  ds_read_b128 a[60:63], v19 offset:192
  ds_read_b64_tr_b16 v[40:41], v22 offset:512
  ds_read_b64_tr_b16 v[42:43], v22 offset:8960
  v_mfma_f32_16x16x32_bf16 v[68:71], v[48:51], a[36:39], v[68:71]
  buffer_load_dwordx4 v10, s[40:43], s81 offen offset:2112 lds
  v_mfma_f32_16x16x32_bf16 v[72:75], v[48:51], a[40:43], v[72:75]
  buffer_load_dwordx4 v11, s[40:43], s81 offen offset:3168 lds
  v_mfma_f32_16x16x32_bf16 v[76:79], v[48:51], a[44:47], v[76:79]
  v_mfma_f32_16x16x32_bf16 v[144:147], v[48:51], v[36:39], v[144:147]
  s_waitcnt lgkmcnt(10)
  v_mfma_f32_16x16x32_bf16 v[80:83], v[52:55], a[32:35], v[80:83]
  ds_read_b64_tr_b16 v[44:45], v22 offset:544
  ds_read_b64_tr_b16 v[46:47], v22 offset:8992
  v_mfma_f32_16x16x32_bf16 v[84:87], v[52:55], a[36:39], v[84:87]
  v_mfma_f32_16x16x32_bf16 v[88:91], v[52:55], a[40:43], v[88:91]
  v_mfma_f32_16x16x32_bf16 v[92:95], v[52:55], a[44:47], v[92:95]
  v_mfma_f32_16x16x32_bf16 v[148:151], v[52:55], v[36:39], v[148:151]
  s_waitcnt lgkmcnt(10)
  v_mfma_f32_16x16x32_bf16 v[96:99], v[56:59], a[32:35], v[96:99]
  ds_read_b64_tr_b16 v[48:49], v23 offset:512
  ds_read_b64_tr_b16 v[50:51], v23 offset:8960
  v_mfma_f32_16x16x32_bf16 v[100:103], v[56:59], a[36:39], v[100:103]
  v_mfma_f32_16x16x32_bf16 v[104:107], v[56:59], a[40:43], v[104:107]
  v_mfma_f32_16x16x32_bf16 v[108:111], v[56:59], a[44:47], v[108:111]
  v_mfma_f32_16x16x32_bf16 v[128:131], v[36:39], a[32:35], v[128:131]
  v_mfma_f32_16x16x32_bf16 v[132:135], a[32:35], a[32:35], v[132:135]
  s_waitcnt lgkmcnt(10)
  v_mfma_f32_16x16x32_bf16 v[112:115], v[60:63], a[32:35], v[112:115]
  ds_read_b64_tr_b16 v[52:53], v23 offset:544
  ds_read_b64_tr_b16 v[54:55], v23 offset:8992
  v_mfma_f32_16x16x32_bf16 v[116:119], v[60:63], a[36:39], v[116:119]
  v_mfma_f32_16x16x32_bf16 v[120:123], v[60:63], a[40:43], v[120:123]
  v_mfma_f32_16x16x32_bf16 v[124:127], v[60:63], a[44:47], v[124:127]
  v_mfma_f32_16x16x32_bf16 v[136:139], v[36:39], a[36:39], v[136:139]
  v_mfma_f32_16x16x32_bf16 v[140:143], a[36:39], a[36:39], v[140:143]
  s_waitcnt lgkmcnt(8)
  s_waitcnt lgkmcnt(6)
  v_mfma_f32_16x16x32_bf16 v[64:67], v[40:43], a[48:51], v[64:67]
  v_mfma_f32_16x16x32_bf16 v[68:71], v[40:43], a[52:55], v[68:71]
  v_mfma_f32_16x16x32_bf16 v[72:75], v[40:43], a[56:59], v[72:75]
  v_mfma_f32_16x16x32_bf16 v[76:79], v[40:43], a[60:63], v[76:79]
  s_waitcnt vmcnt(16)
  s_waitcnt lgkmcnt(0)
  s_barrier
  v_add_u32 v18, 67584, v16
  v_add_u32 v19, 67584, v17
  v_add_u32 v22, 67584, v20
  v_add_u32 v23, 67584, v21
  ds_read_b128 a[64:67], v18 offset:0
  ds_read_b128 a[68:71], v18 offset:128
  ds_read_b128 a[72:75], v19 offset:0
  ds_read_b128 a[76:79], v19 offset:128
  ds_read_b64_tr_b16 v[56:57], v22 offset:0
  ds_read_b64_tr_b16 v[58:59], v22 offset:8448
  v_mfma_f32_16x16x32_bf16 v[144:147], v[40:43], v[36:39], v[144:147]
  s_add_u32 s80, s82, 640
  s_add_u32 m0, s85, 33792
  v_mfma_f32_16x16x32_bf16 v[80:83], v[44:47], a[48:51], v[80:83]
  ds_read_b64_tr_b16 v[60:61], v22 offset:32
  ds_read_b64_tr_b16 v[62:63], v22 offset:8480
  v_mfma_f32_16x16x32_bf16 v[84:87], v[44:47], a[52:55], v[84:87]
  s_add_u32 s81, s83, 1228800
  buffer_load_dwordx4 v4, s[36:39], s80 offen offset:0 lds
  v_mfma_f32_16x16x32_bf16 v[88:91], v[44:47], a[56:59], v[88:91]
  buffer_load_dwordx4 v5, s[36:39], s80 offen offset:1056 lds
  v_mfma_f32_16x16x32_bf16 v[92:95], v[44:47], a[60:63], v[92:95]
  v_mfma_f32_16x16x32_bf16 v[148:151], v[44:47], v[36:39], v[148:151]
  buffer_load_dwordx4 v6, s[36:39], s80 offen offset:2112 lds
  v_mfma_f32_16x16x32_bf16 v[96:99], v[48:51], a[48:51], v[96:99]
  ds_read_b64_tr_b16 v[40:41], v23 offset:0
  ds_read_b64_tr_b16 v[42:43], v23 offset:8448
  v_mfma_f32_16x16x32_bf16 v[100:103], v[48:51], a[52:55], v[100:103]
  buffer_load_dwordx4 v7, s[36:39], s80 offen offset:3168 lds
  v_mfma_f32_16x16x32_bf16 v[104:107], v[48:51], a[56:59], v[104:107]
  s_add_u32 m0, s85, 50688
  s_nop 0
  v_mfma_f32_16x16x32_bf16 v[108:111], v[48:51], a[60:63], v[108:111]
  v_mfma_f32_16x16x32_bf16 v[128:131], v[36:39], a[48:51], v[128:131]
  buffer_load_dwordx4 v8, s[40:43], s81 offen offset:0 lds
  v_mfma_f32_16x16x32_bf16 v[132:135], a[48:51], a[48:51], v[132:135]
  buffer_load_dwordx4 v9, s[40:43], s81 offen offset:1056 lds
  v_mfma_f32_16x16x32_bf16 v[112:115], v[52:55], a[48:51], v[112:115]
  ds_read_b64_tr_b16 v[44:45], v23 offset:32
  ds_read_b64_tr_b16 v[46:47], v23 offset:8480
  v_mfma_f32_16x16x32_bf16 v[116:119], v[52:55], a[52:55], v[116:119]
  buffer_load_dwordx4 v10, s[40:43], s81 offen offset:2112 lds
  v_mfma_f32_16x16x32_bf16 v[120:123], v[52:55], a[56:59], v[120:123]
  buffer_load_dwordx4 v11, s[40:43], s81 offen offset:3168 lds
  v_mfma_f32_16x16x32_bf16 v[124:127], v[52:55], a[60:63], v[124:127]
  v_mfma_f32_16x16x32_bf16 v[136:139], v[36:39], a[52:55], v[136:139]
  v_mfma_f32_16x16x32_bf16 v[140:143], a[52:55], a[52:55], v[140:143]
  s_waitcnt lgkmcnt(8)
  s_waitcnt lgkmcnt(6)
  v_mfma_f32_16x16x32_bf16 v[64:67], v[56:59], a[64:67], v[64:67]
  ds_read_b128 a[80:83], v18 offset:64
  ds_read_b128 a[84:87], v18 offset:192
  ds_read_b128 a[88:91], v19 offset:64
  ds_read_b128 a[92:95], v19 offset:192
  ds_read_b64_tr_b16 v[48:49], v22 offset:512
  ds_read_b64_tr_b16 v[50:51], v22 offset:8960
  v_mfma_f32_16x16x32_bf16 v[68:71], v[56:59], a[68:71], v[68:71]
  v_mfma_f32_16x16x32_bf16 v[72:75], v[56:59], a[72:75], v[72:75]
  v_mfma_f32_16x16x32_bf16 v[76:79], v[56:59], a[76:79], v[76:79]
  v_mfma_f32_16x16x32_bf16 v[144:147], v[56:59], v[36:39], v[144:147]
  s_waitcnt lgkmcnt(10)
  v_mfma_f32_16x16x32_bf16 v[80:83], v[60:63], a[64:67], v[80:83]
  ds_read_b64_tr_b16 v[52:53], v22 offset:544
  ds_read_b64_tr_b16 v[54:55], v22 offset:8992
  v_mfma_f32_16x16x32_bf16 v[84:87], v[60:63], a[68:71], v[84:87]
  v_mfma_f32_16x16x32_bf16 v[88:91], v[60:63], a[72:75], v[88:91]
  v_mfma_f32_16x16x32_bf16 v[92:95], v[60:63], a[76:79], v[92:95]
  v_mfma_f32_16x16x32_bf16 v[148:151], v[60:63], v[36:39], v[148:151]
  s_waitcnt lgkmcnt(10)
  v_mfma_f32_16x16x32_bf16 v[96:99], v[40:43], a[64:67], v[96:99]
  ds_read_b64_tr_b16 v[56:57], v23 offset:512
  ds_read_b64_tr_b16 v[58:59], v23 offset:8960
  v_mfma_f32_16x16x32_bf16 v[100:103], v[40:43], a[68:71], v[100:103]
  v_mfma_f32_16x16x32_bf16 v[104:107], v[40:43], a[72:75], v[104:107]
  v_mfma_f32_16x16x32_bf16 v[108:111], v[40:43], a[76:79], v[108:111]
  v_mfma_f32_16x16x32_bf16 v[128:131], v[36:39], a[64:67], v[128:131]
  v_mfma_f32_16x16x32_bf16 v[132:135], a[64:67], a[64:67], v[132:135]
  s_waitcnt lgkmcnt(10)
  v_mfma_f32_16x16x32_bf16 v[112:115], v[44:47], a[64:67], v[112:115]
  ds_read_b64_tr_b16 v[60:61], v23 offset:544
  ds_read_b64_tr_b16 v[62:63], v23 offset:8992
  v_mfma_f32_16x16x32_bf16 v[116:119], v[44:47], a[68:71], v[116:119]
  v_mfma_f32_16x16x32_bf16 v[120:123], v[44:47], a[72:75], v[120:123]
  v_mfma_f32_16x16x32_bf16 v[124:127], v[44:47], a[76:79], v[124:127]
  v_mfma_f32_16x16x32_bf16 v[136:139], v[36:39], a[68:71], v[136:139]
  v_mfma_f32_16x16x32_bf16 v[140:143], a[68:71], a[68:71], v[140:143]
  s_waitcnt lgkmcnt(8)
  s_waitcnt lgkmcnt(6)
  v_mfma_f32_16x16x32_bf16 v[64:67], v[48:51], a[80:83], v[64:67]
  v_mfma_f32_16x16x32_bf16 v[68:71], v[48:51], a[84:87], v[68:71]
  v_mfma_f32_16x16x32_bf16 v[72:75], v[48:51], a[88:91], v[72:75]
  v_mfma_f32_16x16x32_bf16 v[76:79], v[48:51], a[92:95], v[76:79]
  s_waitcnt vmcnt(16)
  s_waitcnt lgkmcnt(0)
  s_barrier
  v_add_u32 v18, 101376, v16
  v_add_u32 v19, 101376, v17
  v_add_u32 v22, 101376, v20
  v_add_u32 v23, 101376, v21
  s_cmp_lt_u32 s6, 2
  s_cbranch_scc1 cold_5
  s_mov_b32 m0, 139264
  v_and_b32 v32, 7, v1
  v_bfe_u32 v34, v1, 4, 2
  v_lshlrev_b32 v34, 6, v34
  v_bfe_u32 v33, v1, 3, 1
  v_add_u32 v34, v34, v33
  s_lshl_b32 s11, s5, 1
  v_add_u32 v34, s11, v34
  v_mul_u32_u24 v33, 3456, v34
  v_lshl_add_u32 v33, v32, 7, v33
  s_lshr_b32 s11, s4, 1
  s_mul_i32 s12, s11, 896
  v_add_u32 v32, s12, v33
  s_cmp_eq_u32 s6, 3
  s_cbranch_scc1 tw3_6
  s_mov_b32 s91, 0
  buffer_load_dword v32, s[44:47], s91 offen lds
  s_mov_b32 s91, 884736
  buffer_load_dword v32, s[44:47], s91 offen lds
  s_mov_b32 s91, 1769472
  buffer_load_dword v32, s[44:47], s91 offen lds
  s_branch tjoin_7
tw3_6:
  s_mov_b32 s91, 0
  buffer_load_dword v32, s[48:51], s91 offen lds
  s_mov_b32 s91, 884736
  buffer_load_dword v32, s[48:51], s91 offen lds
  s_mov_b32 s91, 1769472
  buffer_load_dword v32, s[48:51], s91 offen lds
tjoin_7:
cold_5:
  ds_read_b128 a[96:99], v18 offset:0
  ds_read_b128 a[100:103], v18 offset:128
  ds_read_b128 a[104:107], v19 offset:0
  ds_read_b128 a[108:111], v19 offset:128
  ds_read_b64_tr_b16 v[40:41], v22 offset:0
  ds_read_b64_tr_b16 v[42:43], v22 offset:8448
  v_mfma_f32_16x16x32_bf16 v[144:147], v[48:51], v[36:39], v[144:147]
  s_add_u32 s80, s82, 768
  s_add_u32 m0, s85, 67584
  v_mfma_f32_16x16x32_bf16 v[80:83], v[52:55], a[80:83], v[80:83]
  ds_read_b64_tr_b16 v[44:45], v22 offset:32
  ds_read_b64_tr_b16 v[46:47], v22 offset:8480
  v_mfma_f32_16x16x32_bf16 v[84:87], v[52:55], a[84:87], v[84:87]
  s_add_u32 s81, s83, 1474560
  buffer_load_dwordx4 v4, s[36:39], s80 offen offset:0 lds
  v_mfma_f32_16x16x32_bf16 v[88:91], v[52:55], a[88:91], v[88:91]
  buffer_load_dwordx4 v5, s[36:39], s80 offen offset:1056 lds
  v_mfma_f32_16x16x32_bf16 v[92:95], v[52:55], a[92:95], v[92:95]
  v_mfma_f32_16x16x32_bf16 v[148:151], v[52:55], v[36:39], v[148:151]
  buffer_load_dwordx4 v6, s[36:39], s80 offen offset:2112 lds
  v_mfma_f32_16x16x32_bf16 v[96:99], v[56:59], a[80:83], v[96:99]
  ds_read_b64_tr_b16 v[48:49], v23 offset:0
  ds_read_b64_tr_b16 v[50:51], v23 offset:8448
  v_mfma_f32_16x16x32_bf16 v[100:103], v[56:59], a[84:87], v[100:103]
  buffer_load_dwordx4 v7, s[36:39], s80 offen offset:3168 lds
  v_mfma_f32_16x16x32_bf16 v[104:107], v[56:59], a[88:91], v[104:107]
  s_add_u32 m0, s85, 84480
  s_nop 0
  v_mfma_f32_16x16x32_bf16 v[108:111], v[56:59], a[92:95], v[108:111]
  v_mfma_f32_16x16x32_bf16 v[128:131], v[36:39], a[80:83], v[128:131]
  buffer_load_dwordx4 v8, s[40:43], s81 offen offset:0 lds
  v_mfma_f32_16x16x32_bf16 v[132:135], a[80:83], a[80:83], v[132:135]
  buffer_load_dwordx4 v9, s[40:43], s81 offen offset:1056 lds
  v_mfma_f32_16x16x32_bf16 v[112:115], v[60:63], a[80:83], v[112:115]
  ds_read_b64_tr_b16 v[52:53], v23 offset:32
  ds_read_b64_tr_b16 v[54:55], v23 offset:8480
  v_mfma_f32_16x16x32_bf16 v[116:119], v[60:63], a[84:87], v[116:119]
  buffer_load_dwordx4 v10, s[40:43], s81 offen offset:2112 lds
  v_mfma_f32_16x16x32_bf16 v[120:123], v[60:63], a[88:91], v[120:123]
  buffer_load_dwordx4 v11, s[40:43], s81 offen offset:3168 lds
  v_mfma_f32_16x16x32_bf16 v[124:127], v[60:63], a[92:95], v[124:127]
  v_mfma_f32_16x16x32_bf16 v[136:139], v[36:39], a[84:87], v[136:139]
  v_mfma_f32_16x16x32_bf16 v[140:143], a[84:87], a[84:87], v[140:143]
  s_waitcnt lgkmcnt(8)
  s_waitcnt lgkmcnt(6)
  v_mfma_f32_16x16x32_bf16 v[64:67], v[40:43], a[96:99], v[64:67]
  ds_read_b128 a[112:115], v18 offset:64
  ds_read_b128 a[116:119], v18 offset:192
  ds_read_b128 a[120:123], v19 offset:64
  ds_read_b128 a[124:127], v19 offset:192
  ds_read_b64_tr_b16 v[56:57], v22 offset:512
  ds_read_b64_tr_b16 v[58:59], v22 offset:8960
  v_mfma_f32_16x16x32_bf16 v[68:71], v[40:43], a[100:103], v[68:71]
  v_mfma_f32_16x16x32_bf16 v[72:75], v[40:43], a[104:107], v[72:75]
  v_mfma_f32_16x16x32_bf16 v[76:79], v[40:43], a[108:111], v[76:79]
  v_mfma_f32_16x16x32_bf16 v[144:147], v[40:43], v[36:39], v[144:147]
  s_waitcnt lgkmcnt(10)
  v_mfma_f32_16x16x32_bf16 v[80:83], v[44:47], a[96:99], v[80:83]
  ds_read_b64_tr_b16 v[60:61], v22 offset:544
  ds_read_b64_tr_b16 v[62:63], v22 offset:8992
  v_mfma_f32_16x16x32_bf16 v[84:87], v[44:47], a[100:103], v[84:87]
  v_mfma_f32_16x16x32_bf16 v[88:91], v[44:47], a[104:107], v[88:91]
  v_mfma_f32_16x16x32_bf16 v[92:95], v[44:47], a[108:111], v[92:95]
  v_mfma_f32_16x16x32_bf16 v[148:151], v[44:47], v[36:39], v[148:151]
  s_waitcnt lgkmcnt(10)
  v_mfma_f32_16x16x32_bf16 v[96:99], v[48:51], a[96:99], v[96:99]
  ds_read_b64_tr_b16 v[40:41], v23 offset:512
  ds_read_b64_tr_b16 v[42:43], v23 offset:8960
  v_mfma_f32_16x16x32_bf16 v[100:103], v[48:51], a[100:103], v[100:103]
  v_mfma_f32_16x16x32_bf16 v[104:107], v[48:51], a[104:107], v[104:107]
  v_mfma_f32_16x16x32_bf16 v[108:111], v[48:51], a[108:111], v[108:111]
  v_mfma_f32_16x16x32_bf16 v[128:131], v[36:39], a[96:99], v[128:131]
  v_mfma_f32_16x16x32_bf16 v[132:135], a[96:99], a[96:99], v[132:135]
  s_waitcnt lgkmcnt(10)
  v_mfma_f32_16x16x32_bf16 v[112:115], v[52:55], a[96:99], v[112:115]
  ds_read_b64_tr_b16 v[44:45], v23 offset:544
  ds_read_b64_tr_b16 v[46:47], v23 offset:8992
  v_mfma_f32_16x16x32_bf16 v[116:119], v[52:55], a[100:103], v[116:119]
  v_mfma_f32_16x16x32_bf16 v[120:123], v[52:55], a[104:107], v[120:123]
  v_mfma_f32_16x16x32_bf16 v[124:127], v[52:55], a[108:111], v[124:127]
  v_mfma_f32_16x16x32_bf16 v[136:139], v[36:39], a[100:103], v[136:139]
  v_mfma_f32_16x16x32_bf16 v[140:143], a[100:103], a[100:103], v[140:143]
  s_waitcnt lgkmcnt(8)
  s_waitcnt lgkmcnt(6)
  v_mfma_f32_16x16x32_bf16 v[64:67], v[56:59], a[112:115], v[64:67]
  v_mfma_f32_16x16x32_bf16 v[68:71], v[56:59], a[116:119], v[68:71]
  v_mfma_f32_16x16x32_bf16 v[72:75], v[56:59], a[120:123], v[72:75]
  v_mfma_f32_16x16x32_bf16 v[76:79], v[56:59], a[124:127], v[76:79]
  s_waitcnt vmcnt(16)
  s_waitcnt lgkmcnt(0)
  s_barrier
  v_add_u32 v18, 0, v16
  v_add_u32 v19, 0, v17
  v_add_u32 v22, 0, v20
  v_add_u32 v23, 0, v21
  ds_read_b128 a[128:131], v18 offset:0
  ds_read_b128 a[132:135], v18 offset:128
  ds_read_b128 a[136:139], v19 offset:0
  ds_read_b128 a[140:143], v19 offset:128
  ds_read_b64_tr_b16 v[48:49], v22 offset:0
  ds_read_b64_tr_b16 v[50:51], v22 offset:8448
  v_mfma_f32_16x16x32_bf16 v[144:147], v[56:59], v[36:39], v[144:147]
  s_add_u32 s80, s82, 896
  s_add_u32 m0, s85, 101376
  v_mfma_f32_16x16x32_bf16 v[80:83], v[60:63], a[112:115], v[80:83]
  ds_read_b64_tr_b16 v[52:53], v22 offset:32
  ds_read_b64_tr_b16 v[54:55], v22 offset:8480
  v_mfma_f32_16x16x32_bf16 v[84:87], v[60:63], a[116:119], v[84:87]
  s_add_u32 s81, s83, 1720320
  buffer_load_dwordx4 v4, s[36:39], s80 offen offset:0 lds
  v_mfma_f32_16x16x32_bf16 v[88:91], v[60:63], a[120:123], v[88:91]
  buffer_load_dwordx4 v5, s[36:39], s80 offen offset:1056 lds
  v_mfma_f32_16x16x32_bf16 v[92:95], v[60:63], a[124:127], v[92:95]
  v_mfma_f32_16x16x32_bf16 v[148:151], v[60:63], v[36:39], v[148:151]
  buffer_load_dwordx4 v6, s[36:39], s80 offen offset:2112 lds
  v_mfma_f32_16x16x32_bf16 v[96:99], v[40:43], a[112:115], v[96:99]
  ds_read_b64_tr_b16 v[56:57], v23 offset:0
  ds_read_b64_tr_b16 v[58:59], v23 offset:8448
  v_mfma_f32_16x16x32_bf16 v[100:103], v[40:43], a[116:119], v[100:103]
  buffer_load_dwordx4 v7, s[36:39], s80 offen offset:3168 lds
  v_mfma_f32_16x16x32_bf16 v[104:107], v[40:43], a[120:123], v[104:107]
  s_add_u32 m0, s85, 118272
  s_nop 0
  v_mfma_f32_16x16x32_bf16 v[108:111], v[40:43], a[124:127], v[108:111]
  v_mfma_f32_16x16x32_bf16 v[128:131], v[36:39], a[112:115], v[128:131]
  buffer_load_dwordx4 v8, s[40:43], s81 offen offset:0 lds
  v_mfma_f32_16x16x32_bf16 v[132:135], a[112:115], a[112:115], v[132:135]
  buffer_load_dwordx4 v9, s[40:43], s81 offen offset:1056 lds
  v_mfma_f32_16x16x32_bf16 v[112:115], v[44:47], a[112:115], v[112:115]
  ds_read_b64_tr_b16 v[60:61], v23 offset:32
  ds_read_b64_tr_b16 v[62:63], v23 offset:8480
  v_mfma_f32_16x16x32_bf16 v[116:119], v[44:47], a[116:119], v[116:119]
  buffer_load_dwordx4 v10, s[40:43], s81 offen offset:2112 lds
  v_mfma_f32_16x16x32_bf16 v[120:123], v[44:47], a[120:123], v[120:123]
  buffer_load_dwordx4 v11, s[40:43], s81 offen offset:3168 lds
  v_mfma_f32_16x16x32_bf16 v[124:127], v[44:47], a[124:127], v[124:127]
  v_mfma_f32_16x16x32_bf16 v[136:139], v[36:39], a[116:119], v[136:139]
  v_mfma_f32_16x16x32_bf16 v[140:143], a[116:119], a[116:119], v[140:143]
  s_waitcnt lgkmcnt(8)
  s_waitcnt lgkmcnt(6)
  v_mfma_f32_16x16x32_bf16 v[64:67], v[48:51], a[128:131], v[64:67]
  ds_read_b128 a[144:147], v18 offset:64
  ds_read_b128 a[148:151], v18 offset:192
  ds_read_b128 a[152:155], v19 offset:64
  ds_read_b128 a[156:159], v19 offset:192
  ds_read_b64_tr_b16 v[40:41], v22 offset:512
  ds_read_b64_tr_b16 v[42:43], v22 offset:8960
  v_mfma_f32_16x16x32_bf16 v[68:71], v[48:51], a[132:135], v[68:71]
  v_mfma_f32_16x16x32_bf16 v[72:75], v[48:51], a[136:139], v[72:75]
  v_mfma_f32_16x16x32_bf16 v[76:79], v[48:51], a[140:143], v[76:79]
  v_mfma_f32_16x16x32_bf16 v[144:147], v[48:51], v[36:39], v[144:147]
  s_waitcnt lgkmcnt(10)
  v_mfma_f32_16x16x32_bf16 v[80:83], v[52:55], a[128:131], v[80:83]
  ds_read_b64_tr_b16 v[44:45], v22 offset:544
  ds_read_b64_tr_b16 v[46:47], v22 offset:8992
  v_mfma_f32_16x16x32_bf16 v[84:87], v[52:55], a[132:135], v[84:87]
  v_mfma_f32_16x16x32_bf16 v[88:91], v[52:55], a[136:139], v[88:91]
  v_mfma_f32_16x16x32_bf16 v[92:95], v[52:55], a[140:143], v[92:95]
  v_mfma_f32_16x16x32_bf16 v[148:151], v[52:55], v[36:39], v[148:151]
  s_waitcnt lgkmcnt(10)
  v_mfma_f32_16x16x32_bf16 v[96:99], v[56:59], a[128:131], v[96:99]
  ds_read_b64_tr_b16 v[48:49], v23 offset:512
  ds_read_b64_tr_b16 v[50:51], v23 offset:8960
  v_mfma_f32_16x16x32_bf16 v[100:103], v[56:59], a[132:135], v[100:103]
  v_mfma_f32_16x16x32_bf16 v[104:107], v[56:59], a[136:139], v[104:107]
  v_mfma_f32_16x16x32_bf16 v[108:111], v[56:59], a[140:143], v[108:111]
  v_mfma_f32_16x16x32_bf16 v[128:131], v[36:39], a[128:131], v[128:131]
  v_mfma_f32_16x16x32_bf16 v[132:135], a[128:131], a[128:131], v[132:135]
  s_waitcnt lgkmcnt(10)
  v_mfma_f32_16x16x32_bf16 v[112:115], v[60:63], a[128:131], v[112:115]
  ds_read_b64_tr_b16 v[52:53], v23 offset:544
  ds_read_b64_tr_b16 v[54:55], v23 offset:8992
  v_mfma_f32_16x16x32_bf16 v[116:119], v[60:63], a[132:135], v[116:119]
  v_mfma_f32_16x16x32_bf16 v[120:123], v[60:63], a[136:139], v[120:123]
  v_mfma_f32_16x16x32_bf16 v[124:127], v[60:63], a[140:143], v[124:127]
  v_mfma_f32_16x16x32_bf16 v[136:139], v[36:39], a[132:135], v[136:139]
  v_mfma_f32_16x16x32_bf16 v[140:143], a[132:135], a[132:135], v[140:143]
  s_waitcnt lgkmcnt(8)
  s_waitcnt lgkmcnt(6)
  v_mfma_f32_16x16x32_bf16 v[64:67], v[40:43], a[144:147], v[64:67]
  v_mfma_f32_16x16x32_bf16 v[68:71], v[40:43], a[148:151], v[68:71]
  v_mfma_f32_16x16x32_bf16 v[72:75], v[40:43], a[152:155], v[72:75]
  v_mfma_f32_16x16x32_bf16 v[76:79], v[40:43], a[156:159], v[76:79]
  s_waitcnt vmcnt(16)
  s_waitcnt lgkmcnt(0)
  s_barrier
  v_add_u32 v18, 33792, v16
  v_add_u32 v19, 33792, v17
  v_add_u32 v22, 33792, v20
  v_add_u32 v23, 33792, v21
  s_cmp_lt_u32 s6, 2
  s_cbranch_scc1 cold_8
  s_lshl_b32 s14, s2, 2
  s_lshl_b32 s15, s6, 1
  s_add_u32 s14, s14, s15
  s_add_u32 s14, s14, -4
  s_mul_i32 s11, s14, 6554
  s_lshr_b32 s11, s11, 16
  s_mul_i32 s12, s11, 10
  s_sub_u32 s12, s14, s12
  s_mul_i32 s96, s11, 40
  s_lshl_b32 s13, s12, 2
  s_add_u32 s96, s96, s13
  s_lshl_b32 s96, s96, 10
  s_add_u32 s96, s96, 19922944
  s_cmp_lt_u32 s14, 740
  s_cselect_b32 s96, s96, 0x40000000
  s_cmp_lt_u32 s11, 54
  s_cselect_b32 s92, s56, s60
  s_cselect_b32 s93, s57, s61
  s_cselect_b32 s94, s58, s62
  s_mov_b32 s95, 0x00020000
  s_cselect_b32 s13, 0, 54
  s_sub_u32 s11, s11, s13
  s_mul_i32 s11, s11, 40960
  s_lshl_b32 s12, s12, 7
  s_add_u32 s11, s11, s12
  v_lshrrev_b32 v32, 3, v1
  v_mul_u32_u24 v32, 1280, v32
  v_and_b32 v33, 7, v1
  v_lshl_add_u32 v32, v33, 4, v32
  s_lshl_b32 s12, s6, 13
  s_add_u32 m0, s12, 126976
  s_add_u32 s13, s11, 0
  buffer_load_dwordx4 v32, s[92:95], s13 offen lds
  s_add_u32 m0, s12, 128000
  s_add_u32 s13, s11, 10240
  buffer_load_dwordx4 v32, s[92:95], s13 offen lds
  s_add_u32 m0, s12, 129024
  s_add_u32 s13, s11, 20480
  buffer_load_dwordx4 v32, s[92:95], s13 offen lds
  s_add_u32 m0, s12, 130048
  s_add_u32 s13, s11, 30720
  buffer_load_dwordx4 v32, s[92:95], s13 offen lds
  s_lshl_b32 s14, s2, 2
  s_lshl_b32 s15, s6, 1
  s_add_u32 s14, s14, s15
  s_add_u32 s14, s14, -3
  s_mul_i32 s11, s14, 6554
  s_lshr_b32 s11, s11, 16
  s_mul_i32 s12, s11, 10
  s_sub_u32 s12, s14, s12
  s_mul_i32 s97, s11, 40
  s_lshl_b32 s13, s12, 2
  s_add_u32 s97, s97, s13
  s_lshl_b32 s97, s97, 10
  s_add_u32 s97, s97, 19922944
  s_cmp_lt_u32 s14, 740
  s_cselect_b32 s97, s97, 0x40000000
  s_cmp_lt_u32 s11, 54
  s_cselect_b32 s92, s56, s60
  s_cselect_b32 s93, s57, s61
  s_cselect_b32 s94, s58, s62
  s_mov_b32 s95, 0x00020000
  s_cselect_b32 s13, 0, 54
  s_sub_u32 s11, s11, s13
  s_mul_i32 s11, s11, 40960
  s_lshl_b32 s12, s12, 7
  s_add_u32 s11, s11, s12
  v_lshrrev_b32 v32, 3, v1
  v_mul_u32_u24 v32, 1280, v32
  v_and_b32 v33, 7, v1
  v_lshl_add_u32 v32, v33, 4, v32
  s_lshl_b32 s12, s6, 13
  s_add_u32 m0, s12, 131072
  s_add_u32 s13, s11, 0
  buffer_load_dwordx4 v32, s[92:95], s13 offen lds
  s_add_u32 m0, s12, 132096
  s_add_u32 s13, s11, 10240
  buffer_load_dwordx4 v32, s[92:95], s13 offen lds
  s_add_u32 m0, s12, 133120
  s_add_u32 s13, s11, 20480
  buffer_load_dwordx4 v32, s[92:95], s13 offen lds
  s_add_u32 m0, s12, 134144
  s_add_u32 s13, s11, 30720
  buffer_load_dwordx4 v32, s[92:95], s13 offen lds
cold_8:
  ds_read_b128 a[160:163], v18 offset:0
  ds_read_b128 a[164:167], v18 offset:128
  ds_read_b128 a[168:171], v19 offset:0
  ds_read_b128 a[172:175], v19 offset:128
  ds_read_b64_tr_b16 v[56:57], v22 offset:0
  ds_read_b64_tr_b16 v[58:59], v22 offset:8448
  v_mfma_f32_16x16x32_bf16 v[144:147], v[40:43], v[36:39], v[144:147]
  s_add_u32 s80, s82, 1024
  s_add_u32 m0, s85, 0
  v_mfma_f32_16x16x32_bf16 v[80:83], v[44:47], a[144:147], v[80:83]
  ds_read_b64_tr_b16 v[60:61], v22 offset:32
  ds_read_b64_tr_b16 v[62:63], v22 offset:8480
  v_mfma_f32_16x16x32_bf16 v[84:87], v[44:47], a[148:151], v[84:87]
  s_add_u32 s81, s83, 1966080
  buffer_load_dwordx4 v4, s[36:39], s80 offen offset:0 lds
  v_mfma_f32_16x16x32_bf16 v[88:91], v[44:47], a[152:155], v[88:91]
  buffer_load_dwordx4 v5, s[36:39], s80 offen offset:1056 lds
  v_mfma_f32_16x16x32_bf16 v[92:95], v[44:47], a[156:159], v[92:95]
  v_mfma_f32_16x16x32_bf16 v[148:151], v[44:47], v[36:39], v[148:151]
  buffer_load_dwordx4 v6, s[36:39], s80 offen offset:2112 lds
  v_mfma_f32_16x16x32_bf16 v[96:99], v[48:51], a[144:147], v[96:99]
  ds_read_b64_tr_b16 v[40:41], v23 offset:0
  ds_read_b64_tr_b16 v[42:43], v23 offset:8448
  v_mfma_f32_16x16x32_bf16 v[100:103], v[48:51], a[148:151], v[100:103]
  buffer_load_dwordx4 v7, s[36:39], s80 offen offset:3168 lds
  v_mfma_f32_16x16x32_bf16 v[104:107], v[48:51], a[152:155], v[104:107]
  s_add_u32 m0, s85, 16896
  s_nop 0
  v_mfma_f32_16x16x32_bf16 v[108:111], v[48:51], a[156:159], v[108:111]
  v_mfma_f32_16x16x32_bf16 v[128:131], v[36:39], a[144:147], v[128:131]
  buffer_load_dwordx4 v8, s[40:43], s81 offen offset:0 lds
  v_mfma_f32_16x16x32_bf16 v[132:135], a[144:147], a[144:147], v[132:135]
  buffer_load_dwordx4 v9, s[40:43], s81 offen offset:1056 lds
  v_mfma_f32_16x16x32_bf16 v[112:115], v[52:55], a[144:147], v[112:115]
  ds_read_b64_tr_b16 v[44:45], v23 offset:32
  ds_read_b64_tr_b16 v[46:47], v23 offset:8480
  v_mfma_f32_16x16x32_bf16 v[116:119], v[52:55], a[148:151], v[116:119]
  buffer_load_dwordx4 v10, s[40:43], s81 offen offset:2112 lds
  v_mfma_f32_16x16x32_bf16 v[120:123], v[52:55], a[152:155], v[120:123]
  buffer_load_dwordx4 v11, s[40:43], s81 offen offset:3168 lds
  v_mfma_f32_16x16x32_bf16 v[124:127], v[52:55], a[156:159], v[124:127]
  v_mfma_f32_16x16x32_bf16 v[136:139], v[36:39], a[148:151], v[136:139]
  v_mfma_f32_16x16x32_bf16 v[140:143], a[148:151], a[148:151], v[140:143]
  s_waitcnt lgkmcnt(8)
  s_waitcnt lgkmcnt(6)
  v_mfma_f32_16x16x32_bf16 v[64:67], v[56:59], a[160:163], v[64:67]
  ds_read_b128 a[176:179], v18 offset:64
  ds_read_b128 a[180:183], v18 offset:192
  ds_read_b128 a[184:187], v19 offset:64
  ds_read_b128 a[188:191], v19 offset:192
  ds_read_b64_tr_b16 v[48:49], v22 offset:512
  ds_read_b64_tr_b16 v[50:51], v22 offset:8960
  v_mfma_f32_16x16x32_bf16 v[68:71], v[56:59], a[164:167], v[68:71]
  v_mfma_f32_16x16x32_bf16 v[72:75], v[56:59], a[168:171], v[72:75]
  v_mfma_f32_16x16x32_bf16 v[76:79], v[56:59], a[172:175], v[76:79]
  v_mfma_f32_16x16x32_bf16 v[144:147], v[56:59], v[36:39], v[144:147]
  s_waitcnt lgkmcnt(10)
  v_mfma_f32_16x16x32_bf16 v[80:83], v[60:63], a[160:163], v[80:83]
  ds_read_b64_tr_b16 v[52:53], v22 offset:544
  ds_read_b64_tr_b16 v[54:55], v22 offset:8992
  v_mfma_f32_16x16x32_bf16 v[84:87], v[60:63], a[164:167], v[84:87]
  v_mfma_f32_16x16x32_bf16 v[88:91], v[60:63], a[168:171], v[88:91]
  v_mfma_f32_16x16x32_bf16 v[92:95], v[60:63], a[172:175], v[92:95]
  v_mfma_f32_16x16x32_bf16 v[148:151], v[60:63], v[36:39], v[148:151]
  s_waitcnt lgkmcnt(10)
  v_mfma_f32_16x16x32_bf16 v[96:99], v[40:43], a[160:163], v[96:99]
  ds_read_b64_tr_b16 v[56:57], v23 offset:512
  ds_read_b64_tr_b16 v[58:59], v23 offset:8960
  v_mfma_f32_16x16x32_bf16 v[100:103], v[40:43], a[164:167], v[100:103]
  v_mfma_f32_16x16x32_bf16 v[104:107], v[40:43], a[168:171], v[104:107]
  v_mfma_f32_16x16x32_bf16 v[108:111], v[40:43], a[172:175], v[108:111]
  v_mfma_f32_16x16x32_bf16 v[128:131], v[36:39], a[160:163], v[128:131]
  v_mfma_f32_16x16x32_bf16 v[132:135], a[160:163], a[160:163], v[132:135]
  s_waitcnt lgkmcnt(10)
  v_mfma_f32_16x16x32_bf16 v[112:115], v[44:47], a[160:163], v[112:115]
  ds_read_b64_tr_b16 v[60:61], v23 offset:544
  ds_read_b64_tr_b16 v[62:63], v23 offset:8992
  v_mfma_f32_16x16x32_bf16 v[116:119], v[44:47], a[164:167], v[116:119]
  v_mfma_f32_16x16x32_bf16 v[120:123], v[44:47], a[168:171], v[120:123]
  v_mfma_f32_16x16x32_bf16 v[124:127], v[44:47], a[172:175], v[124:127]
  v_mfma_f32_16x16x32_bf16 v[136:139], v[36:39], a[164:167], v[136:139]
  v_mfma_f32_16x16x32_bf16 v[140:143], a[164:167], a[164:167], v[140:143]
  s_waitcnt lgkmcnt(8)
  s_waitcnt lgkmcnt(6)
  v_mfma_f32_16x16x32_bf16 v[64:67], v[48:51], a[176:179], v[64:67]
  v_mfma_f32_16x16x32_bf16 v[68:71], v[48:51], a[180:183], v[68:71]
  v_mfma_f32_16x16x32_bf16 v[72:75], v[48:51], a[184:187], v[72:75]
  v_mfma_f32_16x16x32_bf16 v[76:79], v[48:51], a[188:191], v[76:79]
  s_waitcnt vmcnt(16)
  s_waitcnt lgkmcnt(0)
  s_barrier
  v_add_u32 v18, 67584, v16
  v_add_u32 v19, 67584, v17
  v_add_u32 v22, 67584, v20
  v_add_u32 v23, 67584, v21
  ds_read_b128 a[192:195], v18 offset:0
  ds_read_b128 a[196:199], v18 offset:128
  ds_read_b128 a[200:203], v19 offset:0
  ds_read_b128 a[204:207], v19 offset:128
  ds_read_b64_tr_b16 v[40:41], v22 offset:0
  ds_read_b64_tr_b16 v[42:43], v22 offset:8448
  v_mfma_f32_16x16x32_bf16 v[144:147], v[48:51], v[36:39], v[144:147]
  s_add_u32 s80, s82, 1152
  s_add_u32 m0, s85, 33792
  v_mfma_f32_16x16x32_bf16 v[80:83], v[52:55], a[176:179], v[80:83]
  ds_read_b64_tr_b16 v[44:45], v22 offset:32
  ds_read_b64_tr_b16 v[46:47], v22 offset:8480
  v_mfma_f32_16x16x32_bf16 v[84:87], v[52:55], a[180:183], v[84:87]
  s_add_u32 s81, s83, 2211840
  buffer_load_dwordx4 v4, s[36:39], s80 offen offset:0 lds
  v_mfma_f32_16x16x32_bf16 v[88:91], v[52:55], a[184:187], v[88:91]
  buffer_load_dwordx4 v5, s[36:39], s80 offen offset:1056 lds
  v_mfma_f32_16x16x32_bf16 v[92:95], v[52:55], a[188:191], v[92:95]
  v_mfma_f32_16x16x32_bf16 v[148:151], v[52:55], v[36:39], v[148:151]
  buffer_load_dwordx4 v6, s[36:39], s80 offen offset:2112 lds
  v_mfma_f32_16x16x32_bf16 v[96:99], v[56:59], a[176:179], v[96:99]
  ds_read_b64_tr_b16 v[48:49], v23 offset:0
  ds_read_b64_tr_b16 v[50:51], v23 offset:8448
  v_mfma_f32_16x16x32_bf16 v[100:103], v[56:59], a[180:183], v[100:103]
  buffer_load_dwordx4 v7, s[36:39], s80 offen offset:3168 lds
  v_mfma_f32_16x16x32_bf16 v[104:107], v[56:59], a[184:187], v[104:107]
  s_add_u32 m0, s85, 50688
  s_nop 0
  v_mfma_f32_16x16x32_bf16 v[108:111], v[56:59], a[188:191], v[108:111]
  v_mfma_f32_16x16x32_bf16 v[128:131], v[36:39], a[176:179], v[128:131]
  buffer_load_dwordx4 v8, s[40:43], s81 offen offset:0 lds
  v_mfma_f32_16x16x32_bf16 v[132:135], a[176:179], a[176:179], v[132:135]
  buffer_load_dwordx4 v9, s[40:43], s81 offen offset:1056 lds
  v_mfma_f32_16x16x32_bf16 v[112:115], v[60:63], a[176:179], v[112:115]
  ds_read_b64_tr_b16 v[52:53], v23 offset:32
  ds_read_b64_tr_b16 v[54:55], v23 offset:8480
  v_mfma_f32_16x16x32_bf16 v[116:119], v[60:63], a[180:183], v[116:119]
  buffer_load_dwordx4 v10, s[40:43], s81 offen offset:2112 lds
  v_mfma_f32_16x16x32_bf16 v[120:123], v[60:63], a[184:187], v[120:123]
  buffer_load_dwordx4 v11, s[40:43], s81 offen offset:3168 lds
  v_mfma_f32_16x16x32_bf16 v[124:127], v[60:63], a[188:191], v[124:127]
  v_mfma_f32_16x16x32_bf16 v[136:139], v[36:39], a[180:183], v[136:139]
  v_mfma_f32_16x16x32_bf16 v[140:143], a[180:183], a[180:183], v[140:143]
  s_waitcnt lgkmcnt(8)
  s_waitcnt lgkmcnt(6)
  v_mfma_f32_16x16x32_bf16 v[64:67], v[40:43], a[192:195], v[64:67]
  ds_read_b128 a[208:211], v18 offset:64
  ds_read_b128 a[212:215], v18 offset:192
  ds_read_b128 a[216:219], v19 offset:64
  ds_read_b128 a[220:223], v19 offset:192
  ds_read_b64_tr_b16 v[56:57], v22 offset:512
  ds_read_b64_tr_b16 v[58:59], v22 offset:8960
  v_mfma_f32_16x16x32_bf16 v[68:71], v[40:43], a[196:199], v[68:71]
  v_mfma_f32_16x16x32_bf16 v[72:75], v[40:43], a[200:203], v[72:75]
  v_mfma_f32_16x16x32_bf16 v[76:79], v[40:43], a[204:207], v[76:79]
  v_mfma_f32_16x16x32_bf16 v[144:147], v[40:43], v[36:39], v[144:147]
  s_waitcnt lgkmcnt(10)
  v_mfma_f32_16x16x32_bf16 v[80:83], v[44:47], a[192:195], v[80:83]
  ds_read_b64_tr_b16 v[60:61], v22 offset:544
  ds_read_b64_tr_b16 v[62:63], v22 offset:8992
  v_mfma_f32_16x16x32_bf16 v[84:87], v[44:47], a[196:199], v[84:87]
  v_mfma_f32_16x16x32_bf16 v[88:91], v[44:47], a[200:203], v[88:91]
  v_mfma_f32_16x16x32_bf16 v[92:95], v[44:47], a[204:207], v[92:95]
  v_mfma_f32_16x16x32_bf16 v[148:151], v[44:47], v[36:39], v[148:151]
  s_waitcnt lgkmcnt(10)
  v_mfma_f32_16x16x32_bf16 v[96:99], v[48:51], a[192:195], v[96:99]
  ds_read_b64_tr_b16 v[40:41], v23 offset:512
  ds_read_b64_tr_b16 v[42:43], v23 offset:8960
  v_mfma_f32_16x16x32_bf16 v[100:103], v[48:51], a[196:199], v[100:103]
  v_mfma_f32_16x16x32_bf16 v[104:107], v[48:51], a[200:203], v[104:107]
  v_mfma_f32_16x16x32_bf16 v[108:111], v[48:51], a[204:207], v[108:111]
  v_mfma_f32_16x16x32_bf16 v[128:131], v[36:39], a[192:195], v[128:131]
  v_mfma_f32_16x16x32_bf16 v[132:135], a[192:195], a[192:195], v[132:135]
  s_waitcnt lgkmcnt(10)
  v_mfma_f32_16x16x32_bf16 v[112:115], v[52:55], a[192:195], v[112:115]
  ds_read_b64_tr_b16 v[44:45], v23 offset:544
  ds_read_b64_tr_b16 v[46:47], v23 offset:8992
  v_mfma_f32_16x16x32_bf16 v[116:119], v[52:55], a[196:199], v[116:119]
  v_mfma_f32_16x16x32_bf16 v[120:123], v[52:55], a[200:203], v[120:123]
  v_mfma_f32_16x16x32_bf16 v[124:127], v[52:55], a[204:207], v[124:127]
  v_mfma_f32_16x16x32_bf16 v[136:139], v[36:39], a[196:199], v[136:139]
  v_mfma_f32_16x16x32_bf16 v[140:143], a[196:199], a[196:199], v[140:143]
  s_waitcnt lgkmcnt(8)
  s_waitcnt lgkmcnt(6)
  v_mfma_f32_16x16x32_bf16 v[64:67], v[56:59], a[208:211], v[64:67]
  v_mfma_f32_16x16x32_bf16 v[68:71], v[56:59], a[212:215], v[68:71]
  v_mfma_f32_16x16x32_bf16 v[72:75], v[56:59], a[216:219], v[72:75]
  v_mfma_f32_16x16x32_bf16 v[76:79], v[56:59], a[220:223], v[76:79]
  s_waitcnt vmcnt(16)
  s_waitcnt lgkmcnt(0)
  s_barrier
  v_add_u32 v18, 101376, v16
  v_add_u32 v19, 101376, v17
  v_add_u32 v22, 101376, v20
  v_add_u32 v23, 101376, v21
  s_mov_b32 s28, s32
  s_mov_b32 s29, s33
  s_mov_b32 s30, 256
  s_mov_b32 s31, 0x00020000
  s_xor_b32 s11, s6, 2
  s_add_u32 s11, s11, s2
  s_cmp_lg_u32 s11, 0
  s_cbranch_scc1 epub_9
  s_memrealtime s[100:101]
  s_waitcnt lgkmcnt(0)
  s_or_b32 s100, s100, 1
  v_mov_b32 v32, s100
  v_mov_b32 v33, 0
  s_mov_b64 exec, 1
  buffer_store_dword v32, v33, s[28:31], 0 offen sc1
  s_mov_b64 exec, -1
epub_9:
  ds_read_b128 a[224:227], v18 offset:0
  ds_read_b128 a[228:231], v18 offset:128
  ds_read_b128 a[232:235], v19 offset:0
  ds_read_b128 a[236:239], v19 offset:128
  ds_read_b64_tr_b16 v[48:49], v22 offset:0
  ds_read_b64_tr_b16 v[50:51], v22 offset:8448
  v_mfma_f32_16x16x32_bf16 v[144:147], v[56:59], v[36:39], v[144:147]
  s_add_u32 m0, s85, 67584
  s_add_u32 s81, s84, 0
  v_mfma_f32_16x16x32_bf16 v[80:83], v[60:63], a[208:211], v[80:83]
  ds_read_b64_tr_b16 v[52:53], v22 offset:32
  ds_read_b64_tr_b16 v[54:55], v22 offset:8480
  v_mfma_f32_16x16x32_bf16 v[84:87], v[60:63], a[212:215], v[84:87]
  buffer_load_dwordx4 v12, s[44:47], s81 offen offset:0 lds
  v_mfma_f32_16x16x32_bf16 v[88:91], v[60:63], a[216:219], v[88:91]
  buffer_load_dwordx4 v13, s[44:47], s81 offen offset:1056 lds
  v_mfma_f32_16x16x32_bf16 v[92:95], v[60:63], a[220:223], v[92:95]
  v_mfma_f32_16x16x32_bf16 v[148:151], v[60:63], v[36:39], v[148:151]
  buffer_load_dwordx4 v14, s[44:47], s81 offen offset:2112 lds
  v_mfma_f32_16x16x32_bf16 v[96:99], v[40:43], a[208:211], v[96:99]
  ds_read_b64_tr_b16 v[56:57], v23 offset:0
  ds_read_b64_tr_b16 v[58:59], v23 offset:8448
  v_mfma_f32_16x16x32_bf16 v[100:103], v[40:43], a[212:215], v[100:103]
  buffer_load_dwordx4 v15, s[44:47], s81 offen offset:3168 lds
  v_mfma_f32_16x16x32_bf16 v[104:107], v[40:43], a[216:219], v[104:107]
  s_add_u32 m0, s85, 84496
  s_nop 0
  v_mfma_f32_16x16x32_bf16 v[108:111], v[40:43], a[220:223], v[108:111]
  v_mfma_f32_16x16x32_bf16 v[128:131], v[36:39], a[208:211], v[128:131]
  buffer_load_dwordx4 v12, s[48:51], s81 offen offset:0 lds
  v_mfma_f32_16x16x32_bf16 v[132:135], a[208:211], a[208:211], v[132:135]
  buffer_load_dwordx4 v13, s[48:51], s81 offen offset:1056 lds
  v_mfma_f32_16x16x32_bf16 v[112:115], v[44:47], a[208:211], v[112:115]
  ds_read_b64_tr_b16 v[60:61], v23 offset:32
  ds_read_b64_tr_b16 v[62:63], v23 offset:8480
  v_mfma_f32_16x16x32_bf16 v[116:119], v[44:47], a[212:215], v[116:119]
  buffer_load_dwordx4 v14, s[48:51], s81 offen offset:2112 lds
  v_mfma_f32_16x16x32_bf16 v[120:123], v[44:47], a[216:219], v[120:123]
  buffer_load_dwordx4 v15, s[48:51], s81 offen offset:3168 lds
  v_mfma_f32_16x16x32_bf16 v[124:127], v[44:47], a[220:223], v[124:127]
  v_mfma_f32_16x16x32_bf16 v[136:139], v[36:39], a[212:215], v[136:139]
  v_mfma_f32_16x16x32_bf16 v[140:143], a[212:215], a[212:215], v[140:143]
  s_waitcnt lgkmcnt(8)
  s_waitcnt lgkmcnt(6)
  v_mfma_f32_16x16x32_bf16 v[64:67], v[48:51], a[224:227], v[64:67]
  ds_read_b128 a[240:243], v18 offset:64
  ds_read_b128 a[244:247], v18 offset:192
  ds_read_b128 a[248:251], v19 offset:64
  ds_read_b128 a[252:255], v19 offset:192
  ds_read_b64_tr_b16 v[40:41], v22 offset:512
  ds_read_b64_tr_b16 v[42:43], v22 offset:8960
  v_mfma_f32_16x16x32_bf16 v[68:71], v[48:51], a[228:231], v[68:71]
  v_mfma_f32_16x16x32_bf16 v[72:75], v[48:51], a[232:235], v[72:75]
  v_mfma_f32_16x16x32_bf16 v[76:79], v[48:51], a[236:239], v[76:79]
  v_mfma_f32_16x16x32_bf16 v[144:147], v[48:51], v[36:39], v[144:147]
  s_waitcnt lgkmcnt(10)
  v_mfma_f32_16x16x32_bf16 v[80:83], v[52:55], a[224:227], v[80:83]
  ds_read_b64_tr_b16 v[44:45], v22 offset:544
  ds_read_b64_tr_b16 v[46:47], v22 offset:8992
  v_mfma_f32_16x16x32_bf16 v[84:87], v[52:55], a[228:231], v[84:87]
  v_mfma_f32_16x16x32_bf16 v[88:91], v[52:55], a[232:235], v[88:91]
  v_mfma_f32_16x16x32_bf16 v[92:95], v[52:55], a[236:239], v[92:95]
  v_mfma_f32_16x16x32_bf16 v[148:151], v[52:55], v[36:39], v[148:151]
  s_waitcnt lgkmcnt(10)
  v_mfma_f32_16x16x32_bf16 v[96:99], v[56:59], a[224:227], v[96:99]
  ds_read_b64_tr_b16 v[48:49], v23 offset:512
  ds_read_b64_tr_b16 v[50:51], v23 offset:8960
  v_mfma_f32_16x16x32_bf16 v[100:103], v[56:59], a[228:231], v[100:103]
  v_mfma_f32_16x16x32_bf16 v[104:107], v[56:59], a[232:235], v[104:107]
  v_mfma_f32_16x16x32_bf16 v[108:111], v[56:59], a[236:239], v[108:111]
  v_mfma_f32_16x16x32_bf16 v[128:131], v[36:39], a[224:227], v[128:131]
  v_mfma_f32_16x16x32_bf16 v[132:135], a[224:227], a[224:227], v[132:135]
  s_waitcnt lgkmcnt(10)
  v_mfma_f32_16x16x32_bf16 v[112:115], v[60:63], a[224:227], v[112:115]
  ds_read_b64_tr_b16 v[52:53], v23 offset:544
  ds_read_b64_tr_b16 v[54:55], v23 offset:8992
  v_mfma_f32_16x16x32_bf16 v[116:119], v[60:63], a[228:231], v[116:119]
  v_mfma_f32_16x16x32_bf16 v[120:123], v[60:63], a[232:235], v[120:123]
  v_mfma_f32_16x16x32_bf16 v[124:127], v[60:63], a[236:239], v[124:127]
  v_mfma_f32_16x16x32_bf16 v[136:139], v[36:39], a[228:231], v[136:139]
  v_mfma_f32_16x16x32_bf16 v[140:143], a[228:231], a[228:231], v[140:143]
  s_waitcnt lgkmcnt(8)
  s_waitcnt lgkmcnt(6)
  v_mfma_f32_16x16x32_bf16 v[64:67], v[40:43], a[240:243], v[64:67]
  v_mfma_f32_16x16x32_bf16 v[68:71], v[40:43], a[244:247], v[68:71]
  v_mfma_f32_16x16x32_bf16 v[72:75], v[40:43], a[248:251], v[72:75]
  v_mfma_f32_16x16x32_bf16 v[76:79], v[40:43], a[252:255], v[76:79]
  s_waitcnt vmcnt(16)
  s_waitcnt lgkmcnt(0)
  s_barrier
  v_add_u32 v18, 0, v16
  v_add_u32 v19, 0, v17
  v_add_u32 v22, 0, v20
  v_add_u32 v23, 0, v21
  ds_read_b128 v[192:195], v18 offset:0
  ds_read_b128 v[196:199], v18 offset:128
  ds_read_b128 v[200:203], v19 offset:0
  ds_read_b128 v[204:207], v19 offset:128
  ds_read_b64_tr_b16 v[56:57], v22 offset:0
  ds_read_b64_tr_b16 v[58:59], v22 offset:8448
  v_mfma_f32_16x16x32_bf16 v[144:147], v[40:43], v[36:39], v[144:147]
  s_add_u32 m0, s85, 101376
  s_add_u32 s81, s84, 221184
  v_mfma_f32_16x16x32_bf16 v[80:83], v[44:47], a[240:243], v[80:83]
  ds_read_b64_tr_b16 v[60:61], v22 offset:32
  ds_read_b64_tr_b16 v[62:63], v22 offset:8480
  v_mfma_f32_16x16x32_bf16 v[84:87], v[44:47], a[244:247], v[84:87]
  buffer_load_dwordx4 v12, s[44:47], s81 offen offset:0 lds
  v_mfma_f32_16x16x32_bf16 v[88:91], v[44:47], a[248:251], v[88:91]
  buffer_load_dwordx4 v13, s[44:47], s81 offen offset:1056 lds
  v_mfma_f32_16x16x32_bf16 v[92:95], v[44:47], a[252:255], v[92:95]
  v_mfma_f32_16x16x32_bf16 v[148:151], v[44:47], v[36:39], v[148:151]
  buffer_load_dwordx4 v14, s[44:47], s81 offen offset:2112 lds
  v_mfma_f32_16x16x32_bf16 v[96:99], v[48:51], a[240:243], v[96:99]
  ds_read_b64_tr_b16 v[40:41], v23 offset:0
  ds_read_b64_tr_b16 v[42:43], v23 offset:8448
  v_mfma_f32_16x16x32_bf16 v[100:103], v[48:51], a[244:247], v[100:103]
  buffer_load_dwordx4 v15, s[44:47], s81 offen offset:3168 lds
  v_mfma_f32_16x16x32_bf16 v[104:107], v[48:51], a[248:251], v[104:107]
  s_add_u32 m0, s85, 118288
  s_nop 0
  v_mfma_f32_16x16x32_bf16 v[108:111], v[48:51], a[252:255], v[108:111]
  v_mfma_f32_16x16x32_bf16 v[128:131], v[36:39], a[240:243], v[128:131]
  buffer_load_dwordx4 v12, s[48:51], s81 offen offset:0 lds
  v_mfma_f32_16x16x32_bf16 v[132:135], a[240:243], a[240:243], v[132:135]
  buffer_load_dwordx4 v13, s[48:51], s81 offen offset:1056 lds
  v_mfma_f32_16x16x32_bf16 v[112:115], v[52:55], a[240:243], v[112:115]
  ds_read_b64_tr_b16 v[44:45], v23 offset:32
  ds_read_b64_tr_b16 v[46:47], v23 offset:8480
  v_mfma_f32_16x16x32_bf16 v[116:119], v[52:55], a[244:247], v[116:119]
  buffer_load_dwordx4 v14, s[48:51], s81 offen offset:2112 lds
  v_mfma_f32_16x16x32_bf16 v[120:123], v[52:55], a[248:251], v[120:123]
  buffer_load_dwordx4 v15, s[48:51], s81 offen offset:3168 lds
  v_mfma_f32_16x16x32_bf16 v[124:127], v[52:55], a[252:255], v[124:127]
  v_mfma_f32_16x16x32_bf16 v[136:139], v[36:39], a[244:247], v[136:139]
  v_mfma_f32_16x16x32_bf16 v[140:143], a[244:247], a[244:247], v[140:143]
  s_waitcnt lgkmcnt(8)
  s_waitcnt lgkmcnt(6)
  v_mfma_f32_16x16x32_bf16 v[64:67], v[56:59], v[192:195], v[64:67]
  ds_read_b128 v[208:211], v18 offset:64
  ds_read_b128 v[212:215], v18 offset:192
  ds_read_b128 v[216:219], v19 offset:64
  ds_read_b128 v[220:223], v19 offset:192
  ds_read_b64_tr_b16 v[48:49], v22 offset:512
  ds_read_b64_tr_b16 v[50:51], v22 offset:8960
  v_mfma_f32_16x16x32_bf16 v[68:71], v[56:59], v[196:199], v[68:71]
  v_mfma_f32_16x16x32_bf16 v[72:75], v[56:59], v[200:203], v[72:75]
  v_mfma_f32_16x16x32_bf16 v[76:79], v[56:59], v[204:207], v[76:79]
  v_mfma_f32_16x16x32_bf16 v[144:147], v[56:59], v[36:39], v[144:147]
  s_waitcnt lgkmcnt(10)
  v_mfma_f32_16x16x32_bf16 v[80:83], v[60:63], v[192:195], v[80:83]
  ds_read_b64_tr_b16 v[52:53], v22 offset:544
  ds_read_b64_tr_b16 v[54:55], v22 offset:8992
  v_mfma_f32_16x16x32_bf16 v[84:87], v[60:63], v[196:199], v[84:87]
  v_mfma_f32_16x16x32_bf16 v[88:91], v[60:63], v[200:203], v[88:91]
  v_mfma_f32_16x16x32_bf16 v[92:95], v[60:63], v[204:207], v[92:95]
  v_mfma_f32_16x16x32_bf16 v[148:151], v[60:63], v[36:39], v[148:151]
  s_waitcnt lgkmcnt(10)
  v_mfma_f32_16x16x32_bf16 v[96:99], v[40:43], v[192:195], v[96:99]
  ds_read_b64_tr_b16 v[56:57], v23 offset:512
  ds_read_b64_tr_b16 v[58:59], v23 offset:8960
  v_mfma_f32_16x16x32_bf16 v[100:103], v[40:43], v[196:199], v[100:103]
  v_mfma_f32_16x16x32_bf16 v[104:107], v[40:43], v[200:203], v[104:107]
  v_mfma_f32_16x16x32_bf16 v[108:111], v[40:43], v[204:207], v[108:111]
  v_mfma_f32_16x16x32_bf16 v[128:131], v[36:39], v[192:195], v[128:131]
  v_mfma_f32_16x16x32_bf16 v[132:135], v[192:195], v[192:195], v[132:135]
  s_waitcnt lgkmcnt(10)
  v_mfma_f32_16x16x32_bf16 v[112:115], v[44:47], v[192:195], v[112:115]
  ds_read_b64_tr_b16 v[60:61], v23 offset:544
  ds_read_b64_tr_b16 v[62:63], v23 offset:8992
  v_mfma_f32_16x16x32_bf16 v[116:119], v[44:47], v[196:199], v[116:119]
  v_mfma_f32_16x16x32_bf16 v[120:123], v[44:47], v[200:203], v[120:123]
  v_mfma_f32_16x16x32_bf16 v[124:127], v[44:47], v[204:207], v[124:127]
  v_mfma_f32_16x16x32_bf16 v[136:139], v[36:39], v[196:199], v[136:139]
  v_mfma_f32_16x16x32_bf16 v[140:143], v[196:199], v[196:199], v[140:143]
  s_waitcnt lgkmcnt(8)
  s_waitcnt lgkmcnt(6)
  v_mfma_f32_16x16x32_bf16 v[64:67], v[48:51], v[208:211], v[64:67]
  v_mfma_f32_16x16x32_bf16 v[68:71], v[48:51], v[212:215], v[68:71]
  v_mfma_f32_16x16x32_bf16 v[72:75], v[48:51], v[216:219], v[72:75]
  v_mfma_f32_16x16x32_bf16 v[76:79], v[48:51], v[220:223], v[76:79]
  s_waitcnt vmcnt(16)
  s_waitcnt lgkmcnt(0)
  s_barrier
  v_add_u32 v18, 33792, v16
  v_add_u32 v19, 33792, v17
  v_add_u32 v22, 33792, v20
  v_add_u32 v23, 33792, v21
  ds_read_b128 v[224:227], v18 offset:0
  ds_read_b128 v[228:231], v18 offset:128
  ds_read_b128 v[232:235], v19 offset:0
  ds_read_b128 v[236:239], v19 offset:128
  ds_read_b64_tr_b16 v[40:41], v22 offset:0
  ds_read_b64_tr_b16 v[42:43], v22 offset:8448
  v_mfma_f32_16x16x32_bf16 v[144:147], v[48:51], v[36:39], v[144:147]
  s_add_u32 m0, s85, 0
  s_add_u32 s81, s84, 442368
  v_mfma_f32_16x16x32_bf16 v[80:83], v[52:55], v[208:211], v[80:83]
  ds_read_b64_tr_b16 v[44:45], v22 offset:32
  ds_read_b64_tr_b16 v[46:47], v22 offset:8480
  v_mfma_f32_16x16x32_bf16 v[84:87], v[52:55], v[212:215], v[84:87]
  buffer_load_dwordx4 v12, s[44:47], s81 offen offset:0 lds
  v_mfma_f32_16x16x32_bf16 v[88:91], v[52:55], v[216:219], v[88:91]
  buffer_load_dwordx4 v13, s[44:47], s81 offen offset:1056 lds
  v_mfma_f32_16x16x32_bf16 v[92:95], v[52:55], v[220:223], v[92:95]
  v_mfma_f32_16x16x32_bf16 v[148:151], v[52:55], v[36:39], v[148:151]
  buffer_load_dwordx4 v14, s[44:47], s81 offen offset:2112 lds
  v_mfma_f32_16x16x32_bf16 v[96:99], v[56:59], v[208:211], v[96:99]
  ds_read_b64_tr_b16 v[48:49], v23 offset:0
  ds_read_b64_tr_b16 v[50:51], v23 offset:8448
  v_mfma_f32_16x16x32_bf16 v[100:103], v[56:59], v[212:215], v[100:103]
  buffer_load_dwordx4 v15, s[44:47], s81 offen offset:3168 lds
  v_mfma_f32_16x16x32_bf16 v[104:107], v[56:59], v[216:219], v[104:107]
  s_add_u32 m0, s85, 16912
  s_nop 0
  v_mfma_f32_16x16x32_bf16 v[108:111], v[56:59], v[220:223], v[108:111]
  v_mfma_f32_16x16x32_bf16 v[128:131], v[36:39], v[208:211], v[128:131]
  buffer_load_dwordx4 v12, s[48:51], s81 offen offset:0 lds
  v_mfma_f32_16x16x32_bf16 v[132:135], v[208:211], v[208:211], v[132:135]
  buffer_load_dwordx4 v13, s[48:51], s81 offen offset:1056 lds
  v_mfma_f32_16x16x32_bf16 v[112:115], v[60:63], v[208:211], v[112:115]
  ds_read_b64_tr_b16 v[52:53], v23 offset:32
  ds_read_b64_tr_b16 v[54:55], v23 offset:8480
  v_mfma_f32_16x16x32_bf16 v[116:119], v[60:63], v[212:215], v[116:119]
  buffer_load_dwordx4 v14, s[48:51], s81 offen offset:2112 lds
  v_mfma_f32_16x16x32_bf16 v[120:123], v[60:63], v[216:219], v[120:123]
  buffer_load_dwordx4 v15, s[48:51], s81 offen offset:3168 lds
  v_mfma_f32_16x16x32_bf16 v[124:127], v[60:63], v[220:223], v[124:127]
  v_mfma_f32_16x16x32_bf16 v[136:139], v[36:39], v[212:215], v[136:139]
  v_mfma_f32_16x16x32_bf16 v[140:143], v[212:215], v[212:215], v[140:143]
  s_waitcnt lgkmcnt(8)
  s_waitcnt lgkmcnt(6)
  v_mfma_f32_16x16x32_bf16 v[64:67], v[40:43], v[224:227], v[64:67]
  ds_read_b128 v[240:243], v18 offset:64
  ds_read_b128 v[244:247], v18 offset:192
  ds_read_b128 v[248:251], v19 offset:64
  ds_read_b128 v[252:255], v19 offset:192
  ds_read_b64_tr_b16 v[56:57], v22 offset:512
  ds_read_b64_tr_b16 v[58:59], v22 offset:8960
  v_mfma_f32_16x16x32_bf16 v[68:71], v[40:43], v[228:231], v[68:71]
  v_mfma_f32_16x16x32_bf16 v[72:75], v[40:43], v[232:235], v[72:75]
  v_mfma_f32_16x16x32_bf16 v[76:79], v[40:43], v[236:239], v[76:79]
  v_mfma_f32_16x16x32_bf16 v[144:147], v[40:43], v[36:39], v[144:147]
  s_waitcnt lgkmcnt(10)
  v_mfma_f32_16x16x32_bf16 v[80:83], v[44:47], v[224:227], v[80:83]
  ds_read_b64_tr_b16 v[60:61], v22 offset:544
  ds_read_b64_tr_b16 v[62:63], v22 offset:8992
  v_mfma_f32_16x16x32_bf16 v[84:87], v[44:47], v[228:231], v[84:87]
  v_mfma_f32_16x16x32_bf16 v[88:91], v[44:47], v[232:235], v[88:91]
  v_mfma_f32_16x16x32_bf16 v[92:95], v[44:47], v[236:239], v[92:95]
  v_mfma_f32_16x16x32_bf16 v[148:151], v[44:47], v[36:39], v[148:151]
  s_waitcnt lgkmcnt(10)
  v_mfma_f32_16x16x32_bf16 v[96:99], v[48:51], v[224:227], v[96:99]
  ds_read_b64_tr_b16 v[40:41], v23 offset:512
  ds_read_b64_tr_b16 v[42:43], v23 offset:8960
  v_mfma_f32_16x16x32_bf16 v[100:103], v[48:51], v[228:231], v[100:103]
  v_mfma_f32_16x16x32_bf16 v[104:107], v[48:51], v[232:235], v[104:107]
  v_mfma_f32_16x16x32_bf16 v[108:111], v[48:51], v[236:239], v[108:111]
  v_mfma_f32_16x16x32_bf16 v[128:131], v[36:39], v[224:227], v[128:131]
  v_mfma_f32_16x16x32_bf16 v[132:135], v[224:227], v[224:227], v[132:135]
  s_waitcnt lgkmcnt(10)
  v_mfma_f32_16x16x32_bf16 v[112:115], v[52:55], v[224:227], v[112:115]
  ds_read_b64_tr_b16 v[44:45], v23 offset:544
  ds_read_b64_tr_b16 v[46:47], v23 offset:8992
  v_mfma_f32_16x16x32_bf16 v[116:119], v[52:55], v[228:231], v[116:119]
  v_mfma_f32_16x16x32_bf16 v[120:123], v[52:55], v[232:235], v[120:123]
  v_mfma_f32_16x16x32_bf16 v[124:127], v[52:55], v[236:239], v[124:127]
  v_mfma_f32_16x16x32_bf16 v[136:139], v[36:39], v[228:231], v[136:139]
  v_mfma_f32_16x16x32_bf16 v[140:143], v[228:231], v[228:231], v[140:143]
  s_waitcnt lgkmcnt(8)
  s_waitcnt lgkmcnt(6)
  v_mfma_f32_16x16x32_bf16 v[64:67], v[56:59], v[240:243], v[64:67]
  v_mfma_f32_16x16x32_bf16 v[68:71], v[56:59], v[244:247], v[68:71]
  v_mfma_f32_16x16x32_bf16 v[72:75], v[56:59], v[248:251], v[72:75]
  v_mfma_f32_16x16x32_bf16 v[76:79], v[56:59], v[252:255], v[76:79]
  v_mfma_f32_16x16x32_bf16 v[144:147], v[56:59], v[36:39], v[144:147]
  s_waitcnt lgkmcnt(4)
  v_mfma_f32_16x16x32_bf16 v[80:83], v[60:63], v[240:243], v[80:83]
  v_mfma_f32_16x16x32_bf16 v[84:87], v[60:63], v[244:247], v[84:87]
  v_mfma_f32_16x16x32_bf16 v[88:91], v[60:63], v[248:251], v[88:91]
  v_mfma_f32_16x16x32_bf16 v[92:95], v[60:63], v[252:255], v[92:95]
  v_mfma_f32_16x16x32_bf16 v[148:151], v[60:63], v[36:39], v[148:151]
  s_waitcnt lgkmcnt(2)
  v_mfma_f32_16x16x32_bf16 v[96:99], v[40:43], v[240:243], v[96:99]
  v_mfma_f32_16x16x32_bf16 v[100:103], v[40:43], v[244:247], v[100:103]
  v_mfma_f32_16x16x32_bf16 v[104:107], v[40:43], v[248:251], v[104:107]
  v_mfma_f32_16x16x32_bf16 v[108:111], v[40:43], v[252:255], v[108:111]
  v_mfma_f32_16x16x32_bf16 v[128:131], v[36:39], v[240:243], v[128:131]
  v_mfma_f32_16x16x32_bf16 v[132:135], v[240:243], v[240:243], v[132:135]
  s_waitcnt lgkmcnt(0)
  v_mfma_f32_16x16x32_bf16 v[112:115], v[44:47], v[240:243], v[112:115]
  v_mfma_f32_16x16x32_bf16 v[116:119], v[44:47], v[244:247], v[116:119]
  v_mfma_f32_16x16x32_bf16 v[120:123], v[44:47], v[248:251], v[120:123]
  v_mfma_f32_16x16x32_bf16 v[124:127], v[44:47], v[252:255], v[124:127]
  v_mfma_f32_16x16x32_bf16 v[136:139], v[36:39], v[244:247], v[136:139]
  v_mfma_f32_16x16x32_bf16 v[140:143], v[244:247], v[244:247], v[140:143]
  s_nop 9
  v_cndmask_b32 v132, v132, v133, s[70:71]
  v_cndmask_b32 v132, v132, v134, s[72:73]
  v_cndmask_b32 v132, v132, v135, s[74:75]
  v_mul_f32 v32, 0.0015625, v128
  v_mul_f32 v132, 0.0015625, v132
  v_fma_f32 v132, -v32, v32, v132
  v_add_f32 v132, 0x3727c5ac, v132
  v_rsq_f32 v33, v132
  v_cndmask_b32 v140, v140, v141, s[70:71]
  v_cndmask_b32 v140, v140, v142, s[72:73]
  v_cndmask_b32 v140, v140, v143, s[74:75]
  v_mul_f32 v34, 0.0015625, v136
  v_mul_f32 v140, 0.0015625, v140
  v_fma_f32 v140, -v34, v34, v140
  v_add_f32 v140, 0x3727c5ac, v140
  v_rsq_f32 v35, v140
  s_lshl_b32 s11, s7, 9
  s_lshl_b32 s13, s8, 8
  s_add_u32 s14, s11, s13
  s_add_u32 s14, s14, 135168
  v_lshlrev_b32 v128, 3, v2
  v_add_u32 v129, s14, v128
  s_sub_u32 s14, s11, s13
  s_add_u32 s14, s14, 135424
  v_add_u32 v130, s14, v128
  s_mov_b64 exec, s[76:77]
  ds_write_b64 v129, v[32:33]
  ds_write_b64 v129, v[34:35] offset:128
  s_mov_b64 exec, -1
  s_lshl_b32 s11, s8, 8
  s_lshl_b32 s13, s7, 7
  s_add_u32 s14, s11, s13
  s_add_u32 s14, s14, 136192
  v_lshlrev_b32 v128, 4, v3
  v_add_u32 v131, s14, v128
  s_sub_u32 s14, s11, s13
  s_add_u32 s14, s14, 136320
  v_add_u32 v132, s14, v128
  s_mov_b64 exec, s[78:79]
  ds_write_b128 v131, v[144:147]
  ds_write_b128 v131, v[148:151] offset:64
  s_mov_b64 exec, -1
  s_waitcnt lgkmcnt(0)
  s_barrier
  ds_read_b64 v[136:137], v129 offset:0
  ds_read_b64 v[138:139], v129 offset:128
  ds_read_b64 v[140:141], v130 offset:0
  ds_read_b64 v[142:143], v130 offset:128
  ds_read_b128 v[144:147], v131 offset:0
  ds_read_b128 v[148:151], v131 offset:64
  ds_read_b128 v[152:155], v132 offset:0
  ds_read_b128 v[156:159], v132 offset:64
  s_waitcnt lgkmcnt(0)
  v_mov_b32 v24, v136
  v_mov_b32 v28, v137
  v_mov_b32 v25, v138
  v_mov_b32 v29, v139
  v_mov_b32 v26, v140
  v_mov_b32 v30, v141
  v_mov_b32 v27, v142
  v_mov_b32 v31, v143
  s_cmp_lt_u32 s10, 5
  s_cselect_b32 s11, 0x3ea52b5c, 1.0
  v_mul_f32 v136, s11, v28
  v_mul_f32 v137, s11, v29
  v_mul_f32 v138, s11, v30
  v_mul_f32 v139, s11, v31
  v_lshlrev_b32 v128, 14, v3
  v_lshl_add_u32 v128, v2, 4, v128
  s_lshl_b32 s11, s10, 19
  s_lshl_b32 s12, s8, 18
  s_add_u32 s11, s11, s12
  s_lshl_b32 s12, s9, 10
  s_add_u32 s11, s11, s12
  s_lshl_b32 s12, s7, 9
  s_add_u32 s11, s11, s12
  s_cmp_ge_u32 s10, 15
  s_cselect_b32 s11, 0x40000000, s11
  v_pk_fma_f32 v[64:65], v[144:145], v[24:25], v[64:65] op_sel:[0,0,0] op_sel_hi:[1,0,1] neg_lo:[0,1,0] neg_hi:[0,1,0]
  v_pk_fma_f32 v[66:67], v[146:147], v[24:25], v[66:67] op_sel:[0,0,0] op_sel_hi:[1,0,1] neg_lo:[0,1,0] neg_hi:[0,1,0]
  v_pk_mul_f32 v[64:65], v[64:65], v[136:137] op_sel:[0,0] op_sel_hi:[1,0]
  v_pk_mul_f32 v[66:67], v[66:67], v[136:137] op_sel:[0,0] op_sel_hi:[1,0]
  v_cvt_pk_bf16_f32 v40, v64, v65
  v_cvt_pk_bf16_f32 v41, v66, v67
  v_pk_fma_f32 v[68:69], v[144:145], v[24:25], v[68:69] op_sel:[0,1,0] op_sel_hi:[1,1,1] neg_lo:[0,1,0] neg_hi:[0,1,0]
  v_pk_fma_f32 v[70:71], v[146:147], v[24:25], v[70:71] op_sel:[0,1,0] op_sel_hi:[1,1,1] neg_lo:[0,1,0] neg_hi:[0,1,0]
  v_pk_mul_f32 v[68:69], v[68:69], v[136:137] op_sel:[0,1] op_sel_hi:[1,1]
  v_pk_mul_f32 v[70:71], v[70:71], v[136:137] op_sel:[0,1] op_sel_hi:[1,1]
  v_cvt_pk_bf16_f32 v42, v68, v69
  v_cvt_pk_bf16_f32 v43, v70, v71
  s_lshl_b32 s12, s7, 1
  s_add_u32 s12, s12, 0
  s_and_b32 s12, s12, 3
  s_lshl_b32 s12, s12, 16
  s_add_u32 s13, s8, 0
  s_and_b32 s13, s13, 1
  s_lshl_b32 s13, s13, 8
  s_add_u32 s12, s12, s13
  s_add_u32 s12, s12, s11
  buffer_store_dwordx4 v[40:43], v128, s[52:55], s12 offen sc1
  v_pk_fma_f32 v[72:73], v[144:145], v[26:27], v[72:73] op_sel:[0,0,0] op_sel_hi:[1,0,1] neg_lo:[0,1,0] neg_hi:[0,1,0]
  v_pk_fma_f32 v[74:75], v[146:147], v[26:27], v[74:75] op_sel:[0,0,0] op_sel_hi:[1,0,1] neg_lo:[0,1,0] neg_hi:[0,1,0]
  v_pk_mul_f32 v[72:73], v[72:73], v[138:139] op_sel:[0,0] op_sel_hi:[1,0]
  v_pk_mul_f32 v[74:75], v[74:75], v[138:139] op_sel:[0,0] op_sel_hi:[1,0]
  v_cvt_pk_bf16_f32 v44, v72, v73
  v_cvt_pk_bf16_f32 v45, v74, v75
  v_pk_fma_f32 v[76:77], v[144:145], v[26:27], v[76:77] op_sel:[0,1,0] op_sel_hi:[1,1,1] neg_lo:[0,1,0] neg_hi:[0,1,0]
  v_pk_fma_f32 v[78:79], v[146:147], v[26:27], v[78:79] op_sel:[0,1,0] op_sel_hi:[1,1,1] neg_lo:[0,1,0] neg_hi:[0,1,0]
  v_pk_mul_f32 v[76:77], v[76:77], v[138:139] op_sel:[0,1] op_sel_hi:[1,1]
  v_pk_mul_f32 v[78:79], v[78:79], v[138:139] op_sel:[0,1] op_sel_hi:[1,1]
  v_cvt_pk_bf16_f32 v46, v76, v77
  v_cvt_pk_bf16_f32 v47, v78, v79
  s_lshl_b32 s12, s7, 1
  s_add_u32 s12, s12, 0
  s_and_b32 s12, s12, 3
  s_lshl_b32 s12, s12, 16
  s_add_u32 s13, s8, 1
  s_and_b32 s13, s13, 1
  s_lshl_b32 s13, s13, 8
  s_add_u32 s12, s12, s13
  s_add_u32 s12, s12, s11
  buffer_store_dwordx4 v[44:47], v128, s[52:55], s12 offen sc1
  v_pk_fma_f32 v[80:81], v[148:149], v[24:25], v[80:81] op_sel:[0,0,0] op_sel_hi:[1,0,1] neg_lo:[0,1,0] neg_hi:[0,1,0]
  v_pk_fma_f32 v[82:83], v[150:151], v[24:25], v[82:83] op_sel:[0,0,0] op_sel_hi:[1,0,1] neg_lo:[0,1,0] neg_hi:[0,1,0]
  v_pk_mul_f32 v[80:81], v[80:81], v[136:137] op_sel:[0,0] op_sel_hi:[1,0]
  v_pk_mul_f32 v[82:83], v[82:83], v[136:137] op_sel:[0,0] op_sel_hi:[1,0]
  v_cvt_pk_bf16_f32 v48, v80, v81
  v_cvt_pk_bf16_f32 v49, v82, v83
  v_pk_fma_f32 v[84:85], v[148:149], v[24:25], v[84:85] op_sel:[0,1,0] op_sel_hi:[1,1,1] neg_lo:[0,1,0] neg_hi:[0,1,0]
  v_pk_fma_f32 v[86:87], v[150:151], v[24:25], v[86:87] op_sel:[0,1,0] op_sel_hi:[1,1,1] neg_lo:[0,1,0] neg_hi:[0,1,0]
  v_pk_mul_f32 v[84:85], v[84:85], v[136:137] op_sel:[0,1] op_sel_hi:[1,1]
  v_pk_mul_f32 v[86:87], v[86:87], v[136:137] op_sel:[0,1] op_sel_hi:[1,1]
  v_cvt_pk_bf16_f32 v50, v84, v85
  v_cvt_pk_bf16_f32 v51, v86, v87
  s_lshl_b32 s12, s7, 1
  s_add_u32 s12, s12, 1
  s_and_b32 s12, s12, 3
  s_lshl_b32 s12, s12, 16
  s_add_u32 s13, s8, 0
  s_and_b32 s13, s13, 1
  s_lshl_b32 s13, s13, 8
  s_add_u32 s12, s12, s13
  s_add_u32 s12, s12, s11
  buffer_store_dwordx4 v[48:51], v128, s[52:55], s12 offen sc1
  v_pk_fma_f32 v[88:89], v[148:149], v[26:27], v[88:89] op_sel:[0,0,0] op_sel_hi:[1,0,1] neg_lo:[0,1,0] neg_hi:[0,1,0]
  v_pk_fma_f32 v[90:91], v[150:151], v[26:27], v[90:91] op_sel:[0,0,0] op_sel_hi:[1,0,1] neg_lo:[0,1,0] neg_hi:[0,1,0]
  v_pk_mul_f32 v[88:89], v[88:89], v[138:139] op_sel:[0,0] op_sel_hi:[1,0]
  v_pk_mul_f32 v[90:91], v[90:91], v[138:139] op_sel:[0,0] op_sel_hi:[1,0]
  v_cvt_pk_bf16_f32 v52, v88, v89
  v_cvt_pk_bf16_f32 v53, v90, v91
  v_pk_fma_f32 v[92:93], v[148:149], v[26:27], v[92:93] op_sel:[0,1,0] op_sel_hi:[1,1,1] neg_lo:[0,1,0] neg_hi:[0,1,0]
  v_pk_fma_f32 v[94:95], v[150:151], v[26:27], v[94:95] op_sel:[0,1,0] op_sel_hi:[1,1,1] neg_lo:[0,1,0] neg_hi:[0,1,0]
  v_pk_mul_f32 v[92:93], v[92:93], v[138:139] op_sel:[0,1] op_sel_hi:[1,1]
  v_pk_mul_f32 v[94:95], v[94:95], v[138:139] op_sel:[0,1] op_sel_hi:[1,1]
  v_cvt_pk_bf16_f32 v54, v92, v93
  v_cvt_pk_bf16_f32 v55, v94, v95
  s_lshl_b32 s12, s7, 1
  s_add_u32 s12, s12, 1
  s_and_b32 s12, s12, 3
  s_lshl_b32 s12, s12, 16
  s_add_u32 s13, s8, 1
  s_and_b32 s13, s13, 1
  s_lshl_b32 s13, s13, 8
  s_add_u32 s12, s12, s13
  s_add_u32 s12, s12, s11
  buffer_store_dwordx4 v[52:55], v128, s[52:55], s12 offen sc1
  v_pk_fma_f32 v[96:97], v[152:153], v[24:25], v[96:97] op_sel:[0,0,0] op_sel_hi:[1,0,1] neg_lo:[0,1,0] neg_hi:[0,1,0]
  v_pk_fma_f32 v[98:99], v[154:155], v[24:25], v[98:99] op_sel:[0,0,0] op_sel_hi:[1,0,1] neg_lo:[0,1,0] neg_hi:[0,1,0]
  v_pk_mul_f32 v[96:97], v[96:97], v[136:137] op_sel:[0,0] op_sel_hi:[1,0]
  v_pk_mul_f32 v[98:99], v[98:99], v[136:137] op_sel:[0,0] op_sel_hi:[1,0]
  v_cvt_pk_bf16_f32 v40, v96, v97
  v_cvt_pk_bf16_f32 v41, v98, v99
  v_pk_fma_f32 v[100:101], v[152:153], v[24:25], v[100:101] op_sel:[0,1,0] op_sel_hi:[1,1,1] neg_lo:[0,1,0] neg_hi:[0,1,0]
  v_pk_fma_f32 v[102:103], v[154:155], v[24:25], v[102:103] op_sel:[0,1,0] op_sel_hi:[1,1,1] neg_lo:[0,1,0] neg_hi:[0,1,0]
  v_pk_mul_f32 v[100:101], v[100:101], v[136:137] op_sel:[0,1] op_sel_hi:[1,1]
  v_pk_mul_f32 v[102:103], v[102:103], v[136:137] op_sel:[0,1] op_sel_hi:[1,1]
  v_cvt_pk_bf16_f32 v42, v100, v101
  v_cvt_pk_bf16_f32 v43, v102, v103
  s_lshl_b32 s12, s7, 1
  s_add_u32 s12, s12, 2
  s_and_b32 s12, s12, 3
  s_lshl_b32 s12, s12, 16
  s_add_u32 s13, s8, 0
  s_and_b32 s13, s13, 1
  s_lshl_b32 s13, s13, 8
  s_add_u32 s12, s12, s13
  s_add_u32 s12, s12, s11
  buffer_store_dwordx4 v[40:43], v128, s[52:55], s12 offen sc1
  v_pk_fma_f32 v[104:105], v[152:153], v[26:27], v[104:105] op_sel:[0,0,0] op_sel_hi:[1,0,1] neg_lo:[0,1,0] neg_hi:[0,1,0]
  v_pk_fma_f32 v[106:107], v[154:155], v[26:27], v[106:107] op_sel:[0,0,0] op_sel_hi:[1,0,1] neg_lo:[0,1,0] neg_hi:[0,1,0]
  v_pk_mul_f32 v[104:105], v[104:105], v[138:139] op_sel:[0,0] op_sel_hi:[1,0]
  v_pk_mul_f32 v[106:107], v[106:107], v[138:139] op_sel:[0,0] op_sel_hi:[1,0]
  v_cvt_pk_bf16_f32 v44, v104, v105
  v_cvt_pk_bf16_f32 v45, v106, v107
  v_pk_fma_f32 v[108:109], v[152:153], v[26:27], v[108:109] op_sel:[0,1,0] op_sel_hi:[1,1,1] neg_lo:[0,1,0] neg_hi:[0,1,0]
  v_pk_fma_f32 v[110:111], v[154:155], v[26:27], v[110:111] op_sel:[0,1,0] op_sel_hi:[1,1,1] neg_lo:[0,1,0] neg_hi:[0,1,0]
  v_pk_mul_f32 v[108:109], v[108:109], v[138:139] op_sel:[0,1] op_sel_hi:[1,1]
  v_pk_mul_f32 v[110:111], v[110:111], v[138:139] op_sel:[0,1] op_sel_hi:[1,1]
  v_cvt_pk_bf16_f32 v46, v108, v109
  v_cvt_pk_bf16_f32 v47, v110, v111
  s_lshl_b32 s12, s7, 1
  s_add_u32 s12, s12, 2
  s_and_b32 s12, s12, 3
  s_lshl_b32 s12, s12, 16
  s_add_u32 s13, s8, 1
  s_and_b32 s13, s13, 1
  s_lshl_b32 s13, s13, 8
  s_add_u32 s12, s12, s13
  s_add_u32 s12, s12, s11
  buffer_store_dwordx4 v[44:47], v128, s[52:55], s12 offen sc1
  v_pk_fma_f32 v[112:113], v[156:157], v[24:25], v[112:113] op_sel:[0,0,0] op_sel_hi:[1,0,1] neg_lo:[0,1,0] neg_hi:[0,1,0]
  v_pk_fma_f32 v[114:115], v[158:159], v[24:25], v[114:115] op_sel:[0,0,0] op_sel_hi:[1,0,1] neg_lo:[0,1,0] neg_hi:[0,1,0]
  v_pk_mul_f32 v[112:113], v[112:113], v[136:137] op_sel:[0,0] op_sel_hi:[1,0]
  v_pk_mul_f32 v[114:115], v[114:115], v[136:137] op_sel:[0,0] op_sel_hi:[1,0]
  v_cvt_pk_bf16_f32 v48, v112, v113
  v_cvt_pk_bf16_f32 v49, v114, v115
  v_pk_fma_f32 v[116:117], v[156:157], v[24:25], v[116:117] op_sel:[0,1,0] op_sel_hi:[1,1,1] neg_lo:[0,1,0] neg_hi:[0,1,0]
  v_pk_fma_f32 v[118:119], v[158:159], v[24:25], v[118:119] op_sel:[0,1,0] op_sel_hi:[1,1,1] neg_lo:[0,1,0] neg_hi:[0,1,0]
  v_pk_mul_f32 v[116:117], v[116:117], v[136:137] op_sel:[0,1] op_sel_hi:[1,1]
  v_pk_mul_f32 v[118:119], v[118:119], v[136:137] op_sel:[0,1] op_sel_hi:[1,1]
  v_cvt_pk_bf16_f32 v50, v116, v117
  v_cvt_pk_bf16_f32 v51, v118, v119
  s_lshl_b32 s12, s7, 1
  s_add_u32 s12, s12, 3
  s_and_b32 s12, s12, 3
  s_lshl_b32 s12, s12, 16
  s_add_u32 s13, s8, 0
  s_and_b32 s13, s13, 1
  s_lshl_b32 s13, s13, 8
  s_add_u32 s12, s12, s13
  s_add_u32 s12, s12, s11
  buffer_store_dwordx4 v[48:51], v128, s[52:55], s12 offen sc1
  v_pk_fma_f32 v[120:121], v[156:157], v[26:27], v[120:121] op_sel:[0,0,0] op_sel_hi:[1,0,1] neg_lo:[0,1,0] neg_hi:[0,1,0]
  v_pk_fma_f32 v[122:123], v[158:159], v[26:27], v[122:123] op_sel:[0,0,0] op_sel_hi:[1,0,1] neg_lo:[0,1,0] neg_hi:[0,1,0]
  v_pk_mul_f32 v[120:121], v[120:121], v[138:139] op_sel:[0,0] op_sel_hi:[1,0]
  v_pk_mul_f32 v[122:123], v[122:123], v[138:139] op_sel:[0,0] op_sel_hi:[1,0]
  v_cvt_pk_bf16_f32 v52, v120, v121
  v_cvt_pk_bf16_f32 v53, v122, v123
  v_pk_fma_f32 v[124:125], v[156:157], v[26:27], v[124:125] op_sel:[0,1,0] op_sel_hi:[1,1,1] neg_lo:[0,1,0] neg_hi:[0,1,0]
  v_pk_fma_f32 v[126:127], v[158:159], v[26:27], v[126:127] op_sel:[0,1,0] op_sel_hi:[1,1,1] neg_lo:[0,1,0] neg_hi:[0,1,0]
  v_pk_mul_f32 v[124:125], v[124:125], v[138:139] op_sel:[0,1] op_sel_hi:[1,1]
  v_pk_mul_f32 v[126:127], v[126:127], v[138:139] op_sel:[0,1] op_sel_hi:[1,1]
  v_cvt_pk_bf16_f32 v54, v124, v125
  v_cvt_pk_bf16_f32 v55, v126, v127
  s_lshl_b32 s12, s7, 1
  s_add_u32 s12, s12, 3
  s_and_b32 s12, s12, 3
  s_lshl_b32 s12, s12, 16
  s_add_u32 s13, s8, 1
  s_and_b32 s13, s13, 1
  s_lshl_b32 s13, s13, 8
  s_add_u32 s12, s12, s13
  s_add_u32 s12, s12, s11
  buffer_store_dwordx4 v[52:55], v128, s[52:55], s12 offen sc1
  s_cmp_lt_u32 s6, 2
  s_cbranch_scc1 rpf_10
  v_lshrrev_b32 v32, 2, v2
  v_lshl_add_u32 v32, v3, 3, v32
  v_lshlrev_b32 v32, 7, v32
  v_and_b32 v33, 3, v2
  v_lshl_add_u32 v32, v33, 3, v32
  s_lshl_b32 s12, s6, 13
  s_add_u32 s12, s12, 126976
  v_add_u32 v32, s12, v32
  ds_read_b64_tr_b16 v[40:41], v32 offset:0
  ds_read_b64_tr_b16 v[42:43], v32 offset:512
  ds_read_b64_tr_b16 v[44:45], v32 offset:32
  ds_read_b64_tr_b16 v[46:47], v32 offset:544
  ds_read_b64_tr_b16 v[48:49], v32 offset:64
  ds_read_b64_tr_b16 v[50:51], v32 offset:576
  ds_read_b64_tr_b16 v[52:53], v32 offset:96
  ds_read_b64_tr_b16 v[54:55], v32 offset:608
  v_lshlrev_b32 v33, 4, v1
  s_waitcnt lgkmcnt(0)
  buffer_store_dwordx4 v[40:43], v33, s[52:55], s96 offen offset:0 sc1
  buffer_store_dwordx4 v[44:47], v33, s[52:55], s96 offen offset:1024 sc1
  buffer_store_dwordx4 v[48:51], v33, s[52:55], s96 offen offset:2048 sc1
  buffer_store_dwordx4 v[52:55], v33, s[52:55], s96 offen offset:3072 sc1
  v_lshrrev_b32 v32, 2, v2
  v_lshl_add_u32 v32, v3, 3, v32
  v_lshlrev_b32 v32, 7, v32
  v_and_b32 v33, 3, v2
  v_lshl_add_u32 v32, v33, 3, v32
  s_lshl_b32 s12, s6, 13
  s_add_u32 s12, s12, 131072
  v_add_u32 v32, s12, v32
  ds_read_b64_tr_b16 v[40:41], v32 offset:0
  ds_read_b64_tr_b16 v[42:43], v32 offset:512
  ds_read_b64_tr_b16 v[44:45], v32 offset:32
  ds_read_b64_tr_b16 v[46:47], v32 offset:544
  ds_read_b64_tr_b16 v[48:49], v32 offset:64
  ds_read_b64_tr_b16 v[50:51], v32 offset:576
  ds_read_b64_tr_b16 v[52:53], v32 offset:96
  ds_read_b64_tr_b16 v[54:55], v32 offset:608
  v_lshlrev_b32 v33, 4, v1
  s_waitcnt lgkmcnt(0)
  buffer_store_dwordx4 v[40:43], v33, s[52:55], s97 offen offset:0 sc1
  buffer_store_dwordx4 v[44:47], v33, s[52:55], s97 offen offset:1024 sc1
  buffer_store_dwordx4 v[48:51], v33, s[52:55], s97 offen offset:2048 sc1
  buffer_store_dwordx4 v[52:55], v33, s[52:55], s97 offen offset:3072 sc1
rpf_10:
  s_waitcnt vmcnt(24)
  s_waitcnt lgkmcnt(0)
  s_barrier
  s_movk_i32 s12, 1056
  v_lshrrev_b32 v32, 2, v2
  v_and_b32 v33, 1, v3
  v_lshl_add_u32 v32, v33, 2, v32
  v_mul_lo_u32 v32, v32, s12
  v_lshrrev_b32 v33, 1, v3
  v_lshl_add_u32 v32, v33, 8, v32
  v_and_b32 v33, 1, v2
  v_lshl_add_u32 v32, v33, 3, v32
  v_bfe_u32 v33, v2, 1, 1
  s_movk_i32 s12, 16912
  v_mad_u32_u24 v32, v33, s12, v32
  s_mul_i32 s11, s8, 112
  s_mul_i32 s13, s7, 48
  s_add_u32 s14, s11, s13
  v_add_u32 v20, s14, v32
  s_lshl_b32 s13, s7, 6
  s_sub_u32 s14, s11, s13
  s_add_u32 s14, s14, 64
  v_add_u32 v21, s14, v32
  v_add_u32 v22, 67584, v20
  v_add_u32 v23, 67584, v21
  v_mov_b32 v4, 0
  buffer_load_dword v5, v4, s[28:31], 0 offen sc1
  ds_read_b64_tr_b16 v[48:49], v22 offset:0
  ds_read_b64_tr_b16 v[50:51], v22 offset:8448
  s_waitcnt lgkmcnt(0)
  v_mfma_f32_16x16x32_bf16 v[64:67], v[48:51], a[0:3], 0
  ds_read_b64_tr_b16 v[52:53], v22 offset:16
  ds_read_b64_tr_b16 v[54:55], v22 offset:8464
  ds_read_b64_tr_b16 v[56:57], v22 offset:32
  ds_read_b64_tr_b16 v[58:59], v22 offset:8480
  ds_read_b64_tr_b16 v[60:61], v22 offset:48
  ds_read_b64_tr_b16 v[62:63], v22 offset:8496
  ds_read_b64_tr_b16 v[40:41], v23 offset:0
  ds_read_b64_tr_b16 v[42:43], v23 offset:8448
  v_mfma_f32_16x16x32_bf16 v[68:71], v[48:51], a[4:7], 0
  s_add_u32 m0, s85, 33792
  s_add_u32 s81, s84, 663552
  v_mfma_f32_16x16x32_bf16 v[72:75], v[48:51], a[8:11], 0
  buffer_load_dwordx4 v12, s[44:47], s81 offen offset:0 lds
  v_mfma_f32_16x16x32_bf16 v[76:79], v[48:51], a[12:15], 0
  v_mfma_f32_16x16x32_bf16 v[176:179], v[48:51], v[36:39], 0
  buffer_load_dwordx4 v13, s[44:47], s81 offen offset:1056 lds
  s_waitcnt lgkmcnt(6)
  v_mfma_f32_16x16x32_bf16 v[80:83], v[52:55], a[0:3], 0
  ds_read_b64_tr_b16 v[44:45], v23 offset:16
  ds_read_b64_tr_b16 v[46:47], v23 offset:8464
  v_mfma_f32_16x16x32_bf16 v[84:87], v[52:55], a[4:7], 0
  buffer_load_dwordx4 v14, s[44:47], s81 offen offset:2112 lds
  v_mfma_f32_16x16x32_bf16 v[88:91], v[52:55], a[8:11], 0
  buffer_load_dwordx4 v15, s[44:47], s81 offen offset:3168 lds
  v_mfma_f32_16x16x32_bf16 v[92:95], v[52:55], a[12:15], 0
  v_mfma_f32_16x16x32_bf16 v[180:183], v[52:55], v[36:39], 0
  s_add_u32 m0, s85, 50704
  s_nop 0
  s_waitcnt lgkmcnt(6)
  v_mfma_f32_16x16x32_bf16 v[96:99], v[56:59], a[0:3], 0
  ds_read_b64_tr_b16 v[48:49], v23 offset:32
  ds_read_b64_tr_b16 v[50:51], v23 offset:8480
  v_mfma_f32_16x16x32_bf16 v[100:103], v[56:59], a[4:7], 0
  buffer_load_dwordx4 v12, s[48:51], s81 offen offset:0 lds
  v_mfma_f32_16x16x32_bf16 v[104:107], v[56:59], a[8:11], 0
  buffer_load_dwordx4 v13, s[48:51], s81 offen offset:1056 lds
  v_mfma_f32_16x16x32_bf16 v[108:111], v[56:59], a[12:15], 0
  v_mfma_f32_16x16x32_bf16 v[184:187], v[56:59], v[36:39], 0
  buffer_load_dwordx4 v14, s[48:51], s81 offen offset:2112 lds
  s_waitcnt lgkmcnt(6)
  v_mfma_f32_16x16x32_bf16 v[112:115], v[60:63], a[0:3], 0
  ds_read_b64_tr_b16 v[52:53], v22 offset:512
  ds_read_b64_tr_b16 v[54:55], v22 offset:8960
  v_mfma_f32_16x16x32_bf16 v[116:119], v[60:63], a[4:7], 0
  buffer_load_dwordx4 v15, s[48:51], s81 offen offset:3168 lds
  v_mfma_f32_16x16x32_bf16 v[120:123], v[60:63], a[8:11], 0
  v_mfma_f32_16x16x32_bf16 v[124:127], v[60:63], a[12:15], 0
  v_mfma_f32_16x16x32_bf16 v[188:191], v[60:63], v[36:39], 0
  s_waitcnt lgkmcnt(6)
  v_mfma_f32_16x16x32_bf16 v[128:131], v[40:43], a[0:3], 0
  ds_read_b64_tr_b16 v[56:57], v22 offset:528
  ds_read_b64_tr_b16 v[58:59], v22 offset:8976
  v_mfma_f32_16x16x32_bf16 v[132:135], v[40:43], a[4:7], 0
  v_mfma_f32_16x16x32_bf16 v[136:139], v[40:43], a[8:11], 0
  v_mfma_f32_16x16x32_bf16 v[140:143], v[40:43], a[12:15], 0
  s_waitcnt lgkmcnt(6)
  v_mfma_f32_16x16x32_bf16 v[144:147], v[44:47], a[0:3], 0
  ds_read_b64_tr_b16 v[60:61], v22 offset:544
  ds_read_b64_tr_b16 v[62:63], v22 offset:8992
  v_mfma_f32_16x16x32_bf16 v[148:151], v[44:47], a[4:7], 0
  v_mfma_f32_16x16x32_bf16 v[152:155], v[44:47], a[8:11], 0
  v_mfma_f32_16x16x32_bf16 v[156:159], v[44:47], a[12:15], 0
  s_waitcnt lgkmcnt(6)
  v_mfma_f32_16x16x32_bf16 v[160:163], v[48:51], a[0:3], 0
  ds_read_b64_tr_b16 v[40:41], v22 offset:560
  ds_read_b64_tr_b16 v[42:43], v22 offset:9008
  v_mfma_f32_16x16x32_bf16 v[164:167], v[48:51], a[4:7], 0
  v_mfma_f32_16x16x32_bf16 v[168:171], v[48:51], a[8:11], 0
  v_mfma_f32_16x16x32_bf16 v[172:175], v[48:51], a[12:15], 0
  s_waitcnt lgkmcnt(6)
  v_mfma_f32_16x16x32_bf16 v[64:67], v[52:55], a[16:19], v[64:67]
  ds_read_b64_tr_b16 v[44:45], v23 offset:512
  ds_read_b64_tr_b16 v[46:47], v23 offset:8960
  v_mfma_f32_16x16x32_bf16 v[68:71], v[52:55], a[20:23], v[68:71]
  v_mfma_f32_16x16x32_bf16 v[72:75], v[52:55], a[24:27], v[72:75]
  v_mfma_f32_16x16x32_bf16 v[76:79], v[52:55], a[28:31], v[76:79]
  v_mfma_f32_16x16x32_bf16 v[176:179], v[52:55], v[36:39], v[176:179]
  s_waitcnt lgkmcnt(6)
  v_mfma_f32_16x16x32_bf16 v[80:83], v[56:59], a[16:19], v[80:83]
  ds_read_b64_tr_b16 v[48:49], v23 offset:528
  ds_read_b64_tr_b16 v[50:51], v23 offset:8976
  v_mfma_f32_16x16x32_bf16 v[84:87], v[56:59], a[20:23], v[84:87]
  v_mfma_f32_16x16x32_bf16 v[88:91], v[56:59], a[24:27], v[88:91]
  v_mfma_f32_16x16x32_bf16 v[92:95], v[56:59], a[28:31], v[92:95]
  v_mfma_f32_16x16x32_bf16 v[180:183], v[56:59], v[36:39], v[180:183]
  s_waitcnt lgkmcnt(6)
  v_mfma_f32_16x16x32_bf16 v[96:99], v[60:63], a[16:19], v[96:99]
  ds_read_b64_tr_b16 v[52:53], v23 offset:544
  ds_read_b64_tr_b16 v[54:55], v23 offset:8992
  v_mfma_f32_16x16x32_bf16 v[100:103], v[60:63], a[20:23], v[100:103]
  v_mfma_f32_16x16x32_bf16 v[104:107], v[60:63], a[24:27], v[104:107]
  v_mfma_f32_16x16x32_bf16 v[108:111], v[60:63], a[28:31], v[108:111]
  v_mfma_f32_16x16x32_bf16 v[184:187], v[60:63], v[36:39], v[184:187]
  s_waitcnt lgkmcnt(6)
  v_mfma_f32_16x16x32_bf16 v[112:115], v[40:43], a[16:19], v[112:115]
  v_mfma_f32_16x16x32_bf16 v[116:119], v[40:43], a[20:23], v[116:119]
  v_mfma_f32_16x16x32_bf16 v[120:123], v[40:43], a[24:27], v[120:123]
  v_mfma_f32_16x16x32_bf16 v[124:127], v[40:43], a[28:31], v[124:127]
  s_waitcnt vmcnt(25)
  s_waitcnt lgkmcnt(0)
  s_barrier
  v_add_u32 v22, 101376, v20
  v_add_u32 v23, 101376, v21
  ds_read_b64_tr_b16 v[56:57], v22 offset:0
  ds_read_b64_tr_b16 v[58:59], v22 offset:8448
  v_mfma_f32_16x16x32_bf16 v[188:191], v[40:43], v[36:39], v[188:191]
  s_add_u32 m0, s85, 67584
  s_add_u32 s81, s84, 884736
  v_mfma_f32_16x16x32_bf16 v[128:131], v[44:47], a[16:19], v[128:131]
  ds_read_b64_tr_b16 v[60:61], v22 offset:16
  ds_read_b64_tr_b16 v[62:63], v22 offset:8464
  v_mfma_f32_16x16x32_bf16 v[132:135], v[44:47], a[20:23], v[132:135]
  buffer_load_dwordx4 v12, s[44:47], s81 offen offset:0 lds
  v_mfma_f32_16x16x32_bf16 v[136:139], v[44:47], a[24:27], v[136:139]
  buffer_load_dwordx4 v13, s[44:47], s81 offen offset:1056 lds
  v_mfma_f32_16x16x32_bf16 v[140:143], v[44:47], a[28:31], v[140:143]
  v_mfma_f32_16x16x32_bf16 v[144:147], v[48:51], a[16:19], v[144:147]
  ds_read_b64_tr_b16 v[40:41], v22 offset:32
  ds_read_b64_tr_b16 v[42:43], v22 offset:8480
  v_mfma_f32_16x16x32_bf16 v[148:151], v[48:51], a[20:23], v[148:151]
  buffer_load_dwordx4 v14, s[44:47], s81 offen offset:2112 lds
  v_mfma_f32_16x16x32_bf16 v[152:155], v[48:51], a[24:27], v[152:155]
  buffer_load_dwordx4 v15, s[44:47], s81 offen offset:3168 lds
  v_mfma_f32_16x16x32_bf16 v[156:159], v[48:51], a[28:31], v[156:159]
  v_mfma_f32_16x16x32_bf16 v[160:163], v[52:55], a[16:19], v[160:163]
  ds_read_b64_tr_b16 v[44:45], v22 offset:48
  ds_read_b64_tr_b16 v[46:47], v22 offset:8496
  v_mfma_f32_16x16x32_bf16 v[164:167], v[52:55], a[20:23], v[164:167]
  s_add_u32 m0, s85, 84496
  s_nop 0
  buffer_load_dwordx4 v12, s[48:51], s81 offen offset:0 lds
  v_mfma_f32_16x16x32_bf16 v[168:171], v[52:55], a[24:27], v[168:171]
  buffer_load_dwordx4 v13, s[48:51], s81 offen offset:1056 lds
  v_mfma_f32_16x16x32_bf16 v[172:175], v[52:55], a[28:31], v[172:175]
  s_waitcnt lgkmcnt(6)
  v_mfma_f32_16x16x32_bf16 v[64:67], v[56:59], a[32:35], v[64:67]
  ds_read_b64_tr_b16 v[48:49], v23 offset:0
  ds_read_b64_tr_b16 v[50:51], v23 offset:8448
  v_mfma_f32_16x16x32_bf16 v[68:71], v[56:59], a[36:39], v[68:71]
  buffer_load_dwordx4 v14, s[48:51], s81 offen offset:2112 lds
  v_mfma_f32_16x16x32_bf16 v[72:75], v[56:59], a[40:43], v[72:75]
  buffer_load_dwordx4 v15, s[48:51], s81 offen offset:3168 lds
  v_mfma_f32_16x16x32_bf16 v[76:79], v[56:59], a[44:47], v[76:79]
  v_mfma_f32_16x16x32_bf16 v[176:179], v[56:59], v[36:39], v[176:179]
  s_waitcnt lgkmcnt(6)
  v_mfma_f32_16x16x32_bf16 v[80:83], v[60:63], a[32:35], v[80:83]
  ds_read_b64_tr_b16 v[52:53], v23 offset:16
  ds_read_b64_tr_b16 v[54:55], v23 offset:8464
  v_mfma_f32_16x16x32_bf16 v[84:87], v[60:63], a[36:39], v[84:87]
  v_mfma_f32_16x16x32_bf16 v[88:91], v[60:63], a[40:43], v[88:91]
  v_mfma_f32_16x16x32_bf16 v[92:95], v[60:63], a[44:47], v[92:95]
  v_mfma_f32_16x16x32_bf16 v[180:183], v[60:63], v[36:39], v[180:183]
  s_waitcnt lgkmcnt(6)
  v_mfma_f32_16x16x32_bf16 v[96:99], v[40:43], a[32:35], v[96:99]
  ds_read_b64_tr_b16 v[56:57], v23 offset:32
  ds_read_b64_tr_b16 v[58:59], v23 offset:8480
  v_mfma_f32_16x16x32_bf16 v[100:103], v[40:43], a[36:39], v[100:103]
  v_mfma_f32_16x16x32_bf16 v[104:107], v[40:43], a[40:43], v[104:107]
  v_mfma_f32_16x16x32_bf16 v[108:111], v[40:43], a[44:47], v[108:111]
  v_mfma_f32_16x16x32_bf16 v[184:187], v[40:43], v[36:39], v[184:187]
  s_waitcnt lgkmcnt(6)
  v_mfma_f32_16x16x32_bf16 v[112:115], v[44:47], a[32:35], v[112:115]
  ds_read_b64_tr_b16 v[60:61], v22 offset:512
  ds_read_b64_tr_b16 v[62:63], v22 offset:8960
  v_mfma_f32_16x16x32_bf16 v[116:119], v[44:47], a[36:39], v[116:119]
  v_mfma_f32_16x16x32_bf16 v[120:123], v[44:47], a[40:43], v[120:123]
  v_mfma_f32_16x16x32_bf16 v[124:127], v[44:47], a[44:47], v[124:127]
  v_mfma_f32_16x16x32_bf16 v[188:191], v[44:47], v[36:39], v[188:191]
  s_waitcnt lgkmcnt(6)
  v_mfma_f32_16x16x32_bf16 v[128:131], v[48:51], a[32:35], v[128:131]
  ds_read_b64_tr_b16 v[40:41], v22 offset:528
  ds_read_b64_tr_b16 v[42:43], v22 offset:8976
  v_mfma_f32_16x16x32_bf16 v[132:135], v[48:51], a[36:39], v[132:135]
  v_mfma_f32_16x16x32_bf16 v[136:139], v[48:51], a[40:43], v[136:139]
  v_mfma_f32_16x16x32_bf16 v[140:143], v[48:51], a[44:47], v[140:143]
  s_waitcnt lgkmcnt(6)
  v_mfma_f32_16x16x32_bf16 v[144:147], v[52:55], a[32:35], v[144:147]
  ds_read_b64_tr_b16 v[44:45], v22 offset:544
  ds_read_b64_tr_b16 v[46:47], v22 offset:8992
  v_mfma_f32_16x16x32_bf16 v[148:151], v[52:55], a[36:39], v[148:151]
  v_mfma_f32_16x16x32_bf16 v[152:155], v[52:55], a[40:43], v[152:155]
  v_mfma_f32_16x16x32_bf16 v[156:159], v[52:55], a[44:47], v[156:159]
  s_waitcnt lgkmcnt(6)
  v_mfma_f32_16x16x32_bf16 v[160:163], v[56:59], a[32:35], v[160:163]
  ds_read_b64_tr_b16 v[48:49], v22 offset:560
  ds_read_b64_tr_b16 v[50:51], v22 offset:9008
  v_mfma_f32_16x16x32_bf16 v[164:167], v[56:59], a[36:39], v[164:167]
  v_mfma_f32_16x16x32_bf16 v[168:171], v[56:59], a[40:43], v[168:171]
  v_mfma_f32_16x16x32_bf16 v[172:175], v[56:59], a[44:47], v[172:175]
  s_waitcnt lgkmcnt(6)
  v_mfma_f32_16x16x32_bf16 v[64:67], v[60:63], a[48:51], v[64:67]
  ds_read_b64_tr_b16 v[52:53], v23 offset:512
  ds_read_b64_tr_b16 v[54:55], v23 offset:8960
  v_mfma_f32_16x16x32_bf16 v[68:71], v[60:63], a[52:55], v[68:71]
  v_mfma_f32_16x16x32_bf16 v[72:75], v[60:63], a[56:59], v[72:75]
  v_mfma_f32_16x16x32_bf16 v[76:79], v[60:63], a[60:63], v[76:79]
  v_mfma_f32_16x16x32_bf16 v[176:179], v[60:63], v[36:39], v[176:179]
  s_waitcnt lgkmcnt(6)
  v_mfma_f32_16x16x32_bf16 v[80:83], v[40:43], a[48:51], v[80:83]
  ds_read_b64_tr_b16 v[56:57], v23 offset:528
  ds_read_b64_tr_b16 v[58:59], v23 offset:8976
  v_mfma_f32_16x16x32_bf16 v[84:87], v[40:43], a[52:55], v[84:87]
  v_mfma_f32_16x16x32_bf16 v[88:91], v[40:43], a[56:59], v[88:91]
  v_mfma_f32_16x16x32_bf16 v[92:95], v[40:43], a[60:63], v[92:95]
  v_mfma_f32_16x16x32_bf16 v[180:183], v[40:43], v[36:39], v[180:183]
  s_waitcnt lgkmcnt(6)
  v_mfma_f32_16x16x32_bf16 v[96:99], v[44:47], a[48:51], v[96:99]
  ds_read_b64_tr_b16 v[60:61], v23 offset:544
  ds_read_b64_tr_b16 v[62:63], v23 offset:8992
  v_mfma_f32_16x16x32_bf16 v[100:103], v[44:47], a[52:55], v[100:103]
  v_mfma_f32_16x16x32_bf16 v[104:107], v[44:47], a[56:59], v[104:107]
  v_mfma_f32_16x16x32_bf16 v[108:111], v[44:47], a[60:63], v[108:111]
  v_mfma_f32_16x16x32_bf16 v[184:187], v[44:47], v[36:39], v[184:187]
  s_waitcnt lgkmcnt(6)
  v_mfma_f32_16x16x32_bf16 v[112:115], v[48:51], a[48:51], v[112:115]
  v_mfma_f32_16x16x32_bf16 v[116:119], v[48:51], a[52:55], v[116:119]
  v_mfma_f32_16x16x32_bf16 v[120:123], v[48:51], a[56:59], v[120:123]
  v_mfma_f32_16x16x32_bf16 v[124:127], v[48:51], a[60:63], v[124:127]
  s_waitcnt vmcnt(25)
  s_waitcnt lgkmcnt(0)
  s_barrier
  v_add_u32 v22, 0, v20
  v_add_u32 v23, 0, v21
  ds_read_b64_tr_b16 v[40:41], v22 offset:0
  ds_read_b64_tr_b16 v[42:43], v22 offset:8448
  v_mfma_f32_16x16x32_bf16 v[188:191], v[48:51], v[36:39], v[188:191]
  s_add_u32 m0, s85, 101376
  s_add_u32 s81, s84, 1105920
  v_mfma_f32_16x16x32_bf16 v[128:131], v[52:55], a[48:51], v[128:131]
  ds_read_b64_tr_b16 v[44:45], v22 offset:16
  ds_read_b64_tr_b16 v[46:47], v22 offset:8464
  v_mfma_f32_16x16x32_bf16 v[132:135], v[52:55], a[52:55], v[132:135]
  buffer_load_dwordx4 v12, s[44:47], s81 offen offset:0 lds
  v_mfma_f32_16x16x32_bf16 v[136:139], v[52:55], a[56:59], v[136:139]
  buffer_load_dwordx4 v13, s[44:47], s81 offen offset:1056 lds
  v_mfma_f32_16x16x32_bf16 v[140:143], v[52:55], a[60:63], v[140:143]
  v_mfma_f32_16x16x32_bf16 v[144:147], v[56:59], a[48:51], v[144:147]
  ds_read_b64_tr_b16 v[48:49], v22 offset:32
  ds_read_b64_tr_b16 v[50:51], v22 offset:8480
  v_mfma_f32_16x16x32_bf16 v[148:151], v[56:59], a[52:55], v[148:151]
  buffer_load_dwordx4 v14, s[44:47], s81 offen offset:2112 lds
  v_mfma_f32_16x16x32_bf16 v[152:155], v[56:59], a[56:59], v[152:155]
  buffer_load_dwordx4 v15, s[44:47], s81 offen offset:3168 lds
  v_mfma_f32_16x16x32_bf16 v[156:159], v[56:59], a[60:63], v[156:159]
  v_mfma_f32_16x16x32_bf16 v[160:163], v[60:63], a[48:51], v[160:163]
  ds_read_b64_tr_b16 v[52:53], v22 offset:48
  ds_read_b64_tr_b16 v[54:55], v22 offset:8496
  v_mfma_f32_16x16x32_bf16 v[164:167], v[60:63], a[52:55], v[164:167]
  s_add_u32 m0, s85, 118288
  s_nop 0
  buffer_load_dwordx4 v12, s[48:51], s81 offen offset:0 lds
  v_mfma_f32_16x16x32_bf16 v[168:171], v[60:63], a[56:59], v[168:171]
  buffer_load_dwordx4 v13, s[48:51], s81 offen offset:1056 lds
  v_mfma_f32_16x16x32_bf16 v[172:175], v[60:63], a[60:63], v[172:175]
  s_waitcnt lgkmcnt(6)
  v_mfma_f32_16x16x32_bf16 v[64:67], v[40:43], a[64:67], v[64:67]
  ds_read_b64_tr_b16 v[56:57], v23 offset:0
  ds_read_b64_tr_b16 v[58:59], v23 offset:8448
  v_mfma_f32_16x16x32_bf16 v[68:71], v[40:43], a[68:71], v[68:71]
  buffer_load_dwordx4 v14, s[48:51], s81 offen offset:2112 lds
  v_mfma_f32_16x16x32_bf16 v[72:75], v[40:43], a[72:75], v[72:75]
  buffer_load_dwordx4 v15, s[48:51], s81 offen offset:3168 lds
  v_mfma_f32_16x16x32_bf16 v[76:79], v[40:43], a[76:79], v[76:79]
  v_mfma_f32_16x16x32_bf16 v[176:179], v[40:43], v[36:39], v[176:179]
  s_waitcnt lgkmcnt(6)
  v_mfma_f32_16x16x32_bf16 v[80:83], v[44:47], a[64:67], v[80:83]
  ds_read_b64_tr_b16 v[60:61], v23 offset:16
  ds_read_b64_tr_b16 v[62:63], v23 offset:8464
  v_mfma_f32_16x16x32_bf16 v[84:87], v[44:47], a[68:71], v[84:87]
  v_mfma_f32_16x16x32_bf16 v[88:91], v[44:47], a[72:75], v[88:91]
  v_mfma_f32_16x16x32_bf16 v[92:95], v[44:47], a[76:79], v[92:95]
  v_mfma_f32_16x16x32_bf16 v[180:183], v[44:47], v[36:39], v[180:183]
  s_waitcnt lgkmcnt(6)
  v_mfma_f32_16x16x32_bf16 v[96:99], v[48:51], a[64:67], v[96:99]
  ds_read_b64_tr_b16 v[40:41], v23 offset:32
  ds_read_b64_tr_b16 v[42:43], v23 offset:8480
  v_mfma_f32_16x16x32_bf16 v[100:103], v[48:51], a[68:71], v[100:103]
  v_mfma_f32_16x16x32_bf16 v[104:107], v[48:51], a[72:75], v[104:107]
  v_mfma_f32_16x16x32_bf16 v[108:111], v[48:51], a[76:79], v[108:111]
  v_mfma_f32_16x16x32_bf16 v[184:187], v[48:51], v[36:39], v[184:187]
  s_waitcnt lgkmcnt(6)
  v_mfma_f32_16x16x32_bf16 v[112:115], v[52:55], a[64:67], v[112:115]
  ds_read_b64_tr_b16 v[44:45], v22 offset:512
  ds_read_b64_tr_b16 v[46:47], v22 offset:8960
  v_mfma_f32_16x16x32_bf16 v[116:119], v[52:55], a[68:71], v[116:119]
  v_mfma_f32_16x16x32_bf16 v[120:123], v[52:55], a[72:75], v[120:123]
  v_mfma_f32_16x16x32_bf16 v[124:127], v[52:55], a[76:79], v[124:127]
  v_mfma_f32_16x16x32_bf16 v[188:191], v[52:55], v[36:39], v[188:191]
  s_waitcnt lgkmcnt(6)
  v_mfma_f32_16x16x32_bf16 v[128:131], v[56:59], a[64:67], v[128:131]
  ds_read_b64_tr_b16 v[48:49], v22 offset:528
  ds_read_b64_tr_b16 v[50:51], v22 offset:8976
  v_mfma_f32_16x16x32_bf16 v[132:135], v[56:59], a[68:71], v[132:135]
  v_mfma_f32_16x16x32_bf16 v[136:139], v[56:59], a[72:75], v[136:139]
  v_mfma_f32_16x16x32_bf16 v[140:143], v[56:59], a[76:79], v[140:143]
  s_waitcnt lgkmcnt(6)
  v_mfma_f32_16x16x32_bf16 v[144:147], v[60:63], a[64:67], v[144:147]
  ds_read_b64_tr_b16 v[52:53], v22 offset:544
  ds_read_b64_tr_b16 v[54:55], v22 offset:8992
  v_mfma_f32_16x16x32_bf16 v[148:151], v[60:63], a[68:71], v[148:151]
  v_mfma_f32_16x16x32_bf16 v[152:155], v[60:63], a[72:75], v[152:155]
  v_mfma_f32_16x16x32_bf16 v[156:159], v[60:63], a[76:79], v[156:159]
  s_waitcnt lgkmcnt(6)
  v_mfma_f32_16x16x32_bf16 v[160:163], v[40:43], a[64:67], v[160:163]
  ds_read_b64_tr_b16 v[56:57], v22 offset:560
  ds_read_b64_tr_b16 v[58:59], v22 offset:9008
  v_mfma_f32_16x16x32_bf16 v[164:167], v[40:43], a[68:71], v[164:167]
  v_mfma_f32_16x16x32_bf16 v[168:171], v[40:43], a[72:75], v[168:171]
  v_mfma_f32_16x16x32_bf16 v[172:175], v[40:43], a[76:79], v[172:175]
  s_waitcnt lgkmcnt(6)
  v_mfma_f32_16x16x32_bf16 v[64:67], v[44:47], a[80:83], v[64:67]
  ds_read_b64_tr_b16 v[60:61], v23 offset:512
  ds_read_b64_tr_b16 v[62:63], v23 offset:8960
  v_mfma_f32_16x16x32_bf16 v[68:71], v[44:47], a[84:87], v[68:71]
  v_mfma_f32_16x16x32_bf16 v[72:75], v[44:47], a[88:91], v[72:75]
  v_mfma_f32_16x16x32_bf16 v[76:79], v[44:47], a[92:95], v[76:79]
  v_mfma_f32_16x16x32_bf16 v[176:179], v[44:47], v[36:39], v[176:179]
  s_waitcnt lgkmcnt(6)
  v_mfma_f32_16x16x32_bf16 v[80:83], v[48:51], a[80:83], v[80:83]
  ds_read_b64_tr_b16 v[40:41], v23 offset:528
  ds_read_b64_tr_b16 v[42:43], v23 offset:8976
  v_mfma_f32_16x16x32_bf16 v[84:87], v[48:51], a[84:87], v[84:87]
  v_mfma_f32_16x16x32_bf16 v[88:91], v[48:51], a[88:91], v[88:91]
  v_mfma_f32_16x16x32_bf16 v[92:95], v[48:51], a[92:95], v[92:95]
  v_mfma_f32_16x16x32_bf16 v[180:183], v[48:51], v[36:39], v[180:183]
  s_waitcnt lgkmcnt(6)
  v_mfma_f32_16x16x32_bf16 v[96:99], v[52:55], a[80:83], v[96:99]
  ds_read_b64_tr_b16 v[44:45], v23 offset:544
  ds_read_b64_tr_b16 v[46:47], v23 offset:8992
  v_mfma_f32_16x16x32_bf16 v[100:103], v[52:55], a[84:87], v[100:103]
  v_mfma_f32_16x16x32_bf16 v[104:107], v[52:55], a[88:91], v[104:107]
  v_mfma_f32_16x16x32_bf16 v[108:111], v[52:55], a[92:95], v[108:111]
  v_mfma_f32_16x16x32_bf16 v[184:187], v[52:55], v[36:39], v[184:187]
  s_waitcnt lgkmcnt(6)
  v_mfma_f32_16x16x32_bf16 v[112:115], v[56:59], a[80:83], v[112:115]
  v_mfma_f32_16x16x32_bf16 v[116:119], v[56:59], a[84:87], v[116:119]
  v_mfma_f32_16x16x32_bf16 v[120:123], v[56:59], a[88:91], v[120:123]
  v_mfma_f32_16x16x32_bf16 v[124:127], v[56:59], a[92:95], v[124:127]
  s_waitcnt vmcnt(16)
  s_waitcnt lgkmcnt(0)
  s_barrier
  v_add_u32 v22, 33792, v20
  v_add_u32 v23, 33792, v21
  v_cmp_eq_u32 vcc, 0, v5
  s_cbranch_vccz epok_11
  s_mov_b32 s15, 200000
epspin_12:
  s_sleep 2
  buffer_load_dword v5, v4, s[28:31], 0 offen sc1
  s_waitcnt vmcnt(0)
  v_cmp_eq_u32 vcc, 0, v5
  s_cbranch_vccz epok_11
  s_sub_u32 s15, s15, 1
  s_cmp_lg_u32 s15, 0
  s_cbranch_scc1 epspin_12
epok_11:
  v_readfirstlane_b32 s101, v5
  s_nop 3
  s_lshl_b32 s15, s9, 8
  s_lshl_b32 s14, s10, 4
  s_add_u32 s15, s15, s14
  s_lshl_b32 s14, s6, 2
  s_add_u32 s15, s15, s14
  s_add_u32 s15, s15, 23003136
  v_mov_b32 v4, s101
  v_mov_b32 v5, 0
  s_mov_b64 exec, 1
  buffer_store_dword v4, v5, s[52:55], s15 offen sc1
  s_mov_b64 exec, -1
  ds_read_b64_tr_b16 v[48:49], v22 offset:0
  ds_read_b64_tr_b16 v[50:51], v22 offset:8448
  v_mfma_f32_16x16x32_bf16 v[188:191], v[56:59], v[36:39], v[188:191]
  s_add_u32 m0, s85, 0
  s_add_u32 s81, s84, 1327104
  v_mfma_f32_16x16x32_bf16 v[128:131], v[60:63], a[80:83], v[128:131]
  ds_read_b64_tr_b16 v[52:53], v22 offset:16
  ds_read_b64_tr_b16 v[54:55], v22 offset:8464
  v_mfma_f32_16x16x32_bf16 v[132:135], v[60:63], a[84:87], v[132:135]
  buffer_load_dwordx4 v12, s[44:47], s81 offen offset:0 lds
  v_mfma_f32_16x16x32_bf16 v[136:139], v[60:63], a[88:91], v[136:139]
  buffer_load_dwordx4 v13, s[44:47], s81 offen offset:1056 lds
  v_mfma_f32_16x16x32_bf16 v[140:143], v[60:63], a[92:95], v[140:143]
  v_mfma_f32_16x16x32_bf16 v[144:147], v[40:43], a[80:83], v[144:147]
  ds_read_b64_tr_b16 v[56:57], v22 offset:32
  ds_read_b64_tr_b16 v[58:59], v22 offset:8480
  v_mfma_f32_16x16x32_bf16 v[148:151], v[40:43], a[84:87], v[148:151]
  buffer_load_dwordx4 v14, s[44:47], s81 offen offset:2112 lds
  v_mfma_f32_16x16x32_bf16 v[152:155], v[40:43], a[88:91], v[152:155]
  buffer_load_dwordx4 v15, s[44:47], s81 offen offset:3168 lds
  v_mfma_f32_16x16x32_bf16 v[156:159], v[40:43], a[92:95], v[156:159]
  v_mfma_f32_16x16x32_bf16 v[160:163], v[44:47], a[80:83], v[160:163]
  ds_read_b64_tr_b16 v[60:61], v22 offset:48
  ds_read_b64_tr_b16 v[62:63], v22 offset:8496
  v_mfma_f32_16x16x32_bf16 v[164:167], v[44:47], a[84:87], v[164:167]
  s_add_u32 m0, s85, 16912
  s_nop 0
  buffer_load_dwordx4 v12, s[48:51], s81 offen offset:0 lds
  v_mfma_f32_16x16x32_bf16 v[168:171], v[44:47], a[88:91], v[168:171]
  buffer_load_dwordx4 v13, s[48:51], s81 offen offset:1056 lds
  v_mfma_f32_16x16x32_bf16 v[172:175], v[44:47], a[92:95], v[172:175]
  s_waitcnt lgkmcnt(6)
  v_mfma_f32_16x16x32_bf16 v[64:67], v[48:51], a[96:99], v[64:67]
  ds_read_b64_tr_b16 v[40:41], v23 offset:0
  ds_read_b64_tr_b16 v[42:43], v23 offset:8448
  v_mfma_f32_16x16x32_bf16 v[68:71], v[48:51], a[100:103], v[68:71]
  buffer_load_dwordx4 v14, s[48:51], s81 offen offset:2112 lds
  v_mfma_f32_16x16x32_bf16 v[72:75], v[48:51], a[104:107], v[72:75]
  buffer_load_dwordx4 v15, s[48:51], s81 offen offset:3168 lds
  v_mfma_f32_16x16x32_bf16 v[76:79], v[48:51], a[108:111], v[76:79]
  v_mfma_f32_16x16x32_bf16 v[176:179], v[48:51], v[36:39], v[176:179]
  s_waitcnt lgkmcnt(6)
  v_mfma_f32_16x16x32_bf16 v[80:83], v[52:55], a[96:99], v[80:83]
  ds_read_b64_tr_b16 v[44:45], v23 offset:16
  ds_read_b64_tr_b16 v[46:47], v23 offset:8464
  v_mfma_f32_16x16x32_bf16 v[84:87], v[52:55], a[100:103], v[84:87]
  v_mfma_f32_16x16x32_bf16 v[88:91], v[52:55], a[104:107], v[88:91]
  v_mfma_f32_16x16x32_bf16 v[92:95], v[52:55], a[108:111], v[92:95]
  v_mfma_f32_16x16x32_bf16 v[180:183], v[52:55], v[36:39], v[180:183]
  s_waitcnt lgkmcnt(6)
  v_mfma_f32_16x16x32_bf16 v[96:99], v[56:59], a[96:99], v[96:99]
  ds_read_b64_tr_b16 v[48:49], v23 offset:32
  ds_read_b64_tr_b16 v[50:51], v23 offset:8480
  v_mfma_f32_16x16x32_bf16 v[100:103], v[56:59], a[100:103], v[100:103]
  v_mfma_f32_16x16x32_bf16 v[104:107], v[56:59], a[104:107], v[104:107]
  v_mfma_f32_16x16x32_bf16 v[108:111], v[56:59], a[108:111], v[108:111]
  v_mfma_f32_16x16x32_bf16 v[184:187], v[56:59], v[36:39], v[184:187]
  s_waitcnt lgkmcnt(6)
  v_mfma_f32_16x16x32_bf16 v[112:115], v[60:63], a[96:99], v[112:115]
  ds_read_b64_tr_b16 v[52:53], v22 offset:512
  ds_read_b64_tr_b16 v[54:55], v22 offset:8960
  v_mfma_f32_16x16x32_bf16 v[116:119], v[60:63], a[100:103], v[116:119]
  v_mfma_f32_16x16x32_bf16 v[120:123], v[60:63], a[104:107], v[120:123]
  v_mfma_f32_16x16x32_bf16 v[124:127], v[60:63], a[108:111], v[124:127]
  v_mfma_f32_16x16x32_bf16 v[188:191], v[60:63], v[36:39], v[188:191]
  s_waitcnt lgkmcnt(6)
  v_mfma_f32_16x16x32_bf16 v[128:131], v[40:43], a[96:99], v[128:131]
  ds_read_b64_tr_b16 v[56:57], v22 offset:528
  ds_read_b64_tr_b16 v[58:59], v22 offset:8976
  v_mfma_f32_16x16x32_bf16 v[132:135], v[40:43], a[100:103], v[132:135]
  v_mfma_f32_16x16x32_bf16 v[136:139], v[40:43], a[104:107], v[136:139]
  v_mfma_f32_16x16x32_bf16 v[140:143], v[40:43], a[108:111], v[140:143]
  s_waitcnt lgkmcnt(6)
  v_mfma_f32_16x16x32_bf16 v[144:147], v[44:47], a[96:99], v[144:147]
  ds_read_b64_tr_b16 v[60:61], v22 offset:544
  ds_read_b64_tr_b16 v[62:63], v22 offset:8992
  v_mfma_f32_16x16x32_bf16 v[148:151], v[44:47], a[100:103], v[148:151]
  v_mfma_f32_16x16x32_bf16 v[152:155], v[44:47], a[104:107], v[152:155]
  v_mfma_f32_16x16x32_bf16 v[156:159], v[44:47], a[108:111], v[156:159]
  s_waitcnt lgkmcnt(6)
  v_mfma_f32_16x16x32_bf16 v[160:163], v[48:51], a[96:99], v[160:163]
  ds_read_b64_tr_b16 v[40:41], v22 offset:560
  ds_read_b64_tr_b16 v[42:43], v22 offset:9008
  v_mfma_f32_16x16x32_bf16 v[164:167], v[48:51], a[100:103], v[164:167]
  v_mfma_f32_16x16x32_bf16 v[168:171], v[48:51], a[104:107], v[168:171]
  v_mfma_f32_16x16x32_bf16 v[172:175], v[48:51], a[108:111], v[172:175]
  s_waitcnt lgkmcnt(6)
  v_mfma_f32_16x16x32_bf16 v[64:67], v[52:55], a[112:115], v[64:67]
  ds_read_b64_tr_b16 v[44:45], v23 offset:512
  ds_read_b64_tr_b16 v[46:47], v23 offset:8960
  v_mfma_f32_16x16x32_bf16 v[68:71], v[52:55], a[116:119], v[68:71]
  v_mfma_f32_16x16x32_bf16 v[72:75], v[52:55], a[120:123], v[72:75]
  v_mfma_f32_16x16x32_bf16 v[76:79], v[52:55], a[124:127], v[76:79]
  v_mfma_f32_16x16x32_bf16 v[176:179], v[52:55], v[36:39], v[176:179]
  s_waitcnt lgkmcnt(6)
  v_mfma_f32_16x16x32_bf16 v[80:83], v[56:59], a[112:115], v[80:83]
  ds_read_b64_tr_b16 v[48:49], v23 offset:528
  ds_read_b64_tr_b16 v[50:51], v23 offset:8976
  v_mfma_f32_16x16x32_bf16 v[84:87], v[56:59], a[116:119], v[84:87]
  v_mfma_f32_16x16x32_bf16 v[88:91], v[56:59], a[120:123], v[88:91]
  v_mfma_f32_16x16x32_bf16 v[92:95], v[56:59], a[124:127], v[92:95]
  v_mfma_f32_16x16x32_bf16 v[180:183], v[56:59], v[36:39], v[180:183]
  s_waitcnt lgkmcnt(6)
  v_mfma_f32_16x16x32_bf16 v[96:99], v[60:63], a[112:115], v[96:99]
  ds_read_b64_tr_b16 v[52:53], v23 offset:544
  ds_read_b64_tr_b16 v[54:55], v23 offset:8992
  v_mfma_f32_16x16x32_bf16 v[100:103], v[60:63], a[116:119], v[100:103]
  v_mfma_f32_16x16x32_bf16 v[104:107], v[60:63], a[120:123], v[104:107]
  v_mfma_f32_16x16x32_bf16 v[108:111], v[60:63], a[124:127], v[108:111]
  v_mfma_f32_16x16x32_bf16 v[184:187], v[60:63], v[36:39], v[184:187]
  s_waitcnt lgkmcnt(6)
  v_mfma_f32_16x16x32_bf16 v[112:115], v[40:43], a[112:115], v[112:115]
  v_mfma_f32_16x16x32_bf16 v[116:119], v[40:43], a[116:119], v[116:119]
  v_mfma_f32_16x16x32_bf16 v[120:123], v[40:43], a[120:123], v[120:123]
  v_mfma_f32_16x16x32_bf16 v[124:127], v[40:43], a[124:127], v[124:127]
  s_waitcnt vmcnt(17)
  s_waitcnt lgkmcnt(0)
  s_barrier
  v_add_u32 v22, 67584, v20
  v_add_u32 v23, 67584, v21
  ds_read_b64_tr_b16 v[56:57], v22 offset:0
  ds_read_b64_tr_b16 v[58:59], v22 offset:8448
  v_mfma_f32_16x16x32_bf16 v[188:191], v[40:43], v[36:39], v[188:191]
  s_add_u32 m0, s85, 33792
  s_add_u32 s81, s84, 1548288
  v_mfma_f32_16x16x32_bf16 v[128:131], v[44:47], a[112:115], v[128:131]
  ds_read_b64_tr_b16 v[60:61], v22 offset:16
  ds_read_b64_tr_b16 v[62:63], v22 offset:8464
  v_mfma_f32_16x16x32_bf16 v[132:135], v[44:47], a[116:119], v[132:135]
  buffer_load_dwordx4 v12, s[44:47], s81 offen offset:0 lds
  v_mfma_f32_16x16x32_bf16 v[136:139], v[44:47], a[120:123], v[136:139]
  buffer_load_dwordx4 v13, s[44:47], s81 offen offset:1056 lds
  v_mfma_f32_16x16x32_bf16 v[140:143], v[44:47], a[124:127], v[140:143]
  v_mfma_f32_16x16x32_bf16 v[144:147], v[48:51], a[112:115], v[144:147]
  ds_read_b64_tr_b16 v[40:41], v22 offset:32
  ds_read_b64_tr_b16 v[42:43], v22 offset:8480
  v_mfma_f32_16x16x32_bf16 v[148:151], v[48:51], a[116:119], v[148:151]
  buffer_load_dwordx4 v14, s[44:47], s81 offen offset:2112 lds
  v_mfma_f32_16x16x32_bf16 v[152:155], v[48:51], a[120:123], v[152:155]
  buffer_load_dwordx4 v15, s[44:47], s81 offen offset:3168 lds
  v_mfma_f32_16x16x32_bf16 v[156:159], v[48:51], a[124:127], v[156:159]
  v_mfma_f32_16x16x32_bf16 v[160:163], v[52:55], a[112:115], v[160:163]
  ds_read_b64_tr_b16 v[44:45], v22 offset:48
  ds_read_b64_tr_b16 v[46:47], v22 offset:8496
  v_mfma_f32_16x16x32_bf16 v[164:167], v[52:55], a[116:119], v[164:167]
  s_add_u32 m0, s85, 50704
  s_nop 0
  buffer_load_dwordx4 v12, s[48:51], s81 offen offset:0 lds
  v_mfma_f32_16x16x32_bf16 v[168:171], v[52:55], a[120:123], v[168:171]
  buffer_load_dwordx4 v13, s[48:51], s81 offen offset:1056 lds
  v_mfma_f32_16x16x32_bf16 v[172:175], v[52:55], a[124:127], v[172:175]
  s_waitcnt lgkmcnt(6)
  v_mfma_f32_16x16x32_bf16 v[64:67], v[56:59], a[128:131], v[64:67]
  ds_read_b64_tr_b16 v[48:49], v23 offset:0
  ds_read_b64_tr_b16 v[50:51], v23 offset:8448
  v_mfma_f32_16x16x32_bf16 v[68:71], v[56:59], a[132:135], v[68:71]
  buffer_load_dwordx4 v14, s[48:51], s81 offen offset:2112 lds
  v_mfma_f32_16x16x32_bf16 v[72:75], v[56:59], a[136:139], v[72:75]
  buffer_load_dwordx4 v15, s[48:51], s81 offen offset:3168 lds
  v_mfma_f32_16x16x32_bf16 v[76:79], v[56:59], a[140:143], v[76:79]
  v_mfma_f32_16x16x32_bf16 v[176:179], v[56:59], v[36:39], v[176:179]
  s_waitcnt lgkmcnt(6)
  v_mfma_f32_16x16x32_bf16 v[80:83], v[60:63], a[128:131], v[80:83]
  ds_read_b64_tr_b16 v[52:53], v23 offset:16
  ds_read_b64_tr_b16 v[54:55], v23 offset:8464
  v_mfma_f32_16x16x32_bf16 v[84:87], v[60:63], a[132:135], v[84:87]
  v_mfma_f32_16x16x32_bf16 v[88:91], v[60:63], a[136:139], v[88:91]
  v_mfma_f32_16x16x32_bf16 v[92:95], v[60:63], a[140:143], v[92:95]
  v_mfma_f32_16x16x32_bf16 v[180:183], v[60:63], v[36:39], v[180:183]
  s_waitcnt lgkmcnt(6)
  v_mfma_f32_16x16x32_bf16 v[96:99], v[40:43], a[128:131], v[96:99]
  ds_read_b64_tr_b16 v[56:57], v23 offset:32
  ds_read_b64_tr_b16 v[58:59], v23 offset:8480
  v_mfma_f32_16x16x32_bf16 v[100:103], v[40:43], a[132:135], v[100:103]
  v_mfma_f32_16x16x32_bf16 v[104:107], v[40:43], a[136:139], v[104:107]
  v_mfma_f32_16x16x32_bf16 v[108:111], v[40:43], a[140:143], v[108:111]
  v_mfma_f32_16x16x32_bf16 v[184:187], v[40:43], v[36:39], v[184:187]
  s_waitcnt lgkmcnt(6)
  v_mfma_f32_16x16x32_bf16 v[112:115], v[44:47], a[128:131], v[112:115]
  ds_read_b64_tr_b16 v[60:61], v22 offset:512
  ds_read_b64_tr_b16 v[62:63], v22 offset:8960
  v_mfma_f32_16x16x32_bf16 v[116:119], v[44:47], a[132:135], v[116:119]
  v_mfma_f32_16x16x32_bf16 v[120:123], v[44:47], a[136:139], v[120:123]
  v_mfma_f32_16x16x32_bf16 v[124:127], v[44:47], a[140:143], v[124:127]
  v_mfma_f32_16x16x32_bf16 v[188:191], v[44:47], v[36:39], v[188:191]
  s_waitcnt lgkmcnt(6)
  v_mfma_f32_16x16x32_bf16 v[128:131], v[48:51], a[128:131], v[128:131]
  ds_read_b64_tr_b16 v[40:41], v22 offset:528
  ds_read_b64_tr_b16 v[42:43], v22 offset:8976
  v_mfma_f32_16x16x32_bf16 v[132:135], v[48:51], a[132:135], v[132:135]
  v_mfma_f32_16x16x32_bf16 v[136:139], v[48:51], a[136:139], v[136:139]
  v_mfma_f32_16x16x32_bf16 v[140:143], v[48:51], a[140:143], v[140:143]
  s_waitcnt lgkmcnt(6)
  v_mfma_f32_16x16x32_bf16 v[144:147], v[52:55], a[128:131], v[144:147]
  ds_read_b64_tr_b16 v[44:45], v22 offset:544
  ds_read_b64_tr_b16 v[46:47], v22 offset:8992
  v_mfma_f32_16x16x32_bf16 v[148:151], v[52:55], a[132:135], v[148:151]
  v_mfma_f32_16x16x32_bf16 v[152:155], v[52:55], a[136:139], v[152:155]
  v_mfma_f32_16x16x32_bf16 v[156:159], v[52:55], a[140:143], v[156:159]
  s_waitcnt lgkmcnt(6)
  v_mfma_f32_16x16x32_bf16 v[160:163], v[56:59], a[128:131], v[160:163]
  ds_read_b64_tr_b16 v[48:49], v22 offset:560
  ds_read_b64_tr_b16 v[50:51], v22 offset:9008
  v_mfma_f32_16x16x32_bf16 v[164:167], v[56:59], a[132:135], v[164:167]
  v_mfma_f32_16x16x32_bf16 v[168:171], v[56:59], a[136:139], v[168:171]
  v_mfma_f32_16x16x32_bf16 v[172:175], v[56:59], a[140:143], v[172:175]
  s_waitcnt lgkmcnt(6)
  v_mfma_f32_16x16x32_bf16 v[64:67], v[60:63], a[144:147], v[64:67]
  ds_read_b64_tr_b16 v[52:53], v23 offset:512
  ds_read_b64_tr_b16 v[54:55], v23 offset:8960
  v_mfma_f32_16x16x32_bf16 v[68:71], v[60:63], a[148:151], v[68:71]
  v_mfma_f32_16x16x32_bf16 v[72:75], v[60:63], a[152:155], v[72:75]
  v_mfma_f32_16x16x32_bf16 v[76:79], v[60:63], a[156:159], v[76:79]
  v_mfma_f32_16x16x32_bf16 v[176:179], v[60:63], v[36:39], v[176:179]
  s_waitcnt lgkmcnt(6)
  v_mfma_f32_16x16x32_bf16 v[80:83], v[40:43], a[144:147], v[80:83]
  ds_read_b64_tr_b16 v[56:57], v23 offset:528
  ds_read_b64_tr_b16 v[58:59], v23 offset:8976
  v_mfma_f32_16x16x32_bf16 v[84:87], v[40:43], a[148:151], v[84:87]
  v_mfma_f32_16x16x32_bf16 v[88:91], v[40:43], a[152:155], v[88:91]
  v_mfma_f32_16x16x32_bf16 v[92:95], v[40:43], a[156:159], v[92:95]
  v_mfma_f32_16x16x32_bf16 v[180:183], v[40:43], v[36:39], v[180:183]
  s_waitcnt lgkmcnt(6)
  v_mfma_f32_16x16x32_bf16 v[96:99], v[44:47], a[144:147], v[96:99]
  ds_read_b64_tr_b16 v[60:61], v23 offset:544
  ds_read_b64_tr_b16 v[62:63], v23 offset:8992
  v_mfma_f32_16x16x32_bf16 v[100:103], v[44:47], a[148:151], v[100:103]
  v_mfma_f32_16x16x32_bf16 v[104:107], v[44:47], a[152:155], v[104:107]
  v_mfma_f32_16x16x32_bf16 v[108:111], v[44:47], a[156:159], v[108:111]
  v_mfma_f32_16x16x32_bf16 v[184:187], v[44:47], v[36:39], v[184:187]
  s_waitcnt lgkmcnt(6)
  v_mfma_f32_16x16x32_bf16 v[112:115], v[48:51], a[144:147], v[112:115]
  v_mfma_f32_16x16x32_bf16 v[116:119], v[48:51], a[148:151], v[116:119]
  v_mfma_f32_16x16x32_bf16 v[120:123], v[48:51], a[152:155], v[120:123]
  v_mfma_f32_16x16x32_bf16 v[124:127], v[48:51], a[156:159], v[124:127]
  s_waitcnt vmcnt(17)
  s_waitcnt lgkmcnt(0)
  s_barrier
  v_add_u32 v22, 101376, v20
  v_add_u32 v23, 101376, v21
  ds_read_b64_tr_b16 v[40:41], v22 offset:0
  ds_read_b64_tr_b16 v[42:43], v22 offset:8448
  v_mfma_f32_16x16x32_bf16 v[188:191], v[48:51], v[36:39], v[188:191]
  s_add_u32 m0, s85, 67584
  s_add_u32 s81, s84, 1769472
  v_mfma_f32_16x16x32_bf16 v[128:131], v[52:55], a[144:147], v[128:131]
  ds_read_b64_tr_b16 v[44:45], v22 offset:16
  ds_read_b64_tr_b16 v[46:47], v22 offset:8464
  v_mfma_f32_16x16x32_bf16 v[132:135], v[52:55], a[148:151], v[132:135]
  buffer_load_dwordx4 v12, s[44:47], s81 offen offset:0 lds
  v_mfma_f32_16x16x32_bf16 v[136:139], v[52:55], a[152:155], v[136:139]
  buffer_load_dwordx4 v13, s[44:47], s81 offen offset:1056 lds
  v_mfma_f32_16x16x32_bf16 v[140:143], v[52:55], a[156:159], v[140:143]
  v_mfma_f32_16x16x32_bf16 v[144:147], v[56:59], a[144:147], v[144:147]
  ds_read_b64_tr_b16 v[48:49], v22 offset:32
  ds_read_b64_tr_b16 v[50:51], v22 offset:8480
  v_mfma_f32_16x16x32_bf16 v[148:151], v[56:59], a[148:151], v[148:151]
  buffer_load_dwordx4 v14, s[44:47], s81 offen offset:2112 lds
  v_mfma_f32_16x16x32_bf16 v[152:155], v[56:59], a[152:155], v[152:155]
  buffer_load_dwordx4 v15, s[44:47], s81 offen offset:3168 lds
  v_mfma_f32_16x16x32_bf16 v[156:159], v[56:59], a[156:159], v[156:159]
  v_mfma_f32_16x16x32_bf16 v[160:163], v[60:63], a[144:147], v[160:163]
  ds_read_b64_tr_b16 v[52:53], v22 offset:48
  ds_read_b64_tr_b16 v[54:55], v22 offset:8496
  v_mfma_f32_16x16x32_bf16 v[164:167], v[60:63], a[148:151], v[164:167]
  s_add_u32 m0, s85, 84496
  s_nop 0
  buffer_load_dwordx4 v12, s[48:51], s81 offen offset:0 lds
  v_mfma_f32_16x16x32_bf16 v[168:171], v[60:63], a[152:155], v[168:171]
  buffer_load_dwordx4 v13, s[48:51], s81 offen offset:1056 lds
  v_mfma_f32_16x16x32_bf16 v[172:175], v[60:63], a[156:159], v[172:175]
  s_waitcnt lgkmcnt(6)
  v_mfma_f32_16x16x32_bf16 v[64:67], v[40:43], a[160:163], v[64:67]
  ds_read_b64_tr_b16 v[56:57], v23 offset:0
  ds_read_b64_tr_b16 v[58:59], v23 offset:8448
  v_mfma_f32_16x16x32_bf16 v[68:71], v[40:43], a[164:167], v[68:71]
  buffer_load_dwordx4 v14, s[48:51], s81 offen offset:2112 lds
  v_mfma_f32_16x16x32_bf16 v[72:75], v[40:43], a[168:171], v[72:75]
  buffer_load_dwordx4 v15, s[48:51], s81 offen offset:3168 lds
  v_mfma_f32_16x16x32_bf16 v[76:79], v[40:43], a[172:175], v[76:79]
  v_mfma_f32_16x16x32_bf16 v[176:179], v[40:43], v[36:39], v[176:179]
  s_waitcnt lgkmcnt(6)
  v_mfma_f32_16x16x32_bf16 v[80:83], v[44:47], a[160:163], v[80:83]
  ds_read_b64_tr_b16 v[60:61], v23 offset:16
  ds_read_b64_tr_b16 v[62:63], v23 offset:8464
  v_mfma_f32_16x16x32_bf16 v[84:87], v[44:47], a[164:167], v[84:87]
  v_mfma_f32_16x16x32_bf16 v[88:91], v[44:47], a[168:171], v[88:91]
  v_mfma_f32_16x16x32_bf16 v[92:95], v[44:47], a[172:175], v[92:95]
  v_mfma_f32_16x16x32_bf16 v[180:183], v[44:47], v[36:39], v[180:183]
  s_waitcnt lgkmcnt(6)
  v_mfma_f32_16x16x32_bf16 v[96:99], v[48:51], a[160:163], v[96:99]
  ds_read_b64_tr_b16 v[40:41], v23 offset:32
  ds_read_b64_tr_b16 v[42:43], v23 offset:8480
  v_mfma_f32_16x16x32_bf16 v[100:103], v[48:51], a[164:167], v[100:103]
  v_mfma_f32_16x16x32_bf16 v[104:107], v[48:51], a[168:171], v[104:107]
  v_mfma_f32_16x16x32_bf16 v[108:111], v[48:51], a[172:175], v[108:111]
  v_mfma_f32_16x16x32_bf16 v[184:187], v[48:51], v[36:39], v[184:187]
  s_waitcnt lgkmcnt(6)
  v_mfma_f32_16x16x32_bf16 v[112:115], v[52:55], a[160:163], v[112:115]
  ds_read_b64_tr_b16 v[44:45], v22 offset:512
  ds_read_b64_tr_b16 v[46:47], v22 offset:8960
  v_mfma_f32_16x16x32_bf16 v[116:119], v[52:55], a[164:167], v[116:119]
  v_mfma_f32_16x16x32_bf16 v[120:123], v[52:55], a[168:171], v[120:123]
  v_mfma_f32_16x16x32_bf16 v[124:127], v[52:55], a[172:175], v[124:127]
  v_mfma_f32_16x16x32_bf16 v[188:191], v[52:55], v[36:39], v[188:191]
  s_waitcnt lgkmcnt(6)
  v_mfma_f32_16x16x32_bf16 v[128:131], v[56:59], a[160:163], v[128:131]
  ds_read_b64_tr_b16 v[48:49], v22 offset:528
  ds_read_b64_tr_b16 v[50:51], v22 offset:8976
  v_mfma_f32_16x16x32_bf16 v[132:135], v[56:59], a[164:167], v[132:135]
  v_mfma_f32_16x16x32_bf16 v[136:139], v[56:59], a[168:171], v[136:139]
  v_mfma_f32_16x16x32_bf16 v[140:143], v[56:59], a[172:175], v[140:143]
  s_waitcnt lgkmcnt(6)
  v_mfma_f32_16x16x32_bf16 v[144:147], v[60:63], a[160:163], v[144:147]
  ds_read_b64_tr_b16 v[52:53], v22 offset:544
  ds_read_b64_tr_b16 v[54:55], v22 offset:8992
  v_mfma_f32_16x16x32_bf16 v[148:151], v[60:63], a[164:167], v[148:151]
  v_mfma_f32_16x16x32_bf16 v[152:155], v[60:63], a[168:171], v[152:155]
  v_mfma_f32_16x16x32_bf16 v[156:159], v[60:63], a[172:175], v[156:159]
  s_waitcnt lgkmcnt(6)
  v_mfma_f32_16x16x32_bf16 v[160:163], v[40:43], a[160:163], v[160:163]
  ds_read_b64_tr_b16 v[56:57], v22 offset:560
  ds_read_b64_tr_b16 v[58:59], v22 offset:9008
  v_mfma_f32_16x16x32_bf16 v[164:167], v[40:43], a[164:167], v[164:167]
  v_mfma_f32_16x16x32_bf16 v[168:171], v[40:43], a[168:171], v[168:171]
  v_mfma_f32_16x16x32_bf16 v[172:175], v[40:43], a[172:175], v[172:175]
  s_waitcnt lgkmcnt(6)
  v_mfma_f32_16x16x32_bf16 v[64:67], v[44:47], a[176:179], v[64:67]
  ds_read_b64_tr_b16 v[60:61], v23 offset:512
  ds_read_b64_tr_b16 v[62:63], v23 offset:8960
  v_mfma_f32_16x16x32_bf16 v[68:71], v[44:47], a[180:183], v[68:71]
  v_mfma_f32_16x16x32_bf16 v[72:75], v[44:47], a[184:187], v[72:75]
  v_mfma_f32_16x16x32_bf16 v[76:79], v[44:47], a[188:191], v[76:79]
  v_mfma_f32_16x16x32_bf16 v[176:179], v[44:47], v[36:39], v[176:179]
  s_waitcnt lgkmcnt(6)
  v_mfma_f32_16x16x32_bf16 v[80:83], v[48:51], a[176:179], v[80:83]
  ds_read_b64_tr_b16 v[40:41], v23 offset:528
  ds_read_b64_tr_b16 v[42:43], v23 offset:8976
  v_mfma_f32_16x16x32_bf16 v[84:87], v[48:51], a[180:183], v[84:87]
  v_mfma_f32_16x16x32_bf16 v[88:91], v[48:51], a[184:187], v[88:91]
  v_mfma_f32_16x16x32_bf16 v[92:95], v[48:51], a[188:191], v[92:95]
  v_mfma_f32_16x16x32_bf16 v[180:183], v[48:51], v[36:39], v[180:183]
  s_waitcnt lgkmcnt(6)
  v_mfma_f32_16x16x32_bf16 v[96:99], v[52:55], a[176:179], v[96:99]
  ds_read_b64_tr_b16 v[44:45], v23 offset:544
  ds_read_b64_tr_b16 v[46:47], v23 offset:8992
  v_mfma_f32_16x16x32_bf16 v[100:103], v[52:55], a[180:183], v[100:103]
  v_mfma_f32_16x16x32_bf16 v[104:107], v[52:55], a[184:187], v[104:107]
  v_mfma_f32_16x16x32_bf16 v[108:111], v[52:55], a[188:191], v[108:111]
  v_mfma_f32_16x16x32_bf16 v[184:187], v[52:55], v[36:39], v[184:187]
  s_waitcnt lgkmcnt(6)
  v_mfma_f32_16x16x32_bf16 v[112:115], v[56:59], a[176:179], v[112:115]
  v_mfma_f32_16x16x32_bf16 v[116:119], v[56:59], a[180:183], v[116:119]
  v_mfma_f32_16x16x32_bf16 v[120:123], v[56:59], a[184:187], v[120:123]
  v_mfma_f32_16x16x32_bf16 v[124:127], v[56:59], a[188:191], v[124:127]
  s_waitcnt vmcnt(16)
  s_waitcnt lgkmcnt(0)
  s_barrier
  v_add_u32 v22, 0, v20
  v_add_u32 v23, 0, v21
  s_lshr_b32 s11, s5, 4
  s_lshl_b32 s60, s4, 1
  s_add_u32 s60, s60, s11
  s_and_b32 s61, s5, 15
  s_and_b32 s62, s6, 1
  s_lshr_b32 s63, s6, 1
  v_min_u32 v4, 2, v3
  s_sub_u32 s11, s61, 2
  v_add_u32 v4, s11, v4
  v_max_i32 v4, 0, v4
  v_lshlrev_b32 v4, 8, v4
  v_lshl_add_u32 v4, v2, 4, v4
  s_mov_b32 s15, 23003136
  buffer_load_dwordx4 v[8:11], v4, s[52:55], s15 offen offset:0 sc1
  ds_read_b64_tr_b16 v[48:49], v22 offset:0
  ds_read_b64_tr_b16 v[50:51], v22 offset:8448
  v_mfma_f32_16x16x32_bf16 v[188:191], v[56:59], v[36:39], v[188:191]
  s_add_u32 m0, s85, 101376
  s_add_u32 s81, s84, 1990656
  v_mfma_f32_16x16x32_bf16 v[128:131], v[60:63], a[176:179], v[128:131]
  ds_read_b64_tr_b16 v[52:53], v22 offset:16
  ds_read_b64_tr_b16 v[54:55], v22 offset:8464
  v_mfma_f32_16x16x32_bf16 v[132:135], v[60:63], a[180:183], v[132:135]
  buffer_load_dwordx4 v12, s[44:47], s81 offen offset:0 lds
  v_mfma_f32_16x16x32_bf16 v[136:139], v[60:63], a[184:187], v[136:139]
  buffer_load_dwordx4 v13, s[44:47], s81 offen offset:1056 lds
  v_mfma_f32_16x16x32_bf16 v[140:143], v[60:63], a[188:191], v[140:143]
  v_mfma_f32_16x16x32_bf16 v[144:147], v[40:43], a[176:179], v[144:147]
  ds_read_b64_tr_b16 v[56:57], v22 offset:32
  ds_read_b64_tr_b16 v[58:59], v22 offset:8480
  v_mfma_f32_16x16x32_bf16 v[148:151], v[40:43], a[180:183], v[148:151]
  buffer_load_dwordx4 v14, s[44:47], s81 offen offset:2112 lds
  v_mfma_f32_16x16x32_bf16 v[152:155], v[40:43], a[184:187], v[152:155]
  buffer_load_dwordx4 v15, s[44:47], s81 offen offset:3168 lds
  v_mfma_f32_16x16x32_bf16 v[156:159], v[40:43], a[188:191], v[156:159]
  v_mfma_f32_16x16x32_bf16 v[160:163], v[44:47], a[176:179], v[160:163]
  ds_read_b64_tr_b16 v[60:61], v22 offset:48
  ds_read_b64_tr_b16 v[62:63], v22 offset:8496
  v_mfma_f32_16x16x32_bf16 v[164:167], v[44:47], a[180:183], v[164:167]
  s_add_u32 m0, s85, 118288
  s_nop 0
  buffer_load_dwordx4 v12, s[48:51], s81 offen offset:0 lds
  v_mfma_f32_16x16x32_bf16 v[168:171], v[44:47], a[184:187], v[168:171]
  buffer_load_dwordx4 v13, s[48:51], s81 offen offset:1056 lds
  v_mfma_f32_16x16x32_bf16 v[172:175], v[44:47], a[188:191], v[172:175]
  s_waitcnt lgkmcnt(6)
  v_mfma_f32_16x16x32_bf16 v[64:67], v[48:51], a[192:195], v[64:67]
  ds_read_b64_tr_b16 v[40:41], v23 offset:0
  ds_read_b64_tr_b16 v[42:43], v23 offset:8448
  v_mfma_f32_16x16x32_bf16 v[68:71], v[48:51], a[196:199], v[68:71]
  buffer_load_dwordx4 v14, s[48:51], s81 offen offset:2112 lds
  v_mfma_f32_16x16x32_bf16 v[72:75], v[48:51], a[200:203], v[72:75]
  buffer_load_dwordx4 v15, s[48:51], s81 offen offset:3168 lds
  v_mfma_f32_16x16x32_bf16 v[76:79], v[48:51], a[204:207], v[76:79]
  v_mfma_f32_16x16x32_bf16 v[176:179], v[48:51], v[36:39], v[176:179]
  s_waitcnt lgkmcnt(6)
  v_mfma_f32_16x16x32_bf16 v[80:83], v[52:55], a[192:195], v[80:83]
  ds_read_b64_tr_b16 v[44:45], v23 offset:16
  ds_read_b64_tr_b16 v[46:47], v23 offset:8464
  v_mfma_f32_16x16x32_bf16 v[84:87], v[52:55], a[196:199], v[84:87]
  v_mfma_f32_16x16x32_bf16 v[88:91], v[52:55], a[200:203], v[88:91]
  v_mfma_f32_16x16x32_bf16 v[92:95], v[52:55], a[204:207], v[92:95]
  v_mfma_f32_16x16x32_bf16 v[180:183], v[52:55], v[36:39], v[180:183]
  s_waitcnt lgkmcnt(6)
  v_mfma_f32_16x16x32_bf16 v[96:99], v[56:59], a[192:195], v[96:99]
  ds_read_b64_tr_b16 v[48:49], v23 offset:32
  ds_read_b64_tr_b16 v[50:51], v23 offset:8480
  v_mfma_f32_16x16x32_bf16 v[100:103], v[56:59], a[196:199], v[100:103]
  v_mfma_f32_16x16x32_bf16 v[104:107], v[56:59], a[200:203], v[104:107]
  v_mfma_f32_16x16x32_bf16 v[108:111], v[56:59], a[204:207], v[108:111]
  v_mfma_f32_16x16x32_bf16 v[184:187], v[56:59], v[36:39], v[184:187]
  s_waitcnt lgkmcnt(6)
  v_mfma_f32_16x16x32_bf16 v[112:115], v[60:63], a[192:195], v[112:115]
  ds_read_b64_tr_b16 v[52:53], v22 offset:512
  ds_read_b64_tr_b16 v[54:55], v22 offset:8960
  v_mfma_f32_16x16x32_bf16 v[116:119], v[60:63], a[196:199], v[116:119]
  v_mfma_f32_16x16x32_bf16 v[120:123], v[60:63], a[200:203], v[120:123]
  v_mfma_f32_16x16x32_bf16 v[124:127], v[60:63], a[204:207], v[124:127]
  v_mfma_f32_16x16x32_bf16 v[188:191], v[60:63], v[36:39], v[188:191]
  s_waitcnt lgkmcnt(6)
  v_mfma_f32_16x16x32_bf16 v[128:131], v[40:43], a[192:195], v[128:131]
  ds_read_b64_tr_b16 v[56:57], v22 offset:528
  ds_read_b64_tr_b16 v[58:59], v22 offset:8976
  v_mfma_f32_16x16x32_bf16 v[132:135], v[40:43], a[196:199], v[132:135]
  v_mfma_f32_16x16x32_bf16 v[136:139], v[40:43], a[200:203], v[136:139]
  v_mfma_f32_16x16x32_bf16 v[140:143], v[40:43], a[204:207], v[140:143]
  s_waitcnt lgkmcnt(6)
  v_mfma_f32_16x16x32_bf16 v[144:147], v[44:47], a[192:195], v[144:147]
  ds_read_b64_tr_b16 v[60:61], v22 offset:544
  ds_read_b64_tr_b16 v[62:63], v22 offset:8992
  v_mfma_f32_16x16x32_bf16 v[148:151], v[44:47], a[196:199], v[148:151]
  v_mfma_f32_16x16x32_bf16 v[152:155], v[44:47], a[200:203], v[152:155]
  v_mfma_f32_16x16x32_bf16 v[156:159], v[44:47], a[204:207], v[156:159]
  s_waitcnt lgkmcnt(6)
  v_mfma_f32_16x16x32_bf16 v[160:163], v[48:51], a[192:195], v[160:163]
  ds_read_b64_tr_b16 v[40:41], v22 offset:560
  ds_read_b64_tr_b16 v[42:43], v22 offset:9008
  v_mfma_f32_16x16x32_bf16 v[164:167], v[48:51], a[196:199], v[164:167]
  v_mfma_f32_16x16x32_bf16 v[168:171], v[48:51], a[200:203], v[168:171]
  v_mfma_f32_16x16x32_bf16 v[172:175], v[48:51], a[204:207], v[172:175]
  s_waitcnt lgkmcnt(6)
  v_mfma_f32_16x16x32_bf16 v[64:67], v[52:55], a[208:211], v[64:67]
  ds_read_b64_tr_b16 v[44:45], v23 offset:512
  ds_read_b64_tr_b16 v[46:47], v23 offset:8960
  v_mfma_f32_16x16x32_bf16 v[68:71], v[52:55], a[212:215], v[68:71]
  v_mfma_f32_16x16x32_bf16 v[72:75], v[52:55], a[216:219], v[72:75]
  v_mfma_f32_16x16x32_bf16 v[76:79], v[52:55], a[220:223], v[76:79]
  v_mfma_f32_16x16x32_bf16 v[176:179], v[52:55], v[36:39], v[176:179]
  s_waitcnt lgkmcnt(6)
  v_mfma_f32_16x16x32_bf16 v[80:83], v[56:59], a[208:211], v[80:83]
  ds_read_b64_tr_b16 v[48:49], v23 offset:528
  ds_read_b64_tr_b16 v[50:51], v23 offset:8976
  v_mfma_f32_16x16x32_bf16 v[84:87], v[56:59], a[212:215], v[84:87]
  v_mfma_f32_16x16x32_bf16 v[88:91], v[56:59], a[216:219], v[88:91]
  v_mfma_f32_16x16x32_bf16 v[92:95], v[56:59], a[220:223], v[92:95]
  v_mfma_f32_16x16x32_bf16 v[180:183], v[56:59], v[36:39], v[180:183]
  s_waitcnt lgkmcnt(6)
  v_mfma_f32_16x16x32_bf16 v[96:99], v[60:63], a[208:211], v[96:99]
  ds_read_b64_tr_b16 v[52:53], v23 offset:544
  ds_read_b64_tr_b16 v[54:55], v23 offset:8992
  v_mfma_f32_16x16x32_bf16 v[100:103], v[60:63], a[212:215], v[100:103]
  v_mfma_f32_16x16x32_bf16 v[104:107], v[60:63], a[216:219], v[104:107]
  v_mfma_f32_16x16x32_bf16 v[108:111], v[60:63], a[220:223], v[108:111]
  v_mfma_f32_16x16x32_bf16 v[184:187], v[60:63], v[36:39], v[184:187]
  s_waitcnt lgkmcnt(6)
  v_mfma_f32_16x16x32_bf16 v[112:115], v[40:43], a[208:211], v[112:115]
  v_mfma_f32_16x16x32_bf16 v[116:119], v[40:43], a[212:215], v[116:119]
  v_mfma_f32_16x16x32_bf16 v[120:123], v[40:43], a[216:219], v[120:123]
  v_mfma_f32_16x16x32_bf16 v[124:127], v[40:43], a[220:223], v[124:127]
  s_waitcnt vmcnt(17)
  s_waitcnt lgkmcnt(0)
  s_barrier
  v_add_u32 v22, 33792, v20
  v_add_u32 v23, 33792, v21
  ds_read_b64_tr_b16 v[56:57], v22 offset:0
  ds_read_b64_tr_b16 v[58:59], v22 offset:8448
  v_mfma_f32_16x16x32_bf16 v[188:191], v[40:43], v[36:39], v[188:191]
  v_mfma_f32_16x16x32_bf16 v[128:131], v[44:47], a[208:211], v[128:131]
  ds_read_b64_tr_b16 v[60:61], v22 offset:16
  ds_read_b64_tr_b16 v[62:63], v22 offset:8464
  v_mfma_f32_16x16x32_bf16 v[132:135], v[44:47], a[212:215], v[132:135]
  v_mfma_f32_16x16x32_bf16 v[136:139], v[44:47], a[216:219], v[136:139]
  v_mfma_f32_16x16x32_bf16 v[140:143], v[44:47], a[220:223], v[140:143]
  v_mfma_f32_16x16x32_bf16 v[144:147], v[48:51], a[208:211], v[144:147]
  ds_read_b64_tr_b16 v[40:41], v22 offset:32
  ds_read_b64_tr_b16 v[42:43], v22 offset:8480
  v_mfma_f32_16x16x32_bf16 v[148:151], v[48:51], a[212:215], v[148:151]
  v_mfma_f32_16x16x32_bf16 v[152:155], v[48:51], a[216:219], v[152:155]
  v_mfma_f32_16x16x32_bf16 v[156:159], v[48:51], a[220:223], v[156:159]
  v_mfma_f32_16x16x32_bf16 v[160:163], v[52:55], a[208:211], v[160:163]
  ds_read_b64_tr_b16 v[44:45], v22 offset:48
  ds_read_b64_tr_b16 v[46:47], v22 offset:8496
  v_mfma_f32_16x16x32_bf16 v[164:167], v[52:55], a[212:215], v[164:167]
  v_mfma_f32_16x16x32_bf16 v[168:171], v[52:55], a[216:219], v[168:171]
  v_mfma_f32_16x16x32_bf16 v[172:175], v[52:55], a[220:223], v[172:175]
  s_waitcnt lgkmcnt(6)
  v_mfma_f32_16x16x32_bf16 v[64:67], v[56:59], a[224:227], v[64:67]
  ds_read_b64_tr_b16 v[48:49], v23 offset:0
  ds_read_b64_tr_b16 v[50:51], v23 offset:8448
  v_mfma_f32_16x16x32_bf16 v[68:71], v[56:59], a[228:231], v[68:71]
  v_mfma_f32_16x16x32_bf16 v[72:75], v[56:59], a[232:235], v[72:75]
  v_mfma_f32_16x16x32_bf16 v[76:79], v[56:59], a[236:239], v[76:79]
  v_mfma_f32_16x16x32_bf16 v[176:179], v[56:59], v[36:39], v[176:179]
  s_waitcnt lgkmcnt(6)
  v_mfma_f32_16x16x32_bf16 v[80:83], v[60:63], a[224:227], v[80:83]
  ds_read_b64_tr_b16 v[52:53], v23 offset:16
  ds_read_b64_tr_b16 v[54:55], v23 offset:8464
  v_mfma_f32_16x16x32_bf16 v[84:87], v[60:63], a[228:231], v[84:87]
  v_mfma_f32_16x16x32_bf16 v[88:91], v[60:63], a[232:235], v[88:91]
  v_mfma_f32_16x16x32_bf16 v[92:95], v[60:63], a[236:239], v[92:95]
  v_mfma_f32_16x16x32_bf16 v[180:183], v[60:63], v[36:39], v[180:183]
  s_waitcnt lgkmcnt(6)
  v_mfma_f32_16x16x32_bf16 v[96:99], v[40:43], a[224:227], v[96:99]
  ds_read_b64_tr_b16 v[56:57], v23 offset:32
  ds_read_b64_tr_b16 v[58:59], v23 offset:8480
  v_mfma_f32_16x16x32_bf16 v[100:103], v[40:43], a[228:231], v[100:103]
  v_mfma_f32_16x16x32_bf16 v[104:107], v[40:43], a[232:235], v[104:107]
  v_mfma_f32_16x16x32_bf16 v[108:111], v[40:43], a[236:239], v[108:111]
  v_mfma_f32_16x16x32_bf16 v[184:187], v[40:43], v[36:39], v[184:187]
  s_waitcnt lgkmcnt(6)
  v_mfma_f32_16x16x32_bf16 v[112:115], v[44:47], a[224:227], v[112:115]
  ds_read_b64_tr_b16 v[60:61], v22 offset:512
  ds_read_b64_tr_b16 v[62:63], v22 offset:8960
  v_mfma_f32_16x16x32_bf16 v[116:119], v[44:47], a[228:231], v[116:119]
  v_mfma_f32_16x16x32_bf16 v[120:123], v[44:47], a[232:235], v[120:123]
  v_mfma_f32_16x16x32_bf16 v[124:127], v[44:47], a[236:239], v[124:127]
  v_mfma_f32_16x16x32_bf16 v[188:191], v[44:47], v[36:39], v[188:191]
  s_waitcnt lgkmcnt(6)
  v_mfma_f32_16x16x32_bf16 v[128:131], v[48:51], a[224:227], v[128:131]
  ds_read_b64_tr_b16 v[40:41], v22 offset:528
  ds_read_b64_tr_b16 v[42:43], v22 offset:8976
  v_mfma_f32_16x16x32_bf16 v[132:135], v[48:51], a[228:231], v[132:135]
  v_mfma_f32_16x16x32_bf16 v[136:139], v[48:51], a[232:235], v[136:139]
  v_mfma_f32_16x16x32_bf16 v[140:143], v[48:51], a[236:239], v[140:143]
  s_waitcnt lgkmcnt(6)
  v_mfma_f32_16x16x32_bf16 v[144:147], v[52:55], a[224:227], v[144:147]
  ds_read_b64_tr_b16 v[44:45], v22 offset:544
  ds_read_b64_tr_b16 v[46:47], v22 offset:8992
  v_mfma_f32_16x16x32_bf16 v[148:151], v[52:55], a[228:231], v[148:151]
  v_mfma_f32_16x16x32_bf16 v[152:155], v[52:55], a[232:235], v[152:155]
  v_mfma_f32_16x16x32_bf16 v[156:159], v[52:55], a[236:239], v[156:159]
  s_waitcnt lgkmcnt(6)
  v_mfma_f32_16x16x32_bf16 v[160:163], v[56:59], a[224:227], v[160:163]
  ds_read_b64_tr_b16 v[48:49], v22 offset:560
  ds_read_b64_tr_b16 v[50:51], v22 offset:9008
  v_mfma_f32_16x16x32_bf16 v[164:167], v[56:59], a[228:231], v[164:167]
  v_mfma_f32_16x16x32_bf16 v[168:171], v[56:59], a[232:235], v[168:171]
  v_mfma_f32_16x16x32_bf16 v[172:175], v[56:59], a[236:239], v[172:175]
  s_waitcnt lgkmcnt(6)
  v_mfma_f32_16x16x32_bf16 v[64:67], v[60:63], a[240:243], v[64:67]
  ds_read_b64_tr_b16 v[52:53], v23 offset:512
  ds_read_b64_tr_b16 v[54:55], v23 offset:8960
  v_mfma_f32_16x16x32_bf16 v[68:71], v[60:63], a[244:247], v[68:71]
  v_mfma_f32_16x16x32_bf16 v[72:75], v[60:63], a[248:251], v[72:75]
  v_mfma_f32_16x16x32_bf16 v[76:79], v[60:63], a[252:255], v[76:79]
  v_mfma_f32_16x16x32_bf16 v[176:179], v[60:63], v[36:39], v[176:179]
  s_waitcnt lgkmcnt(6)
  v_mfma_f32_16x16x32_bf16 v[80:83], v[40:43], a[240:243], v[80:83]
  ds_read_b64_tr_b16 v[56:57], v23 offset:528
  ds_read_b64_tr_b16 v[58:59], v23 offset:8976
  v_mfma_f32_16x16x32_bf16 v[84:87], v[40:43], a[244:247], v[84:87]
  v_mfma_f32_16x16x32_bf16 v[88:91], v[40:43], a[248:251], v[88:91]
  v_mfma_f32_16x16x32_bf16 v[92:95], v[40:43], a[252:255], v[92:95]
  v_mfma_f32_16x16x32_bf16 v[180:183], v[40:43], v[36:39], v[180:183]
  s_waitcnt lgkmcnt(6)
  v_mfma_f32_16x16x32_bf16 v[96:99], v[44:47], a[240:243], v[96:99]
  ds_read_b64_tr_b16 v[60:61], v23 offset:544
  ds_read_b64_tr_b16 v[62:63], v23 offset:8992
  v_mfma_f32_16x16x32_bf16 v[100:103], v[44:47], a[244:247], v[100:103]
  v_mfma_f32_16x16x32_bf16 v[104:107], v[44:47], a[248:251], v[104:107]
  v_mfma_f32_16x16x32_bf16 v[108:111], v[44:47], a[252:255], v[108:111]
  v_mfma_f32_16x16x32_bf16 v[184:187], v[44:47], v[36:39], v[184:187]
  s_waitcnt lgkmcnt(6)
  v_mfma_f32_16x16x32_bf16 v[112:115], v[48:51], a[240:243], v[112:115]
  v_mfma_f32_16x16x32_bf16 v[116:119], v[48:51], a[244:247], v[116:119]
  v_mfma_f32_16x16x32_bf16 v[120:123], v[48:51], a[248:251], v[120:123]
  v_mfma_f32_16x16x32_bf16 v[124:127], v[48:51], a[252:255], v[124:127]
  s_waitcnt vmcnt(9)
  s_waitcnt lgkmcnt(0)
  s_barrier
  v_add_u32 v22, 67584, v20
  v_add_u32 v23, 67584, v21
  s_waitcnt vmcnt(8)
  v_xor_b32 v8, s101, v8
  v_xor_b32 v9, s101, v9
  v_xor_b32 v10, s101, v10
  v_xor_b32 v11, s101, v11
  v_or_b32 v8, v8, v9
  v_or_b32 v8, v8, v10
  v_or_b32 v8, v8, v11
  v_cmp_ne_u32 vcc, 0, v8
  s_cbranch_vccz pollok_13
  s_mov_b32 s14, 200000
pollspin_14:
  s_sleep 2
  s_mov_b32 s15, 23003136
  buffer_load_dwordx4 v[8:11], v4, s[52:55], s15 offen offset:0 sc1
  s_waitcnt vmcnt(0)
  v_xor_b32 v8, s101, v8
  v_xor_b32 v9, s101, v9
  v_xor_b32 v10, s101, v10
  v_xor_b32 v11, s101, v11
  v_or_b32 v8, v8, v9
  v_or_b32 v8, v8, v10
  v_or_b32 v8, v8, v11
  v_cmp_ne_u32 vcc, 0, v8
  s_cbranch_vccz pollok_13
  s_sub_u32 s14, s14, 1
  s_cmp_lg_u32 s14, 0
  s_cbranch_scc1 pollspin_14
pollok_13:
  ds_read_b64_tr_b16 v[40:41], v22 offset:0
  ds_read_b64_tr_b16 v[42:43], v22 offset:8448
  v_mfma_f32_16x16x32_bf16 v[188:191], v[48:51], v[36:39], v[188:191]
  v_lshlrev_b32 v5, 4, v1
  s_lshr_b32 s11, s6, 1
  v_mfma_f32_16x16x32_bf16 v[128:131], v[52:55], a[240:243], v[128:131]
  ds_read_b64_tr_b16 v[44:45], v22 offset:16
  ds_read_b64_tr_b16 v[46:47], v22 offset:8464
  v_mfma_f32_16x16x32_bf16 v[132:135], v[52:55], a[244:247], v[132:135]
  s_add_u32 s11, s11, 1
  s_mul_i32 s11, s11, 160
  s_mul_i32 s13, s60, 10
  v_mfma_f32_16x16x32_bf16 v[136:139], v[52:55], a[248:251], v[136:139]
  s_add_u32 s11, s11, s13
  s_and_b32 s12, s6, 1
  s_mul_i32 s13, s12, 5
  v_mfma_f32_16x16x32_bf16 v[140:143], v[52:55], a[252:255], v[140:143]
  v_mfma_f32_16x16x32_bf16 v[144:147], v[56:59], a[240:243], v[144:147]
  ds_read_b64_tr_b16 v[48:49], v22 offset:32
  ds_read_b64_tr_b16 v[50:51], v22 offset:8480
  v_mfma_f32_16x16x32_bf16 v[148:151], v[56:59], a[244:247], v[148:151]
  s_add_u32 s11, s11, s13
  s_lshl_b32 s11, s11, 14
  s_lshl_b32 s14, s61, 10
  v_mfma_f32_16x16x32_bf16 v[152:155], v[56:59], a[248:251], v[152:155]
  s_add_u32 s11, s11, s14
  s_sub_u32 s96, s11, 2048
  s_mul_i32 s13, s12, 15360
  v_mfma_f32_16x16x32_bf16 v[156:159], v[56:59], a[252:255], v[156:159]
  v_mfma_f32_16x16x32_bf16 v[160:163], v[60:63], a[240:243], v[160:163]
  ds_read_b64_tr_b16 v[52:53], v22 offset:48
  ds_read_b64_tr_b16 v[54:55], v22 offset:8496
  v_mfma_f32_16x16x32_bf16 v[164:167], v[60:63], a[244:247], v[164:167]
  s_add_u32 s13, s13, 0
  s_mul_i32 s14, s12, 15520
  s_add_u32 s14, s14, 30720
  v_mfma_f32_16x16x32_bf16 v[168:171], v[60:63], a[248:251], v[168:171]
  s_cmp_lt_u32 s6, 2
  s_cselect_b32 s97, s13, s14
  s_movk_i32 s13, 3072
  v_mfma_f32_16x16x32_bf16 v[172:175], v[60:63], a[252:255], v[172:175]
  s_waitcnt lgkmcnt(6)
  v_mfma_f32_16x16x32_bf16 v[64:67], v[40:43], v[192:195], v[64:67]
  ds_read_b64_tr_b16 v[56:57], v23 offset:0
  ds_read_b64_tr_b16 v[58:59], v23 offset:8448
  v_mfma_f32_16x16x32_bf16 v[68:71], v[40:43], v[196:199], v[68:71]
  s_cselect_b32 s98, s13, 3104
  s_add_u32 s14, s61, 0
  v_mfma_f32_16x16x32_bf16 v[72:75], v[40:43], v[200:203], v[72:75]
  s_cmp_ge_u32 s14, 2
  s_cselect_b32 s15, 0, 0x40000000
  v_mfma_f32_16x16x32_bf16 v[76:79], v[40:43], v[204:207], v[76:79]
  v_mfma_f32_16x16x32_bf16 v[176:179], v[40:43], v[36:39], v[176:179]
  s_or_b32 s99, s96, s15
  s_mul_i32 s15, s98, 0
  s_waitcnt lgkmcnt(6)
  v_mfma_f32_16x16x32_bf16 v[80:83], v[44:47], v[192:195], v[80:83]
  ds_read_b64_tr_b16 v[60:61], v23 offset:16
  ds_read_b64_tr_b16 v[62:63], v23 offset:8464
  v_mfma_f32_16x16x32_bf16 v[84:87], v[44:47], v[196:199], v[84:87]
  s_add_u32 s15, s15, s97
  s_add_u32 m0, s15, 0
  v_mfma_f32_16x16x32_bf16 v[88:91], v[44:47], v[200:203], v[88:91]
  s_add_u32 s14, s99, 0
  buffer_load_dwordx4 v5, s[52:55], s14 offen sc1 lds
  v_mfma_f32_16x16x32_bf16 v[92:95], v[44:47], v[204:207], v[92:95]
  v_mfma_f32_16x16x32_bf16 v[180:183], v[44:47], v[36:39], v[180:183]
  s_mul_i32 s15, s98, 1
  s_add_u32 s15, s15, s97
  s_waitcnt lgkmcnt(6)
  v_mfma_f32_16x16x32_bf16 v[96:99], v[48:51], v[192:195], v[96:99]
  ds_read_b64_tr_b16 v[40:41], v23 offset:32
  ds_read_b64_tr_b16 v[42:43], v23 offset:8480
  v_mfma_f32_16x16x32_bf16 v[100:103], v[48:51], v[196:199], v[100:103]
  s_add_u32 m0, s15, 0
  s_add_u32 s14, s99, 16384
  v_mfma_f32_16x16x32_bf16 v[104:107], v[48:51], v[200:203], v[104:107]
  buffer_load_dwordx4 v5, s[52:55], s14 offen sc1 lds
  v_mfma_f32_16x16x32_bf16 v[108:111], v[48:51], v[204:207], v[108:111]
  v_mfma_f32_16x16x32_bf16 v[184:187], v[48:51], v[36:39], v[184:187]
  s_mul_i32 s15, s98, 2
  s_add_u32 s15, s15, s97
  s_waitcnt lgkmcnt(6)
  v_mfma_f32_16x16x32_bf16 v[112:115], v[52:55], v[192:195], v[112:115]
  ds_read_b64_tr_b16 v[44:45], v22 offset:512
  ds_read_b64_tr_b16 v[46:47], v22 offset:8960
  v_mfma_f32_16x16x32_bf16 v[116:119], v[52:55], v[196:199], v[116:119]
  s_add_u32 m0, s15, 0
  s_add_u32 s14, s99, 32768
  v_mfma_f32_16x16x32_bf16 v[120:123], v[52:55], v[200:203], v[120:123]
  buffer_load_dwordx4 v5, s[52:55], s14 offen sc1 lds
  v_mfma_f32_16x16x32_bf16 v[124:127], v[52:55], v[204:207], v[124:127]
  v_mfma_f32_16x16x32_bf16 v[188:191], v[52:55], v[36:39], v[188:191]
  s_mul_i32 s15, s98, 3
  s_add_u32 s15, s15, s97
  s_waitcnt lgkmcnt(6)
  v_mfma_f32_16x16x32_bf16 v[128:131], v[56:59], v[192:195], v[128:131]
  ds_read_b64_tr_b16 v[48:49], v22 offset:528
  ds_read_b64_tr_b16 v[50:51], v22 offset:8976
  v_mfma_f32_16x16x32_bf16 v[132:135], v[56:59], v[196:199], v[132:135]
  s_add_u32 m0, s15, 0
  s_add_u32 s14, s99, 49152
  buffer_load_dwordx4 v5, s[52:55], s14 offen sc1 lds
  v_mfma_f32_16x16x32_bf16 v[136:139], v[56:59], v[200:203], v[136:139]
  s_mul_i32 s15, s98, 4
  s_add_u32 s15, s15, s97
  s_add_u32 m0, s15, 0
  v_mfma_f32_16x16x32_bf16 v[140:143], v[56:59], v[204:207], v[140:143]
  s_waitcnt lgkmcnt(6)
  v_mfma_f32_16x16x32_bf16 v[144:147], v[60:63], v[192:195], v[144:147]
  ds_read_b64_tr_b16 v[52:53], v22 offset:544
  ds_read_b64_tr_b16 v[54:55], v22 offset:8992
  v_mfma_f32_16x16x32_bf16 v[148:151], v[60:63], v[196:199], v[148:151]
  s_add_u32 s14, s99, 65536
  buffer_load_dwordx4 v5, s[52:55], s14 offen sc1 lds
  v_mfma_f32_16x16x32_bf16 v[152:155], v[60:63], v[200:203], v[152:155]
  s_add_u32 s14, s61, 1
  s_cmp_ge_u32 s14, 2
  s_cselect_b32 s15, 0, 0x40000000
  v_mfma_f32_16x16x32_bf16 v[156:159], v[60:63], v[204:207], v[156:159]
  s_waitcnt lgkmcnt(6)
  v_mfma_f32_16x16x32_bf16 v[160:163], v[40:43], v[192:195], v[160:163]
  ds_read_b64_tr_b16 v[56:57], v22 offset:560
  ds_read_b64_tr_b16 v[58:59], v22 offset:9008
  v_mfma_f32_16x16x32_bf16 v[164:167], v[40:43], v[196:199], v[164:167]
  s_or_b32 s99, s96, s15
  s_mul_i32 s15, s98, 0
  s_add_u32 s15, s15, s97
  v_mfma_f32_16x16x32_bf16 v[168:171], v[40:43], v[200:203], v[168:171]
  s_add_u32 m0, s15, 1024
  s_add_u32 s14, s99, 1024
  buffer_load_dwordx4 v5, s[52:55], s14 offen sc1 lds
  v_mfma_f32_16x16x32_bf16 v[172:175], v[40:43], v[204:207], v[172:175]
  s_waitcnt lgkmcnt(6)
  v_mfma_f32_16x16x32_bf16 v[64:67], v[44:47], v[208:211], v[64:67]
  ds_read_b64_tr_b16 v[60:61], v23 offset:512
  ds_read_b64_tr_b16 v[62:63], v23 offset:8960
  v_mfma_f32_16x16x32_bf16 v[68:71], v[44:47], v[212:215], v[68:71]
  s_mul_i32 s15, s98, 1
  s_add_u32 s15, s15, s97
  v_mfma_f32_16x16x32_bf16 v[72:75], v[44:47], v[216:219], v[72:75]
  s_add_u32 m0, s15, 1024
  s_add_u32 s14, s99, 17408
  v_mfma_f32_16x16x32_bf16 v[76:79], v[44:47], v[220:223], v[76:79]
  v_mfma_f32_16x16x32_bf16 v[176:179], v[44:47], v[36:39], v[176:179]
  buffer_load_dwordx4 v5, s[52:55], s14 offen sc1 lds
  s_waitcnt lgkmcnt(6)
  v_mfma_f32_16x16x32_bf16 v[80:83], v[48:51], v[208:211], v[80:83]
  ds_read_b64_tr_b16 v[40:41], v23 offset:528
  ds_read_b64_tr_b16 v[42:43], v23 offset:8976
  v_mfma_f32_16x16x32_bf16 v[84:87], v[48:51], v[212:215], v[84:87]
  s_mul_i32 s15, s98, 2
  s_add_u32 s15, s15, s97
  v_mfma_f32_16x16x32_bf16 v[88:91], v[48:51], v[216:219], v[88:91]
  s_add_u32 m0, s15, 1024
  s_add_u32 s14, s99, 33792
  v_mfma_f32_16x16x32_bf16 v[92:95], v[48:51], v[220:223], v[92:95]
  v_mfma_f32_16x16x32_bf16 v[180:183], v[48:51], v[36:39], v[180:183]
  buffer_load_dwordx4 v5, s[52:55], s14 offen sc1 lds
  s_waitcnt lgkmcnt(6)
  v_mfma_f32_16x16x32_bf16 v[96:99], v[52:55], v[208:211], v[96:99]
  ds_read_b64_tr_b16 v[44:45], v23 offset:544
  ds_read_b64_tr_b16 v[46:47], v23 offset:8992
  v_mfma_f32_16x16x32_bf16 v[100:103], v[52:55], v[212:215], v[100:103]
  s_mul_i32 s15, s98, 3
  s_add_u32 s15, s15, s97
  v_mfma_f32_16x16x32_bf16 v[104:107], v[52:55], v[216:219], v[104:107]
  s_add_u32 m0, s15, 1024
  s_add_u32 s14, s99, 50176
  v_mfma_f32_16x16x32_bf16 v[108:111], v[52:55], v[220:223], v[108:111]
  v_mfma_f32_16x16x32_bf16 v[184:187], v[52:55], v[36:39], v[184:187]
  buffer_load_dwordx4 v5, s[52:55], s14 offen sc1 lds
  s_waitcnt lgkmcnt(6)
  v_mfma_f32_16x16x32_bf16 v[112:115], v[56:59], v[208:211], v[112:115]
  v_mfma_f32_16x16x32_bf16 v[116:119], v[56:59], v[212:215], v[116:119]
  s_mul_i32 s15, s98, 4
  s_add_u32 s15, s15, s97
  v_mfma_f32_16x16x32_bf16 v[120:123], v[56:59], v[216:219], v[120:123]
  s_add_u32 m0, s15, 1024
  s_add_u32 s14, s99, 66560
  v_mfma_f32_16x16x32_bf16 v[124:127], v[56:59], v[220:223], v[124:127]
  s_waitcnt vmcnt(9)
  s_waitcnt lgkmcnt(0)
  s_barrier
  v_add_u32 v22, 101376, v20
  v_add_u32 v23, 101376, v21
  ds_read_b64_tr_b16 v[48:49], v22 offset:0
  ds_read_b64_tr_b16 v[50:51], v22 offset:8448
  v_mfma_f32_16x16x32_bf16 v[188:191], v[56:59], v[36:39], v[188:191]
  buffer_load_dwordx4 v5, s[52:55], s14 offen sc1 lds
  v_mfma_f32_16x16x32_bf16 v[128:131], v[60:63], v[208:211], v[128:131]
  ds_read_b64_tr_b16 v[52:53], v22 offset:16
  ds_read_b64_tr_b16 v[54:55], v22 offset:8464
  v_mfma_f32_16x16x32_bf16 v[132:135], v[60:63], v[212:215], v[132:135]
  s_add_u32 s14, s61, 2
  s_cmp_ge_u32 s14, 2
  s_cselect_b32 s15, 0, 0x40000000
  v_mfma_f32_16x16x32_bf16 v[136:139], v[60:63], v[216:219], v[136:139]
  s_or_b32 s99, s96, s15
  s_mul_i32 s15, s98, 0
  s_add_u32 s15, s15, s97
  v_mfma_f32_16x16x32_bf16 v[140:143], v[60:63], v[220:223], v[140:143]
  v_mfma_f32_16x16x32_bf16 v[144:147], v[40:43], v[208:211], v[144:147]
  ds_read_b64_tr_b16 v[56:57], v22 offset:32
  ds_read_b64_tr_b16 v[58:59], v22 offset:8480
  v_mfma_f32_16x16x32_bf16 v[148:151], v[40:43], v[212:215], v[148:151]
  s_add_u32 m0, s15, 2048
  s_add_u32 s14, s99, 2048
  buffer_load_dwordx4 v5, s[52:55], s14 offen sc1 lds
  v_mfma_f32_16x16x32_bf16 v[152:155], v[40:43], v[216:219], v[152:155]
  s_mul_i32 s15, s98, 1
  s_add_u32 s15, s15, s97
  s_add_u32 m0, s15, 2048
  v_mfma_f32_16x16x32_bf16 v[156:159], v[40:43], v[220:223], v[156:159]
  v_mfma_f32_16x16x32_bf16 v[160:163], v[44:47], v[208:211], v[160:163]
  ds_read_b64_tr_b16 v[60:61], v22 offset:48
  ds_read_b64_tr_b16 v[62:63], v22 offset:8496
  v_mfma_f32_16x16x32_bf16 v[164:167], v[44:47], v[212:215], v[164:167]
  s_add_u32 s14, s99, 18432
  buffer_load_dwordx4 v5, s[52:55], s14 offen sc1 lds
  v_mfma_f32_16x16x32_bf16 v[168:171], v[44:47], v[216:219], v[168:171]
  s_mul_i32 s15, s98, 2
  s_add_u32 s15, s15, s97
  s_add_u32 m0, s15, 2048
  v_mfma_f32_16x16x32_bf16 v[172:175], v[44:47], v[220:223], v[172:175]
  s_waitcnt lgkmcnt(6)
  v_mfma_f32_16x16x32_bf16 v[64:67], v[48:51], v[224:227], v[64:67]
  ds_read_b64_tr_b16 v[40:41], v23 offset:0
  ds_read_b64_tr_b16 v[42:43], v23 offset:8448
  v_mfma_f32_16x16x32_bf16 v[68:71], v[48:51], v[228:231], v[68:71]
  s_add_u32 s14, s99, 34816
  buffer_load_dwordx4 v5, s[52:55], s14 offen sc1 lds
  v_mfma_f32_16x16x32_bf16 v[72:75], v[48:51], v[232:235], v[72:75]
  s_mul_i32 s15, s98, 3
  s_add_u32 s15, s15, s97
  v_mfma_f32_16x16x32_bf16 v[76:79], v[48:51], v[236:239], v[76:79]
  v_mfma_f32_16x16x32_bf16 v[176:179], v[48:51], v[36:39], v[176:179]
  s_add_u32 m0, s15, 2048
  s_add_u32 s14, s99, 51200
  s_waitcnt lgkmcnt(6)
  v_mfma_f32_16x16x32_bf16 v[80:83], v[52:55], v[224:227], v[80:83]
  ds_read_b64_tr_b16 v[44:45], v23 offset:16
  ds_read_b64_tr_b16 v[46:47], v23 offset:8464
  v_mfma_f32_16x16x32_bf16 v[84:87], v[52:55], v[228:231], v[84:87]
  buffer_load_dwordx4 v5, s[52:55], s14 offen sc1 lds
  v_mfma_f32_16x16x32_bf16 v[88:91], v[52:55], v[232:235], v[88:91]
  s_mul_i32 s15, s98, 4
  s_add_u32 s15, s15, s97
  v_mfma_f32_16x16x32_bf16 v[92:95], v[52:55], v[236:239], v[92:95]
  v_mfma_f32_16x16x32_bf16 v[180:183], v[52:55], v[36:39], v[180:183]
  s_add_u32 m0, s15, 2048
  s_add_u32 s14, s99, 67584
  s_waitcnt lgkmcnt(6)
  v_mfma_f32_16x16x32_bf16 v[96:99], v[56:59], v[224:227], v[96:99]
  ds_read_b64_tr_b16 v[48:49], v23 offset:32
  ds_read_b64_tr_b16 v[50:51], v23 offset:8480
  v_mfma_f32_16x16x32_bf16 v[100:103], v[56:59], v[228:231], v[100:103]
  buffer_load_dwordx4 v5, s[52:55], s14 offen sc1 lds
  v_mfma_f32_16x16x32_bf16 v[104:107], v[56:59], v[232:235], v[104:107]
  s_mul_i32 s96, s60, 163840
  s_lshl_b32 s14, s61, 10
  v_mfma_f32_16x16x32_bf16 v[108:111], v[56:59], v[236:239], v[108:111]
  v_mfma_f32_16x16x32_bf16 v[184:187], v[56:59], v[36:39], v[184:187]
  s_add_u32 s96, s96, s14
  s_add_u32 s11, s6, 0
  s_waitcnt lgkmcnt(6)
  v_mfma_f32_16x16x32_bf16 v[112:115], v[60:63], v[224:227], v[112:115]
  ds_read_b64_tr_b16 v[52:53], v22 offset:512
  ds_read_b64_tr_b16 v[54:55], v22 offset:8960
  v_mfma_f32_16x16x32_bf16 v[116:119], v[60:63], v[228:231], v[116:119]
  s_lshl_b32 s12, s11, 10
  s_add_u32 s13, s12, 61760
  v_mfma_f32_16x16x32_bf16 v[120:123], v[60:63], v[232:235], v[120:123]
  s_add_u32 s14, s12, 150528
  s_cmp_lt_u32 s11, 5
  v_mfma_f32_16x16x32_bf16 v[124:127], v[60:63], v[236:239], v[124:127]
  v_mfma_f32_16x16x32_bf16 v[188:191], v[60:63], v[36:39], v[188:191]
  s_cselect_b32 s13, s13, s14
  s_cmp_lt_u32 s11, 10
  s_waitcnt lgkmcnt(6)
  v_mfma_f32_16x16x32_bf16 v[128:131], v[40:43], v[224:227], v[128:131]
  ds_read_b64_tr_b16 v[56:57], v22 offset:528
  ds_read_b64_tr_b16 v[58:59], v22 offset:8976
  v_mfma_f32_16x16x32_bf16 v[132:135], v[40:43], v[228:231], v[132:135]
  s_cselect_b32 s13, s13, 161792
  s_cselect_b32 s15, 0, 0x40000000
  s_mov_b32 m0, s13
  v_mfma_f32_16x16x32_bf16 v[136:139], v[40:43], v[232:235], v[136:139]
  s_lshl_b32 s12, s11, 14
  s_add_u32 s14, s96, s12
  s_or_b32 s14, s14, s15
  v_mfma_f32_16x16x32_bf16 v[140:143], v[40:43], v[236:239], v[140:143]
  s_waitcnt lgkmcnt(6)
  v_mfma_f32_16x16x32_bf16 v[144:147], v[44:47], v[224:227], v[144:147]
  ds_read_b64_tr_b16 v[60:61], v22 offset:544
  ds_read_b64_tr_b16 v[62:63], v22 offset:8992
  v_mfma_f32_16x16x32_bf16 v[148:151], v[44:47], v[228:231], v[148:151]
  buffer_load_dwordx4 v5, s[52:55], s14 offen sc1 lds
  v_mfma_f32_16x16x32_bf16 v[152:155], v[44:47], v[232:235], v[152:155]
  s_add_u32 s11, s6, 4
  s_lshl_b32 s12, s11, 10
  s_add_u32 s13, s12, 61760
  v_mfma_f32_16x16x32_bf16 v[156:159], v[44:47], v[236:239], v[156:159]
  s_waitcnt lgkmcnt(6)
  v_mfma_f32_16x16x32_bf16 v[160:163], v[48:51], v[224:227], v[160:163]
  ds_read_b64_tr_b16 v[40:41], v22 offset:560
  ds_read_b64_tr_b16 v[42:43], v22 offset:9008
  v_mfma_f32_16x16x32_bf16 v[164:167], v[48:51], v[228:231], v[164:167]
  s_add_u32 s14, s12, 150528
  s_cmp_lt_u32 s11, 5
  s_cselect_b32 s13, s13, s14
  v_mfma_f32_16x16x32_bf16 v[168:171], v[48:51], v[232:235], v[168:171]
  s_cmp_lt_u32 s11, 10
  s_cselect_b32 s13, s13, 161792
  s_cselect_b32 s15, 0, 0x40000000
  v_mfma_f32_16x16x32_bf16 v[172:175], v[48:51], v[236:239], v[172:175]
  s_waitcnt lgkmcnt(6)
  v_mfma_f32_16x16x32_bf16 v[64:67], v[52:55], v[240:243], v[64:67]
  ds_read_b64_tr_b16 v[44:45], v23 offset:512
  ds_read_b64_tr_b16 v[46:47], v23 offset:8960
  v_mfma_f32_16x16x32_bf16 v[68:71], v[52:55], v[244:247], v[68:71]
  s_mov_b32 m0, s13
  s_lshl_b32 s12, s11, 14
  v_mfma_f32_16x16x32_bf16 v[72:75], v[52:55], v[248:251], v[72:75]
  s_add_u32 s14, s96, s12
  s_or_b32 s14, s14, s15
  v_mfma_f32_16x16x32_bf16 v[76:79], v[52:55], v[252:255], v[76:79]
  v_mfma_f32_16x16x32_bf16 v[176:179], v[52:55], v[36:39], v[176:179]
  buffer_load_dwordx4 v5, s[52:55], s14 offen sc1 lds
  s_waitcnt lgkmcnt(6)
  v_mfma_f32_16x16x32_bf16 v[80:83], v[56:59], v[240:243], v[80:83]
  ds_read_b64_tr_b16 v[48:49], v23 offset:528
  ds_read_b64_tr_b16 v[50:51], v23 offset:8976
  v_mfma_f32_16x16x32_bf16 v[84:87], v[56:59], v[244:247], v[84:87]
  s_add_u32 s11, s6, 8
  s_lshl_b32 s12, s11, 10
  v_mfma_f32_16x16x32_bf16 v[88:91], v[56:59], v[248:251], v[88:91]
  s_add_u32 s13, s12, 61760
  s_add_u32 s14, s12, 150528
  v_mfma_f32_16x16x32_bf16 v[92:95], v[56:59], v[252:255], v[92:95]
  v_mfma_f32_16x16x32_bf16 v[180:183], v[56:59], v[36:39], v[180:183]
  s_cmp_lt_u32 s11, 5
  s_cselect_b32 s13, s13, s14
  s_waitcnt lgkmcnt(6)
  v_mfma_f32_16x16x32_bf16 v[96:99], v[60:63], v[240:243], v[96:99]
  ds_read_b64_tr_b16 v[52:53], v23 offset:544
  ds_read_b64_tr_b16 v[54:55], v23 offset:8992
  v_mfma_f32_16x16x32_bf16 v[100:103], v[60:63], v[244:247], v[100:103]
  s_cmp_lt_u32 s11, 10
  s_cselect_b32 s13, s13, 161792
  v_mfma_f32_16x16x32_bf16 v[104:107], v[60:63], v[248:251], v[104:107]
  s_cselect_b32 s15, 0, 0x40000000
  s_mov_b32 m0, s13
  v_mfma_f32_16x16x32_bf16 v[108:111], v[60:63], v[252:255], v[108:111]
  v_mfma_f32_16x16x32_bf16 v[184:187], v[60:63], v[36:39], v[184:187]
  s_lshl_b32 s12, s11, 14
  s_add_u32 s14, s96, s12
  s_waitcnt lgkmcnt(6)
  v_mfma_f32_16x16x32_bf16 v[112:115], v[40:43], v[240:243], v[112:115]
  v_mfma_f32_16x16x32_bf16 v[116:119], v[40:43], v[244:247], v[116:119]
  s_or_b32 s14, s14, s15
  buffer_load_dwordx4 v5, s[52:55], s14 offen sc1 lds
  v_mfma_f32_16x16x32_bf16 v[120:123], v[40:43], v[248:251], v[120:123]
  v_mfma_f32_16x16x32_bf16 v[124:127], v[40:43], v[252:255], v[124:127]
  v_mfma_f32_16x16x32_bf16 v[188:191], v[40:43], v[36:39], v[188:191]
  s_waitcnt lgkmcnt(4)
  v_mfma_f32_16x16x32_bf16 v[128:131], v[44:47], v[240:243], v[128:131]
  v_mfma_f32_16x16x32_bf16 v[132:135], v[44:47], v[244:247], v[132:135]
  v_mfma_f32_16x16x32_bf16 v[136:139], v[44:47], v[248:251], v[136:139]
  v_mfma_f32_16x16x32_bf16 v[140:143], v[44:47], v[252:255], v[140:143]
  s_waitcnt lgkmcnt(2)
  v_mfma_f32_16x16x32_bf16 v[144:147], v[48:51], v[240:243], v[144:147]
  v_mfma_f32_16x16x32_bf16 v[148:151], v[48:51], v[244:247], v[148:151]
  v_mfma_f32_16x16x32_bf16 v[152:155], v[48:51], v[248:251], v[152:155]
  v_mfma_f32_16x16x32_bf16 v[156:159], v[48:51], v[252:255], v[156:159]
  s_waitcnt lgkmcnt(0)
  v_mfma_f32_16x16x32_bf16 v[160:163], v[52:55], v[240:243], v[160:163]
  v_mfma_f32_16x16x32_bf16 v[164:167], v[52:55], v[244:247], v[164:167]
  v_mfma_f32_16x16x32_bf16 v[168:171], v[52:55], v[248:251], v[168:171]
  v_mfma_f32_16x16x32_bf16 v[172:175], v[52:55], v[252:255], v[172:175]
  s_nop 9
  s_mul_i32 s11, s8, 448
  s_add_u32 s11, s11, 136704
  s_mul_i32 s13, s7, 192
  s_add_u32 s14, s11, s13
  v_lshlrev_b32 v32, 4, v3
  v_add_u32 v33, s14, v32
  s_lshl_b32 s13, s7, 8
  s_sub_u32 s14, s11, s13
  s_add_u32 s14, s14, 256
  v_add_u32 v34, s14, v32
  s_mov_b64 exec, s[78:79]
  ds_write_b128 v33, v[176:179] offset:0
  ds_write_b128 v33, v[180:183] offset:64
  ds_write_b128 v33, v[184:187] offset:128
  ds_write_b128 v33, v[188:191] offset:192
  s_mov_b64 exec, -1
  s_waitcnt lgkmcnt(0)
  s_barrier
  ds_read_b128 v[176:179], v33 offset:0
  ds_read_b128 v[180:183], v33 offset:64
  ds_read_b128 v[184:187], v33 offset:128
  ds_read_b128 v[188:191], v33 offset:192
  ds_read_b128 v[40:43], v34 offset:0
  ds_read_b128 v[44:47], v34 offset:64
  ds_read_b128 v[48:51], v34 offset:128
  v_cmp_gt_u32 vcc, 32, v1
  s_nop 1
  v_cndmask_b32 v52, v29, v28, vcc
  v_mul_f32 v52, v52, v52
  v_cndmask_b32 v53, v31, v30, vcc
  v_mul_f32 v53, v53, v53
  v_lshrrev_b32 v54, 5, v1
  s_mov_b32 s11, 55296
  v_mul_lo_u32 v54, v54, s11
  v_lshl_add_u32 v54, v2, 4, v54
  v_and_b32 v56, 1, v3
  v_lshl_add_u32 v55, v56, 3, v54
  v_lshl_add_u32 v54, v56, 8, v54
  s_lshl_b32 s11, s9, 3
  s_lshl_b32 s12, s7, 2
  s_add_u32 s11, s11, s12
  s_mul_i32 s11, s11, 55296
  s_add_u32 s11, s11, 8388608
  s_mul_i32 s15, s10, 14
  s_mul_i32 s12, s8, 7
  s_add_u32 s15, s15, s12
  s_waitcnt lgkmcnt(0)
  v_pk_fma_f32 v[64:65], v[176:177], v[24:25], v[64:65] op_sel:[0,0,0] op_sel_hi:[1,0,1] neg_lo:[0,1,0] neg_hi:[0,1,0]
  v_pk_fma_f32 v[68:69], v[176:177], v[24:25], v[68:69] op_sel:[0,1,0] op_sel_hi:[1,1,1] neg_lo:[0,1,0] neg_hi:[0,1,0]
  v_pk_fma_f32 v[66:67], v[178:179], v[24:25], v[66:67] op_sel:[0,0,0] op_sel_hi:[1,0,1] neg_lo:[0,1,0] neg_hi:[0,1,0]
  v_pk_fma_f32 v[70:71], v[178:179], v[24:25], v[70:71] op_sel:[0,1,0] op_sel_hi:[1,1,1] neg_lo:[0,1,0] neg_hi:[0,1,0]
  v_pk_fma_f32 v[80:81], v[180:181], v[24:25], v[80:81] op_sel:[0,0,0] op_sel_hi:[1,0,1] neg_lo:[0,1,0] neg_hi:[0,1,0]
  v_pk_fma_f32 v[84:85], v[180:181], v[24:25], v[84:85] op_sel:[0,1,0] op_sel_hi:[1,1,1] neg_lo:[0,1,0] neg_hi:[0,1,0]
  v_pk_fma_f32 v[82:83], v[182:183], v[24:25], v[82:83] op_sel:[0,0,0] op_sel_hi:[1,0,1] neg_lo:[0,1,0] neg_hi:[0,1,0]
  v_pk_fma_f32 v[86:87], v[182:183], v[24:25], v[86:87] op_sel:[0,1,0] op_sel_hi:[1,1,1] neg_lo:[0,1,0] neg_hi:[0,1,0]
  v_permlane32_swap_b32 v64, v68
  v_permlane32_swap_b32 v65, v69
  v_permlane32_swap_b32 v66, v70
  v_permlane32_swap_b32 v67, v71
  v_permlane32_swap_b32 v80, v84
  v_permlane32_swap_b32 v81, v85
  v_permlane32_swap_b32 v82, v86
  v_permlane32_swap_b32 v83, v87
  v_pk_mul_f32 v[64:65], v[64:65], v[68:69]
  v_pk_mul_f32 v[66:67], v[66:67], v[70:71]
  v_pk_mul_f32 v[80:81], v[80:81], v[84:85]
  v_pk_mul_f32 v[82:83], v[82:83], v[86:87]
  v_pk_mul_f32 v[64:65], v[64:65], v[52:53] op_sel:[0,0] op_sel_hi:[1,0]
  v_pk_mul_f32 v[66:67], v[66:67], v[52:53] op_sel:[0,0] op_sel_hi:[1,0]
  v_pk_mul_f32 v[80:81], v[80:81], v[52:53] op_sel:[0,0] op_sel_hi:[1,0]
  v_pk_mul_f32 v[82:83], v[82:83], v[52:53] op_sel:[0,0] op_sel_hi:[1,0]
  v_cvt_pk_bf16_f32 v58, v64, v65
  v_cvt_pk_bf16_f32 v59, v66, v67
  v_cvt_pk_bf16_f32 v60, v80, v81
  v_cvt_pk_bf16_f32 v61, v82, v83
  s_mul_i32 s12, s7, 3
  s_add_u32 s12, s12, 0
  s_add_u32 s12, s12, s15
  s_add_u32 s13, s8, 0
  s_and_b32 s13, s13, 1
  s_mul_i32 s13, s13, 110592
  s_add_u32 s13, s13, s11
  s_lshl_b32 s14, s12, 8
  s_add_u32 s13, s13, s14
  s_nop 0
  v_permlane16_swap_b32 v58, v60
  v_permlane16_swap_b32 v59, v61
  v_add_u32 v57, s12, v56
  v_cmp_gt_u32 vcc, 216, v57
  s_nop 1
  v_cndmask_b32 v57, 0x40000000, v54, vcc
  buffer_store_dwordx4 v[58:61], v57, s[52:55], s13 offen sc1
  s_nop 1
  v_pk_fma_f32 v[96:97], v[184:185], v[24:25], v[96:97] op_sel:[0,0,0] op_sel_hi:[1,0,1] neg_lo:[0,1,0] neg_hi:[0,1,0]
  v_pk_fma_f32 v[100:101], v[184:185], v[24:25], v[100:101] op_sel:[0,1,0] op_sel_hi:[1,1,1] neg_lo:[0,1,0] neg_hi:[0,1,0]
  v_pk_fma_f32 v[98:99], v[186:187], v[24:25], v[98:99] op_sel:[0,0,0] op_sel_hi:[1,0,1] neg_lo:[0,1,0] neg_hi:[0,1,0]
  v_pk_fma_f32 v[102:103], v[186:187], v[24:25], v[102:103] op_sel:[0,1,0] op_sel_hi:[1,1,1] neg_lo:[0,1,0] neg_hi:[0,1,0]
  v_pk_fma_f32 v[112:113], v[188:189], v[24:25], v[112:113] op_sel:[0,0,0] op_sel_hi:[1,0,1] neg_lo:[0,1,0] neg_hi:[0,1,0]
  v_pk_fma_f32 v[116:117], v[188:189], v[24:25], v[116:117] op_sel:[0,1,0] op_sel_hi:[1,1,1] neg_lo:[0,1,0] neg_hi:[0,1,0]
  v_pk_fma_f32 v[114:115], v[190:191], v[24:25], v[114:115] op_sel:[0,0,0] op_sel_hi:[1,0,1] neg_lo:[0,1,0] neg_hi:[0,1,0]
  v_pk_fma_f32 v[118:119], v[190:191], v[24:25], v[118:119] op_sel:[0,1,0] op_sel_hi:[1,1,1] neg_lo:[0,1,0] neg_hi:[0,1,0]
  v_permlane32_swap_b32 v96, v100
  v_permlane32_swap_b32 v97, v101
  v_permlane32_swap_b32 v98, v102
  v_permlane32_swap_b32 v99, v103
  v_permlane32_swap_b32 v112, v116
  v_permlane32_swap_b32 v113, v117
  v_permlane32_swap_b32 v114, v118
  v_permlane32_swap_b32 v115, v119
  v_pk_mul_f32 v[96:97], v[96:97], v[100:101]
  v_pk_mul_f32 v[98:99], v[98:99], v[102:103]
  v_pk_mul_f32 v[112:113], v[112:113], v[116:117]
  v_pk_mul_f32 v[114:115], v[114:115], v[118:119]
  v_pk_mul_f32 v[96:97], v[96:97], v[52:53] op_sel:[0,0] op_sel_hi:[1,0]
  v_pk_mul_f32 v[98:99], v[98:99], v[52:53] op_sel:[0,0] op_sel_hi:[1,0]
  v_pk_mul_f32 v[112:113], v[112:113], v[52:53] op_sel:[0,0] op_sel_hi:[1,0]
  v_pk_mul_f32 v[114:115], v[114:115], v[52:53] op_sel:[0,0] op_sel_hi:[1,0]
  v_cvt_pk_bf16_f32 v58, v96, v97
  v_cvt_pk_bf16_f32 v59, v98, v99
  v_cvt_pk_bf16_f32 v60, v112, v113
  v_cvt_pk_bf16_f32 v61, v114, v115
  s_mul_i32 s12, s7, 3
  s_add_u32 s12, s12, 2
  s_add_u32 s12, s12, s15
  s_add_u32 s13, s8, 0
  s_and_b32 s13, s13, 1
  s_mul_i32 s13, s13, 110592
  s_add_u32 s13, s13, s11
  s_lshl_b32 s14, s12, 8
  s_add_u32 s13, s13, s14
  s_nop 0
  v_permlane16_swap_b32 v58, v60
  v_permlane16_swap_b32 v59, v61
  v_add_u32 v57, s12, v56
  v_cmp_gt_u32 vcc, 216, v57
  s_nop 1
  v_cndmask_b32 v57, 0x40000000, v54, vcc
  buffer_store_dwordx4 v[58:61], v57, s[52:55], s13 offen sc1
  s_nop 1
  v_pk_fma_f32 v[128:129], v[40:41], v[24:25], v[128:129] op_sel:[0,0,0] op_sel_hi:[1,0,1] neg_lo:[0,1,0] neg_hi:[0,1,0]
  v_pk_fma_f32 v[132:133], v[40:41], v[24:25], v[132:133] op_sel:[0,1,0] op_sel_hi:[1,1,1] neg_lo:[0,1,0] neg_hi:[0,1,0]
  v_pk_fma_f32 v[130:131], v[42:43], v[24:25], v[130:131] op_sel:[0,0,0] op_sel_hi:[1,0,1] neg_lo:[0,1,0] neg_hi:[0,1,0]
  v_pk_fma_f32 v[134:135], v[42:43], v[24:25], v[134:135] op_sel:[0,1,0] op_sel_hi:[1,1,1] neg_lo:[0,1,0] neg_hi:[0,1,0]
  v_pk_fma_f32 v[144:145], v[44:45], v[24:25], v[144:145] op_sel:[0,0,0] op_sel_hi:[1,0,1] neg_lo:[0,1,0] neg_hi:[0,1,0]
  v_pk_fma_f32 v[148:149], v[44:45], v[24:25], v[148:149] op_sel:[0,1,0] op_sel_hi:[1,1,1] neg_lo:[0,1,0] neg_hi:[0,1,0]
  v_pk_fma_f32 v[146:147], v[46:47], v[24:25], v[146:147] op_sel:[0,0,0] op_sel_hi:[1,0,1] neg_lo:[0,1,0] neg_hi:[0,1,0]
  v_pk_fma_f32 v[150:151], v[46:47], v[24:25], v[150:151] op_sel:[0,1,0] op_sel_hi:[1,1,1] neg_lo:[0,1,0] neg_hi:[0,1,0]
  v_permlane32_swap_b32 v128, v132
  v_permlane32_swap_b32 v129, v133
  v_permlane32_swap_b32 v130, v134
  v_permlane32_swap_b32 v131, v135
  v_permlane32_swap_b32 v144, v148
  v_permlane32_swap_b32 v145, v149
  v_permlane32_swap_b32 v146, v150
  v_permlane32_swap_b32 v147, v151
  v_pk_mul_f32 v[128:129], v[128:129], v[132:133]
  v_pk_mul_f32 v[130:131], v[130:131], v[134:135]
  v_pk_mul_f32 v[144:145], v[144:145], v[148:149]
  v_pk_mul_f32 v[146:147], v[146:147], v[150:151]
  v_pk_mul_f32 v[128:129], v[128:129], v[52:53] op_sel:[0,0] op_sel_hi:[1,0]
  v_pk_mul_f32 v[130:131], v[130:131], v[52:53] op_sel:[0,0] op_sel_hi:[1,0]
  v_pk_mul_f32 v[144:145], v[144:145], v[52:53] op_sel:[0,0] op_sel_hi:[1,0]
  v_pk_mul_f32 v[146:147], v[146:147], v[52:53] op_sel:[0,0] op_sel_hi:[1,0]
  v_cvt_pk_bf16_f32 v58, v128, v129
  v_cvt_pk_bf16_f32 v59, v130, v131
  v_cvt_pk_bf16_f32 v60, v144, v145
  v_cvt_pk_bf16_f32 v61, v146, v147
  s_lshl_b32 s12, s7, 2
  s_sub_u32 s12, 4, s12
  s_add_u32 s12, s12, s15
  s_add_u32 s13, s8, 0
  s_and_b32 s13, s13, 1
  s_mul_i32 s13, s13, 110592
  s_add_u32 s13, s13, s11
  s_lshl_b32 s14, s12, 8
  s_add_u32 s13, s13, s14
  s_nop 0
  v_permlane16_swap_b32 v58, v60
  v_permlane16_swap_b32 v59, v61
  v_add_u32 v57, s12, v56
  v_cmp_gt_u32 vcc, 216, v57
  s_nop 1
  v_cndmask_b32 v57, 0x40000000, v54, vcc
  buffer_store_dwordx4 v[58:61], v57, s[52:55], s13 offen sc1
  s_nop 1
  v_pk_fma_f32 v[160:161], v[48:49], v[24:25], v[160:161] op_sel:[0,0,0] op_sel_hi:[1,0,1] neg_lo:[0,1,0] neg_hi:[0,1,0]
  v_pk_fma_f32 v[164:165], v[48:49], v[24:25], v[164:165] op_sel:[0,1,0] op_sel_hi:[1,1,1] neg_lo:[0,1,0] neg_hi:[0,1,0]
  v_pk_fma_f32 v[162:163], v[50:51], v[24:25], v[162:163] op_sel:[0,0,0] op_sel_hi:[1,0,1] neg_lo:[0,1,0] neg_hi:[0,1,0]
  v_pk_fma_f32 v[166:167], v[50:51], v[24:25], v[166:167] op_sel:[0,1,0] op_sel_hi:[1,1,1] neg_lo:[0,1,0] neg_hi:[0,1,0]
  s_nop 1
  v_permlane32_swap_b32 v160, v164
  v_permlane32_swap_b32 v161, v165
  v_permlane32_swap_b32 v162, v166
  v_permlane32_swap_b32 v163, v167
  v_pk_mul_f32 v[160:161], v[160:161], v[164:165]
  v_pk_mul_f32 v[162:163], v[162:163], v[166:167]
  v_pk_mul_f32 v[160:161], v[160:161], v[52:53] op_sel:[0,0] op_sel_hi:[1,0]
  v_pk_mul_f32 v[162:163], v[162:163], v[52:53] op_sel:[0,0] op_sel_hi:[1,0]
  v_cvt_pk_bf16_f32 v58, v160, v161
  v_cvt_pk_bf16_f32 v59, v162, v163
  s_lshl_b32 s12, s7, 2
  s_sub_u32 s12, 6, s12
  s_add_u32 s12, s12, s15
  s_add_u32 s13, s8, 0
  s_and_b32 s13, s13, 1
  s_mul_i32 s13, s13, 110592
  s_add_u32 s13, s13, s11
  s_lshl_b32 s14, s12, 8
  s_add_u32 s13, s13, s14
  s_cmp_lt_u32 s12, 216
  s_cselect_b32 s14, 0, 0x40000000
  v_or_b32 v57, s14, v55
  buffer_store_dwordx2 v[58:59], v57, s[52:55], s13 offen sc1
  s_nop 1
  v_pk_fma_f32 v[72:73], v[176:177], v[26:27], v[72:73] op_sel:[0,0,0] op_sel_hi:[1,0,1] neg_lo:[0,1,0] neg_hi:[0,1,0]
  v_pk_fma_f32 v[76:77], v[176:177], v[26:27], v[76:77] op_sel:[0,1,0] op_sel_hi:[1,1,1] neg_lo:[0,1,0] neg_hi:[0,1,0]
  v_pk_fma_f32 v[74:75], v[178:179], v[26:27], v[74:75] op_sel:[0,0,0] op_sel_hi:[1,0,1] neg_lo:[0,1,0] neg_hi:[0,1,0]
  v_pk_fma_f32 v[78:79], v[178:179], v[26:27], v[78:79] op_sel:[0,1,0] op_sel_hi:[1,1,1] neg_lo:[0,1,0] neg_hi:[0,1,0]
  v_pk_fma_f32 v[88:89], v[180:181], v[26:27], v[88:89] op_sel:[0,0,0] op_sel_hi:[1,0,1] neg_lo:[0,1,0] neg_hi:[0,1,0]
  v_pk_fma_f32 v[92:93], v[180:181], v[26:27], v[92:93] op_sel:[0,1,0] op_sel_hi:[1,1,1] neg_lo:[0,1,0] neg_hi:[0,1,0]
  v_pk_fma_f32 v[90:91], v[182:183], v[26:27], v[90:91] op_sel:[0,0,0] op_sel_hi:[1,0,1] neg_lo:[0,1,0] neg_hi:[0,1,0]
  v_pk_fma_f32 v[94:95], v[182:183], v[26:27], v[94:95] op_sel:[0,1,0] op_sel_hi:[1,1,1] neg_lo:[0,1,0] neg_hi:[0,1,0]
  v_permlane32_swap_b32 v72, v76
  v_permlane32_swap_b32 v73, v77
  v_permlane32_swap_b32 v74, v78
  v_permlane32_swap_b32 v75, v79
  v_permlane32_swap_b32 v88, v92
  v_permlane32_swap_b32 v89, v93
  v_permlane32_swap_b32 v90, v94
  v_permlane32_swap_b32 v91, v95
  v_pk_mul_f32 v[72:73], v[72:73], v[76:77]
  v_pk_mul_f32 v[74:75], v[74:75], v[78:79]
  v_pk_mul_f32 v[88:89], v[88:89], v[92:93]
  v_pk_mul_f32 v[90:91], v[90:91], v[94:95]
  v_pk_mul_f32 v[72:73], v[72:73], v[52:53] op_sel:[0,1] op_sel_hi:[1,1]
  v_pk_mul_f32 v[74:75], v[74:75], v[52:53] op_sel:[0,1] op_sel_hi:[1,1]
  v_pk_mul_f32 v[88:89], v[88:89], v[52:53] op_sel:[0,1] op_sel_hi:[1,1]
  v_pk_mul_f32 v[90:91], v[90:91], v[52:53] op_sel:[0,1] op_sel_hi:[1,1]
  v_cvt_pk_bf16_f32 v58, v72, v73
  v_cvt_pk_bf16_f32 v59, v74, v75
  v_cvt_pk_bf16_f32 v60, v88, v89
  v_cvt_pk_bf16_f32 v61, v90, v91
  s_mul_i32 s12, s7, 3
  s_add_u32 s12, s12, 0
  s_add_u32 s12, s12, s15
  s_add_u32 s13, s8, 1
  s_and_b32 s13, s13, 1
  s_mul_i32 s13, s13, 110592
  s_add_u32 s13, s13, s11
  s_lshl_b32 s14, s12, 8
  s_add_u32 s13, s13, s14
  s_nop 0
  v_permlane16_swap_b32 v58, v60
  v_permlane16_swap_b32 v59, v61
  v_add_u32 v57, s12, v56
  v_cmp_gt_u32 vcc, 216, v57
  s_nop 1
  v_cndmask_b32 v57, 0x40000000, v54, vcc
  buffer_store_dwordx4 v[58:61], v57, s[52:55], s13 offen sc1
  s_nop 1
  v_pk_fma_f32 v[104:105], v[184:185], v[26:27], v[104:105] op_sel:[0,0,0] op_sel_hi:[1,0,1] neg_lo:[0,1,0] neg_hi:[0,1,0]
  v_pk_fma_f32 v[108:109], v[184:185], v[26:27], v[108:109] op_sel:[0,1,0] op_sel_hi:[1,1,1] neg_lo:[0,1,0] neg_hi:[0,1,0]
  v_pk_fma_f32 v[106:107], v[186:187], v[26:27], v[106:107] op_sel:[0,0,0] op_sel_hi:[1,0,1] neg_lo:[0,1,0] neg_hi:[0,1,0]
  v_pk_fma_f32 v[110:111], v[186:187], v[26:27], v[110:111] op_sel:[0,1,0] op_sel_hi:[1,1,1] neg_lo:[0,1,0] neg_hi:[0,1,0]
  v_pk_fma_f32 v[120:121], v[188:189], v[26:27], v[120:121] op_sel:[0,0,0] op_sel_hi:[1,0,1] neg_lo:[0,1,0] neg_hi:[0,1,0]
  v_pk_fma_f32 v[124:125], v[188:189], v[26:27], v[124:125] op_sel:[0,1,0] op_sel_hi:[1,1,1] neg_lo:[0,1,0] neg_hi:[0,1,0]
  v_pk_fma_f32 v[122:123], v[190:191], v[26:27], v[122:123] op_sel:[0,0,0] op_sel_hi:[1,0,1] neg_lo:[0,1,0] neg_hi:[0,1,0]
  v_pk_fma_f32 v[126:127], v[190:191], v[26:27], v[126:127] op_sel:[0,1,0] op_sel_hi:[1,1,1] neg_lo:[0,1,0] neg_hi:[0,1,0]
  v_permlane32_swap_b32 v104, v108
  v_permlane32_swap_b32 v105, v109
  v_permlane32_swap_b32 v106, v110
  v_permlane32_swap_b32 v107, v111
  v_permlane32_swap_b32 v120, v124
  v_permlane32_swap_b32 v121, v125
  v_permlane32_swap_b32 v122, v126
  v_permlane32_swap_b32 v123, v127
  v_pk_mul_f32 v[104:105], v[104:105], v[108:109]
  v_pk_mul_f32 v[106:107], v[106:107], v[110:111]
  v_pk_mul_f32 v[120:121], v[120:121], v[124:125]
  v_pk_mul_f32 v[122:123], v[122:123], v[126:127]
  v_pk_mul_f32 v[104:105], v[104:105], v[52:53] op_sel:[0,1] op_sel_hi:[1,1]
  v_pk_mul_f32 v[106:107], v[106:107], v[52:53] op_sel:[0,1] op_sel_hi:[1,1]
  v_pk_mul_f32 v[120:121], v[120:121], v[52:53] op_sel:[0,1] op_sel_hi:[1,1]
  v_pk_mul_f32 v[122:123], v[122:123], v[52:53] op_sel:[0,1] op_sel_hi:[1,1]
  v_cvt_pk_bf16_f32 v58, v104, v105
  v_cvt_pk_bf16_f32 v59, v106, v107
  v_cvt_pk_bf16_f32 v60, v120, v121
  v_cvt_pk_bf16_f32 v61, v122, v123
  s_mul_i32 s12, s7, 3
  s_add_u32 s12, s12, 2
  s_add_u32 s12, s12, s15
  s_add_u32 s13, s8, 1
  s_and_b32 s13, s13, 1
  s_mul_i32 s13, s13, 110592
  s_add_u32 s13, s13, s11
  s_lshl_b32 s14, s12, 8
  s_add_u32 s13, s13, s14
  s_nop 0
  v_permlane16_swap_b32 v58, v60
  v_permlane16_swap_b32 v59, v61
  v_add_u32 v57, s12, v56
  v_cmp_gt_u32 vcc, 216, v57
  s_nop 1
  v_cndmask_b32 v57, 0x40000000, v54, vcc
  buffer_store_dwordx4 v[58:61], v57, s[52:55], s13 offen sc1
  s_nop 1
  v_pk_fma_f32 v[136:137], v[40:41], v[26:27], v[136:137] op_sel:[0,0,0] op_sel_hi:[1,0,1] neg_lo:[0,1,0] neg_hi:[0,1,0]
  v_pk_fma_f32 v[140:141], v[40:41], v[26:27], v[140:141] op_sel:[0,1,0] op_sel_hi:[1,1,1] neg_lo:[0,1,0] neg_hi:[0,1,0]
  v_pk_fma_f32 v[138:139], v[42:43], v[26:27], v[138:139] op_sel:[0,0,0] op_sel_hi:[1,0,1] neg_lo:[0,1,0] neg_hi:[0,1,0]
  v_pk_fma_f32 v[142:143], v[42:43], v[26:27], v[142:143] op_sel:[0,1,0] op_sel_hi:[1,1,1] neg_lo:[0,1,0] neg_hi:[0,1,0]
  v_pk_fma_f32 v[152:153], v[44:45], v[26:27], v[152:153] op_sel:[0,0,0] op_sel_hi:[1,0,1] neg_lo:[0,1,0] neg_hi:[0,1,0]
  v_pk_fma_f32 v[156:157], v[44:45], v[26:27], v[156:157] op_sel:[0,1,0] op_sel_hi:[1,1,1] neg_lo:[0,1,0] neg_hi:[0,1,0]
  v_pk_fma_f32 v[154:155], v[46:47], v[26:27], v[154:155] op_sel:[0,0,0] op_sel_hi:[1,0,1] neg_lo:[0,1,0] neg_hi:[0,1,0]
  v_pk_fma_f32 v[158:159], v[46:47], v[26:27], v[158:159] op_sel:[0,1,0] op_sel_hi:[1,1,1] neg_lo:[0,1,0] neg_hi:[0,1,0]
  v_permlane32_swap_b32 v136, v140
  v_permlane32_swap_b32 v137, v141
  v_permlane32_swap_b32 v138, v142
  v_permlane32_swap_b32 v139, v143
  v_permlane32_swap_b32 v152, v156
  v_permlane32_swap_b32 v153, v157
  v_permlane32_swap_b32 v154, v158
  v_permlane32_swap_b32 v155, v159
  v_pk_mul_f32 v[136:137], v[136:137], v[140:141]
  v_pk_mul_f32 v[138:139], v[138:139], v[142:143]
  v_pk_mul_f32 v[152:153], v[152:153], v[156:157]
  v_pk_mul_f32 v[154:155], v[154:155], v[158:159]
  v_pk_mul_f32 v[136:137], v[136:137], v[52:53] op_sel:[0,1] op_sel_hi:[1,1]
  v_pk_mul_f32 v[138:139], v[138:139], v[52:53] op_sel:[0,1] op_sel_hi:[1,1]
  v_pk_mul_f32 v[152:153], v[152:153], v[52:53] op_sel:[0,1] op_sel_hi:[1,1]
  v_pk_mul_f32 v[154:155], v[154:155], v[52:53] op_sel:[0,1] op_sel_hi:[1,1]
  v_cvt_pk_bf16_f32 v58, v136, v137
  v_cvt_pk_bf16_f32 v59, v138, v139
  v_cvt_pk_bf16_f32 v60, v152, v153
  v_cvt_pk_bf16_f32 v61, v154, v155
  s_lshl_b32 s12, s7, 2
  s_sub_u32 s12, 4, s12
  s_add_u32 s12, s12, s15
  s_add_u32 s13, s8, 1
  s_and_b32 s13, s13, 1
  s_mul_i32 s13, s13, 110592
  s_add_u32 s13, s13, s11
  s_lshl_b32 s14, s12, 8
  s_add_u32 s13, s13, s14
  s_nop 0
  v_permlane16_swap_b32 v58, v60
  v_permlane16_swap_b32 v59, v61
  v_add_u32 v57, s12, v56
  v_cmp_gt_u32 vcc, 216, v57
  s_nop 1
  v_cndmask_b32 v57, 0x40000000, v54, vcc
  buffer_store_dwordx4 v[58:61], v57, s[52:55], s13 offen sc1
  s_nop 1
  v_pk_fma_f32 v[168:169], v[48:49], v[26:27], v[168:169] op_sel:[0,0,0] op_sel_hi:[1,0,1] neg_lo:[0,1,0] neg_hi:[0,1,0]
  v_pk_fma_f32 v[172:173], v[48:49], v[26:27], v[172:173] op_sel:[0,1,0] op_sel_hi:[1,1,1] neg_lo:[0,1,0] neg_hi:[0,1,0]
  v_pk_fma_f32 v[170:171], v[50:51], v[26:27], v[170:171] op_sel:[0,0,0] op_sel_hi:[1,0,1] neg_lo:[0,1,0] neg_hi:[0,1,0]
  v_pk_fma_f32 v[174:175], v[50:51], v[26:27], v[174:175] op_sel:[0,1,0] op_sel_hi:[1,1,1] neg_lo:[0,1,0] neg_hi:[0,1,0]
  s_nop 1
  v_permlane32_swap_b32 v168, v172
  v_permlane32_swap_b32 v169, v173
  v_permlane32_swap_b32 v170, v174
  v_permlane32_swap_b32 v171, v175
  v_pk_mul_f32 v[168:169], v[168:169], v[172:173]
  v_pk_mul_f32 v[170:171], v[170:171], v[174:175]
  v_pk_mul_f32 v[168:169], v[168:169], v[52:53] op_sel:[0,1] op_sel_hi:[1,1]
  v_pk_mul_f32 v[170:171], v[170:171], v[52:53] op_sel:[0,1] op_sel_hi:[1,1]
  v_cvt_pk_bf16_f32 v58, v168, v169
  v_cvt_pk_bf16_f32 v59, v170, v171
  s_lshl_b32 s12, s7, 2
  s_sub_u32 s12, 6, s12
  s_add_u32 s12, s12, s15
  s_add_u32 s13, s8, 1
  s_and_b32 s13, s13, 1
  s_mul_i32 s13, s13, 110592
  s_add_u32 s13, s13, s11
  s_lshl_b32 s14, s12, 8
  s_add_u32 s13, s13, s14
  s_cmp_lt_u32 s12, 216
  s_cselect_b32 s14, 0, 0x40000000
  v_or_b32 v57, s14, v55
  buffer_store_dwordx2 v[58:59], v57, s[52:55], s13 offen sc1
  s_nop 1
  s_lshr_b32 s11, s4, 1
  s_lshl_b32 s11, s11, 3
  s_and_b32 s12, s5, 7
  s_add_u32 s14, s11, s12
  s_and_b32 s11, s4, 1
  s_lshl_b32 s11, s11, 2
  s_lshr_b32 s12, s5, 3
  s_add_u32 s15, s11, s12
  v_lshlrev_b32 v244, 4, v1
  s_mul_i32 s40, s14, 221184
  s_add_u32 s40, s40, 8388608
  s_lshl_b32 s11, s6, 10
  s_add_u32 s40, s40, s11
  s_mul_i32 s41, s14, 81920
  s_add_u32 s41, s41, 16777216
  s_add_u32 s41, s41, s11
  s_mul_i32 s42, s6, 40
  s_mul_i32 s11, s15, 5
  s_add_u32 s42, s42, s11
  s_lshl_b32 s42, s42, 10
  s_add_u32 s42, s42, 19922944
  s_lshl_b32 s11, s14, 6
  s_lshr_b32 s12, s6, 1
  s_lshl_b32 s12, s12, 5
  s_add_u32 s11, s11, s12
  s_and_b32 s12, s6, 1
  s_add_u32 s11, s11, s12
  s_mul_i32 s11, s11, 1280
  s_mul_i32 s12, s15, 160
  s_add_u32 s43, s11, s12
  s_lshr_b32 s44, s14, 1
  v_lshrrev_b32 v17, 5, v1
  v_and_b32 v18, 31, v1
  v_mov_b32 v21, 0
  v_cmp_gt_u32 vcc, 32, v1
  v_mov_b32 v22, 0x3f80
  s_nop 0
  v_cndmask_b32 v22, 0, v22, vcc
  v_accvgpr_write_b32 a100, v21
  v_accvgpr_write_b32 a101, v21
  v_accvgpr_write_b32 a102, v22
  v_accvgpr_write_b32 a103, v21
  v_accvgpr_write_b32 a108, v21
  v_accvgpr_write_b32 a109, v21
  v_accvgpr_write_b32 a110, v22
  v_accvgpr_write_b32 a111, v21
  v_lshlrev_b32 v21, 3, v0
  v_mov_b32 v22, 0x3f803f80
  v_mov_b32 v23, 0x3f803f80
  v_add_u32 v26, 143520, v21
  v_add_u32 v27, 151552, v21
  ds_write_b64 v26, v[22:23]
  ds_write_b64 v26, v[22:23] offset:4000
  s_lshl_b32 s13, s61, 7
  s_sub_u32 s13, 256, s13
  v_mov_b32 v24, 0xf149
  v_mov_b32 v25, 0
  v_cmp_gt_i32 vcc, s13, v0
  s_nop 1
  v_cndmask_b32 v24, 0, v24, vcc
  ds_write_b64 v27, v[24:25]
  v_cmp_gt_u32 vcc, 128, v0
  v_mov_b32 v28, 0
  v_mov_b32 v29, 0
  s_and_saveexec_b64 s[72:73], vcc
  ds_write_b64 v26, v[22:23] offset:2048
  ds_write_b64 v26, v[22:23] offset:6048
  ds_write_b64 v27, v[28:29] offset:2048
  s_mov_b64 exec, s[72:73]
  v_lshlrev_b32 v21, 2, v17
  v_mov_b32 v23, 0xf149f2ca
  v_add_u32 v22, 0, v21
  v_cmp_gt_u32 vcc, v22, v18
  s_nop 1
  v_cndmask_b32 v176, v23, 0, vcc
  v_cndmask_b32 v192, 0, v23, vcc
  v_add_u32 v22, 1, v21
  v_cmp_gt_u32 vcc, v22, v18
  s_nop 1
  v_cndmask_b32 v177, v23, 0, vcc
  v_cndmask_b32 v193, 0, v23, vcc
  v_add_u32 v22, 2, v21
  v_cmp_gt_u32 vcc, v22, v18
  s_nop 1
  v_cndmask_b32 v178, v23, 0, vcc
  v_cndmask_b32 v194, 0, v23, vcc
  v_add_u32 v22, 3, v21
  v_cmp_gt_u32 vcc, v22, v18
  s_nop 1
  v_cndmask_b32 v179, v23, 0, vcc
  v_cndmask_b32 v195, 0, v23, vcc
  v_add_u32 v22, 8, v21
  v_cmp_gt_u32 vcc, v22, v18
  s_nop 1
  v_cndmask_b32 v180, v23, 0, vcc
  v_cndmask_b32 v196, 0, v23, vcc
  v_add_u32 v22, 9, v21
  v_cmp_gt_u32 vcc, v22, v18
  s_nop 1
  v_cndmask_b32 v181, v23, 0, vcc
  v_cndmask_b32 v197, 0, v23, vcc
  v_add_u32 v22, 10, v21
  v_cmp_gt_u32 vcc, v22, v18
  s_nop 1
  v_cndmask_b32 v182, v23, 0, vcc
  v_cndmask_b32 v198, 0, v23, vcc
  v_add_u32 v22, 11, v21
  v_cmp_gt_u32 vcc, v22, v18
  s_nop 1
  v_cndmask_b32 v183, v23, 0, vcc
  v_cndmask_b32 v199, 0, v23, vcc
  v_add_u32 v22, 16, v21
  v_cmp_gt_u32 vcc, v22, v18
  s_nop 1
  v_cndmask_b32 v184, v23, 0, vcc
  v_cndmask_b32 v200, 0, v23, vcc
  v_add_u32 v22, 17, v21
  v_cmp_gt_u32 vcc, v22, v18
  s_nop 1
  v_cndmask_b32 v185, v23, 0, vcc
  v_cndmask_b32 v201, 0, v23, vcc
  v_add_u32 v22, 18, v21
  v_cmp_gt_u32 vcc, v22, v18
  s_nop 1
  v_cndmask_b32 v186, v23, 0, vcc
  v_cndmask_b32 v202, 0, v23, vcc
  v_add_u32 v22, 19, v21
  v_cmp_gt_u32 vcc, v22, v18
  s_nop 1
  v_cndmask_b32 v187, v23, 0, vcc
  v_cndmask_b32 v203, 0, v23, vcc
  v_add_u32 v22, 24, v21
  v_cmp_gt_u32 vcc, v22, v18
  s_nop 1
  v_cndmask_b32 v188, v23, 0, vcc
  v_cndmask_b32 v204, 0, v23, vcc
  v_add_u32 v22, 25, v21
  v_cmp_gt_u32 vcc, v22, v18
  s_nop 1
  v_cndmask_b32 v189, v23, 0, vcc
  v_cndmask_b32 v205, 0, v23, vcc
  v_add_u32 v22, 26, v21
  v_cmp_gt_u32 vcc, v22, v18
  s_nop 1
  v_cndmask_b32 v190, v23, 0, vcc
  v_cndmask_b32 v206, 0, v23, vcc
  v_add_u32 v22, 27, v21
  v_cmp_gt_u32 vcc, v22, v18
  s_nop 1
  v_cndmask_b32 v191, v23, 0, vcc
  v_cndmask_b32 v207, 0, v23, vcc
  v_lshlrev_b32 v245, 4, v1
  s_mov_b32 s15, 23003136
  buffer_load_dwordx4 v[208:211], v245, s[52:55], s15 offen offset:0 sc1
  buffer_load_dwordx4 v[212:215], v245, s[52:55], s15 offen offset:1024 sc1
  buffer_load_dwordx4 v[216:219], v245, s[52:55], s15 offen offset:2048 sc1
  buffer_load_dwordx4 v[220:223], v245, s[52:55], s15 offen offset:3072 sc1
  s_lshr_b32 s11, s4, 1
  s_lshl_b32 s11, s11, 10
  s_add_u32 s11, s11, 4096
  v_lshlrev_b32 v246, 4, v1
  v_add_u32 v246, s11, v246
  s_waitcnt vmcnt(12)
  s_waitcnt lgkmcnt(0)
  s_barrier
  s_cmp_eq_u32 s62, 0
  s_mov_b32 s11, 61760
  s_cselect_b32 s11, s11, 155648
  s_lshl_b32 s12, s63, 9
  s_add_u32 s11, s11, s12
  v_lshlrev_b32 v20, 3, v18
  v_add_u32 v20, s11, v20
  v_lshl_add_u32 v19, v17, 11, v20
  ds_read_b64 a[96:97], v19 offset:0
  ds_read_b64 a[98:99], v19 offset:1024
  ds_read_b64 a[104:105], v19 offset:256
  ds_read_b64 a[106:107], v19 offset:1280
  s_mov_b32 exec_hi, 0
  ds_read_b64 a[100:101], v20 offset:4096
  ds_read_b64 a[108:109], v20 offset:4352
  s_mov_b64 exec, -1
  s_mul_i32 s11, s62, 15360
  s_lshl_b32 s12, s63, 9
  s_add_u32 s11, s11, s12
  v_mul_u32_u24 v19, 6144, v17
  v_lshl_add_u32 v19, v18, 3, v19
  v_add_u32 v19, s11, v19
  v_lshlrev_b32 v20, 3, v18
  v_add_u32 v22, s11, v20
  s_add_u32 s13, s12, 151552
  v_add_u32 v20, s13, v20
  v_and_b32 v24, 1, v3
  v_and_b32 v23, 3, v2
  v_lshl_add_u32 v24, v24, 2, v23
  s_movk_i32 s14, 3104
  v_mul_lo_u32 v25, v24, s14
  s_mul_i32 s14, s62, 15520
  s_add_u32 s14, s14, 30720
  v_add_u32 v25, s14, v25
  s_mul_i32 s14, s62, 4000
  s_add_u32 s14, s14, 143520
  v_mov_b32 v26, s14
  v_cmp_gt_u32 vcc, 5, v24
  s_nop 1
  v_cndmask_b32 v25, v26, v25, vcc
  v_lshrrev_b32 v23, 2, v2
  v_lshl_add_u32 v23, v17, 2, v23
  v_lshl_add_u32 v21, v23, 3, v25
  v_add_u32 v21, s12, v21
  v_mov_b32 v27, 0xf149f2ca
  ds_read_b64 a[0:1], v19 offset:0
  ds_read_b64 a[2:3], v19 offset:3072
  ds_read_b64 a[4:5], v22 offset:12288
  ds_read_b64 a[6:7], v20 offset:0
  ds_read_b64 a[8:9], v19 offset:256
  ds_read_b64 a[10:11], v19 offset:3328
  ds_read_b64 a[12:13], v22 offset:12544
  ds_read_b64 a[14:15], v20 offset:256
  ds_read_b64 a[16:17], v19 offset:512
  ds_read_b64 a[18:19], v19 offset:3584
  ds_read_b64 a[20:21], v22 offset:12800
  ds_read_b64 a[22:23], v20 offset:512
  s_waitcnt lgkmcnt(8)
  v_mfma_f32_32x32x16_bf16 v[80:95], a[0:3], a[96:99], v[176:191]
  ds_read_b64 a[24:25], v19 offset:768
  ds_read_b64 a[26:27], v19 offset:3840
  ds_read_b64 a[28:29], v22 offset:13056
  ds_read_b64 a[30:31], v20 offset:768
  v_mfma_f32_32x32x16_bf16 v[80:95], a[4:7], a[100:103], v[80:95]
  s_waitcnt lgkmcnt(8)
  v_mfma_f32_32x32x16_bf16 v[48:63], a[8:11], a[96:99], 0
  ds_read_b64 a[32:33], v19 offset:1024
  ds_read_b64 a[34:35], v19 offset:4096
  ds_read_b64 a[36:37], v22 offset:13312
  ds_read_b64 a[38:39], v20 offset:1024
  v_mfma_f32_32x32x16_bf16 v[48:63], a[12:15], a[100:103], v[48:63]
  s_waitcnt lgkmcnt(8)
  v_mfma_f32_32x32x16_bf16 v[64:79], a[16:19], a[96:99], 0
  ds_read_b64 a[40:41], v19 offset:1280
  ds_read_b64 a[42:43], v19 offset:4352
  ds_read_b64 a[44:45], v22 offset:13568
  ds_read_b64 a[46:47], v20 offset:1280
  v_mfma_f32_32x32x16_bf16 v[64:79], a[20:23], a[100:103], v[64:79]
  v_max3_f32 v27, v80, v81, v27
  v_max3_f32 v27, v82, v83, v27
  v_max3_f32 v27, v84, v85, v27
  v_max3_f32 v27, v86, v87, v27
  v_max3_f32 v27, v88, v89, v27
  v_max3_f32 v27, v90, v91, v27
  v_max3_f32 v27, v92, v93, v27
  v_max3_f32 v27, v94, v95, v27
  s_waitcnt lgkmcnt(8)
  v_mfma_f32_32x32x16_bf16 v[32:47], a[24:27], a[96:99], 0
  ds_read_b64 a[48:49], v19 offset:1536
  ds_read_b64 a[50:51], v19 offset:4608
  ds_read_b64 a[52:53], v22 offset:13824
  ds_read_b64 a[54:55], v20 offset:1536
  v_mfma_f32_32x32x16_bf16 v[32:47], a[28:31], a[100:103], v[32:47]
  v_max3_f32 v27, v48, v49, v27
  v_max3_f32 v27, v50, v51, v27
  v_max3_f32 v27, v52, v53, v27
  v_max3_f32 v27, v54, v55, v27
  v_max3_f32 v27, v56, v57, v27
  v_max3_f32 v27, v58, v59, v27
  v_max3_f32 v27, v60, v61, v27
  v_max3_f32 v27, v62, v63, v27
  s_waitcnt lgkmcnt(8)
  v_mfma_f32_32x32x16_bf16 v[48:63], a[32:35], a[96:99], 0
  ds_read_b64 a[56:57], v19 offset:1792
  ds_read_b64 a[58:59], v19 offset:4864
  ds_read_b64 a[60:61], v22 offset:14080
  ds_read_b64 a[62:63], v20 offset:1792
  v_mfma_f32_32x32x16_bf16 v[48:63], a[36:39], a[100:103], v[48:63]
  v_max3_f32 v27, v64, v65, v27
  v_max3_f32 v27, v66, v67, v27
  v_max3_f32 v27, v68, v69, v27
  v_max3_f32 v27, v70, v71, v27
  v_max3_f32 v27, v72, v73, v27
  v_max3_f32 v27, v74, v75, v27
  v_max3_f32 v27, v76, v77, v27
  v_max3_f32 v27, v78, v79, v27
  s_waitcnt lgkmcnt(8)
  v_mfma_f32_32x32x16_bf16 v[64:79], a[40:43], a[96:99], 0
  ds_read_b64 a[64:65], v19 offset:2048
  ds_read_b64 a[66:67], v19 offset:5120
  ds_read_b64 a[68:69], v22 offset:14336
  ds_read_b64 a[70:71], v20 offset:2048
  v_mfma_f32_32x32x16_bf16 v[64:79], a[44:47], a[100:103], v[64:79]
  v_max3_f32 v27, v32, v33, v27
  v_max3_f32 v27, v34, v35, v27
  v_max3_f32 v27, v36, v37, v27
  v_max3_f32 v27, v38, v39, v27
  v_max3_f32 v27, v40, v41, v27
  v_max3_f32 v27, v42, v43, v27
  v_max3_f32 v27, v44, v45, v27
  v_max3_f32 v27, v46, v47, v27
  s_waitcnt lgkmcnt(8)
  v_mfma_f32_32x32x16_bf16 v[32:47], a[48:51], a[96:99], 0
  v_mfma_f32_32x32x16_bf16 v[32:47], a[52:55], a[100:103], v[32:47]
  v_max3_f32 v27, v48, v49, v27
  v_max3_f32 v27, v50, v51, v27
  v_max3_f32 v27, v52, v53, v27
  v_max3_f32 v27, v54, v55, v27
  v_max3_f32 v27, v56, v57, v27
  v_max3_f32 v27, v58, v59, v27
  v_max3_f32 v27, v60, v61, v27
  v_max3_f32 v27, v62, v63, v27
  s_waitcnt lgkmcnt(4)
  v_mfma_f32_32x32x16_bf16 v[48:63], a[56:59], a[96:99], 0
  v_mfma_f32_32x32x16_bf16 v[48:63], a[60:63], a[100:103], v[48:63]
  v_max3_f32 v27, v64, v65, v27
  v_max3_f32 v27, v66, v67, v27
  v_max3_f32 v27, v68, v69, v27
  v_max3_f32 v27, v70, v71, v27
  v_max3_f32 v27, v72, v73, v27
  v_max3_f32 v27, v74, v75, v27
  v_max3_f32 v27, v76, v77, v27
  v_max3_f32 v27, v78, v79, v27
  s_waitcnt lgkmcnt(0)
  v_mfma_f32_32x32x16_bf16 v[96:111], a[64:67], a[96:99], v[192:207]
  v_mfma_f32_32x32x16_bf16 v[96:111], a[68:71], a[100:103], v[96:111]
  v_max3_f32 v27, v32, v33, v27
  v_max3_f32 v27, v34, v35, v27
  v_max3_f32 v27, v36, v37, v27
  v_max3_f32 v27, v38, v39, v27
  v_max3_f32 v27, v40, v41, v27
  v_max3_f32 v27, v42, v43, v27
  v_max3_f32 v27, v44, v45, v27
  v_max3_f32 v27, v46, v47, v27
  ds_read_b64 a[0:1], v19 offset:2304
  ds_read_b64 a[2:3], v19 offset:5376
  ds_read_b64 a[4:5], v22 offset:14592
  ds_read_b64 a[6:7], v20 offset:2304
  ds_read_b64_tr_b16 a[72:73], v21 offset:0
  ds_read_b64_tr_b16 a[74:75], v21 offset:64
  ds_read_b64_tr_b16 a[76:77], v21 offset:128
  ds_read_b64_tr_b16 a[78:79], v21 offset:192
  ds_read_b64_tr_b16 a[80:81], v21 offset:256
  ds_read_b64_tr_b16 a[82:83], v21 offset:320
  ds_read_b64_tr_b16 a[84:85], v21 offset:384
  ds_read_b64_tr_b16 a[86:87], v21 offset:448
  v_max3_f32 v27, v48, v49, v27
  v_max3_f32 v27, v50, v51, v27
  v_max3_f32 v27, v52, v53, v27
  v_max3_f32 v27, v54, v55, v27
  v_max3_f32 v27, v56, v57, v27
  v_max3_f32 v27, v58, v59, v27
  v_max3_f32 v27, v60, v61, v27
  v_max3_f32 v27, v62, v63, v27
  s_nop 1
  v_max3_f32 v27, v96, v97, v27
  v_max3_f32 v27, v98, v99, v27
  v_max3_f32 v27, v100, v101, v27
  v_max3_f32 v27, v102, v103, v27
  v_max3_f32 v27, v104, v105, v27
  v_max3_f32 v27, v106, v107, v27
  v_max3_f32 v27, v108, v109, v27
  v_max3_f32 v27, v110, v111, v27
  v_mov_b32 v28, v27
  s_nop 1
  v_permlane32_swap_b32 v27, v28
  s_nop 1
  v_max_f32 v27, v27, v28
  v_sub_f32 v112, 0, v27
  v_sub_f32 v113, 0, v27
  v_sub_f32 v114, 0, v27
  v_sub_f32 v115, 0, v27
  v_sub_f32 v116, 0, v27
  v_sub_f32 v117, 0, v27
  v_sub_f32 v118, 0, v27
  v_sub_f32 v119, 0, v27
  v_sub_f32 v120, 0, v27
  v_sub_f32 v121, 0, v27
  v_sub_f32 v122, 0, v27
  v_sub_f32 v123, 0, v27
  v_sub_f32 v124, 0, v27
  v_sub_f32 v125, 0, v27
  v_sub_f32 v126, 0, v27
  v_sub_f32 v127, 0, v27
  s_nop 1
  v_mfma_f32_32x32x16_bf16 v[48:63], a[8:11], a[96:99], v[112:127]
  v_mfma_f32_32x32x16_bf16 v[48:63], a[12:15], a[100:103], v[48:63]
  v_sub_f32 v80, v80, v27
  v_sub_f32 v81, v81, v27
  ds_read_b64_tr_b16 a[88:89], v21 offset:512
  v_sub_f32 v82, v82, v27
  v_sub_f32 v83, v83, v27
  ds_read_b64_tr_b16 a[90:91], v21 offset:576
  v_sub_f32 v84, v84, v27
  v_sub_f32 v85, v85, v27
  ds_read_b64_tr_b16 a[92:93], v21 offset:640
  v_sub_f32 v86, v86, v27
  v_sub_f32 v87, v87, v27
  ds_read_b64_tr_b16 a[94:95], v21 offset:704
  v_sub_f32 v88, v88, v27
  v_sub_f32 v89, v89, v27
  v_sub_f32 v90, v90, v27
  v_sub_f32 v91, v91, v27
  v_sub_f32 v92, v92, v27
  v_sub_f32 v93, v93, v27
  v_sub_f32 v94, v94, v27
  v_sub_f32 v95, v95, v27
  v_exp_f32 v80, v80
  v_exp_f32 v81, v81
  v_exp_f32 v82, v82
  v_exp_f32 v83, v83
  v_cvt_pk_bf16_f32 v128, v80, v81
  v_exp_f32 v84, v84
  v_exp_f32 v85, v85
  v_cvt_pk_bf16_f32 v129, v82, v83
  v_exp_f32 v86, v86
  v_exp_f32 v87, v87
  v_cvt_pk_bf16_f32 v130, v84, v85
  v_exp_f32 v88, v88
  v_exp_f32 v89, v89
  v_cvt_pk_bf16_f32 v131, v86, v87
  v_exp_f32 v90, v90
  v_exp_f32 v91, v91
  v_cvt_pk_bf16_f32 v132, v88, v89
  v_exp_f32 v92, v92
  v_exp_f32 v93, v93
  v_cvt_pk_bf16_f32 v133, v90, v91
  v_exp_f32 v94, v94
  v_exp_f32 v95, v95
  v_cvt_pk_bf16_f32 v134, v92, v93
  s_nop 0
  v_cvt_pk_bf16_f32 v135, v94, v95
  s_waitcnt vmcnt(4)
  s_lshl_b32 s15, s9, 8
  s_lshl_b32 s14, s10, 4
  s_add_u32 s15, s15, s14
  s_lshl_b32 s14, s6, 2
  s_add_u32 s15, s15, s14
  s_add_u32 s15, s15, 23007232
  v_mov_b32 v252, s101
  v_mov_b32 v253, 0
  s_mov_b64 exec, 1
  buffer_store_dword v252, v253, s[52:55], s15 offen sc1
  s_mov_b64 exec, -1
  s_waitcnt vmcnt(1)
  v_xor_b32 v208, s101, v208
  v_xor_b32 v209, s101, v209
  v_xor_b32 v210, s101, v210
  v_xor_b32 v211, s101, v211
  v_xor_b32 v212, s101, v212
  v_xor_b32 v213, s101, v213
  v_xor_b32 v214, s101, v214
  v_xor_b32 v215, s101, v215
  v_xor_b32 v216, s101, v216
  v_xor_b32 v217, s101, v217
  v_xor_b32 v218, s101, v218
  v_xor_b32 v219, s101, v219
  v_xor_b32 v220, s101, v220
  v_xor_b32 v221, s101, v221
  v_xor_b32 v222, s101, v222
  v_xor_b32 v223, s101, v223
  v_or_b32 v208, v208, v209
  v_or_b32 v208, v208, v210
  v_or_b32 v208, v208, v211
  v_or_b32 v208, v208, v212
  v_or_b32 v208, v208, v213
  v_or_b32 v208, v208, v214
  v_or_b32 v208, v208, v215
  v_or_b32 v208, v208, v216
  v_or_b32 v208, v208, v217
  v_or_b32 v208, v208, v218
  v_or_b32 v208, v208, v219
  v_or_b32 v208, v208, v220
  v_or_b32 v208, v208, v221
  v_or_b32 v208, v208, v222
  v_or_b32 v208, v208, v223
  v_cmp_ne_u32 vcc, 0, v208
  s_cbranch_vccz pollok_15
  s_mov_b32 s14, 200000
pollspin_16:
  s_sleep 2
  s_mov_b32 s15, 23003136
  buffer_load_dwordx4 v[208:211], v245, s[52:55], s15 offen offset:0 sc1
  buffer_load_dwordx4 v[212:215], v245, s[52:55], s15 offen offset:1024 sc1
  buffer_load_dwordx4 v[216:219], v245, s[52:55], s15 offen offset:2048 sc1
  buffer_load_dwordx4 v[220:223], v245, s[52:55], s15 offen offset:3072 sc1
  s_waitcnt vmcnt(0)
  v_xor_b32 v208, s101, v208
  v_xor_b32 v209, s101, v209
  v_xor_b32 v210, s101, v210
  v_xor_b32 v211, s101, v211
  v_xor_b32 v212, s101, v212
  v_xor_b32 v213, s101, v213
  v_xor_b32 v214, s101, v214
  v_xor_b32 v215, s101, v215
  v_xor_b32 v216, s101, v216
  v_xor_b32 v217, s101, v217
  v_xor_b32 v218, s101, v218
  v_xor_b32 v219, s101, v219
  v_xor_b32 v220, s101, v220
  v_xor_b32 v221, s101, v221
  v_xor_b32 v222, s101, v222
  v_xor_b32 v223, s101, v223
  v_or_b32 v208, v208, v209
  v_or_b32 v208, v208, v210
  v_or_b32 v208, v208, v211
  v_or_b32 v208, v208, v212
  v_or_b32 v208, v208, v213
  v_or_b32 v208, v208, v214
  v_or_b32 v208, v208, v215
  v_or_b32 v208, v208, v216
  v_or_b32 v208, v208, v217
  v_or_b32 v208, v208, v218
  v_or_b32 v208, v208, v219
  v_or_b32 v208, v208, v220
  v_or_b32 v208, v208, v221
  v_or_b32 v208, v208, v222
  v_or_b32 v208, v208, v223
  v_cmp_ne_u32 vcc, 0, v208
  s_cbranch_vccz pollok_15
  s_sub_u32 s14, s14, 1
  s_cmp_lg_u32 s14, 0
  s_cbranch_scc1 pollspin_16
pollok_15:
  s_add_u32 s45, s42, 0
  s_waitcnt lgkmcnt(8)
  v_mfma_f32_32x32x16_bf16 v[144:159], a[72:75], v[128:131], 0
  v_exp_f32 v48, v48
  v_exp_f32 v49, v49
  v_exp_f32 v50, v50
  v_exp_f32 v51, v51
  v_cvt_pk_bf16_f32 v136, v48, v49
  v_exp_f32 v52, v52
  v_mfma_f32_32x32x16_bf16 v[144:159], a[76:79], v[132:135], v[144:159]
  v_exp_f32 v53, v53
  v_cvt_pk_bf16_f32 v137, v50, v51
  ds_read_b64_tr_b16 a[72:73], v21 offset:768
  v_exp_f32 v54, v54
  v_exp_f32 v55, v55
  ds_read_b64_tr_b16 a[74:75], v21 offset:832
  v_cvt_pk_bf16_f32 v138, v52, v53
  v_exp_f32 v56, v56
  ds_read_b64_tr_b16 a[76:77], v21 offset:896
  v_mfma_f32_32x32x16_bf16 v[64:79], a[16:19], a[96:99], v[112:127]
  v_exp_f32 v57, v57
  v_cvt_pk_bf16_f32 v139, v54, v55
  ds_read_b64_tr_b16 a[78:79], v21 offset:960
  v_exp_f32 v58, v58
  v_exp_f32 v59, v59
  v_cvt_pk_bf16_f32 v140, v56, v57
  v_exp_f32 v60, v60
  v_mfma_f32_32x32x16_bf16 v[64:79], a[20:23], a[100:103], v[64:79]
  v_exp_f32 v61, v61
  v_cvt_pk_bf16_f32 v141, v58, v59
  v_exp_f32 v62, v62
  v_exp_f32 v63, v63
  v_cvt_pk_bf16_f32 v142, v60, v61
  s_nop 0
  v_cvt_pk_bf16_f32 v143, v62, v63
  buffer_load_dwordx4 a[128:131], v244, s[52:55], s45 offen offset:0 sc1
  buffer_load_dwordx4 a[132:135], v244, s[52:55], s45 offen offset:1024 sc1
  buffer_load_dwordx4 a[136:139], v244, s[52:55], s45 offen offset:2048 sc1
  s_waitcnt lgkmcnt(8)
  v_mfma_f32_32x32x16_bf16 v[144:159], a[80:83], v[136:139], v[144:159]
  v_exp_f32 v64, v64
  v_exp_f32 v65, v65
  v_exp_f32 v66, v66
  v_exp_f32 v67, v67
  v_cvt_pk_bf16_f32 v128, v64, v65
  v_exp_f32 v68, v68
  v_mfma_f32_32x32x16_bf16 v[144:159], a[84:87], v[140:143], v[144:159]
  v_exp_f32 v69, v69
  v_cvt_pk_bf16_f32 v129, v66, v67
  ds_read_b64_tr_b16 a[80:81], v21 offset:1024
  v_exp_f32 v70, v70
  v_exp_f32 v71, v71
  ds_read_b64_tr_b16 a[82:83], v21 offset:1088
  v_cvt_pk_bf16_f32 v130, v68, v69
  v_exp_f32 v72, v72
  ds_read_b64_tr_b16 a[84:85], v21 offset:1152
  v_mfma_f32_32x32x16_bf16 v[32:47], a[24:27], a[96:99], v[112:127]
  v_exp_f32 v73, v73
  v_cvt_pk_bf16_f32 v131, v70, v71
  ds_read_b64_tr_b16 a[86:87], v21 offset:1216
  v_exp_f32 v74, v74
  v_exp_f32 v75, v75
  v_cvt_pk_bf16_f32 v132, v72, v73
  v_exp_f32 v76, v76
  v_mfma_f32_32x32x16_bf16 v[32:47], a[28:31], a[100:103], v[32:47]
  v_exp_f32 v77, v77
  v_cvt_pk_bf16_f32 v133, v74, v75
  v_exp_f32 v78, v78
  v_exp_f32 v79, v79
  v_cvt_pk_bf16_f32 v134, v76, v77
  s_nop 0
  v_cvt_pk_bf16_f32 v135, v78, v79
  buffer_load_dwordx4 a[140:143], v244, s[52:55], s45 offen offset:3072 sc1
  s_add_u32 s45, s45, 4096
  buffer_load_dwordx4 a[144:147], v244, s[52:55], s45 offen sc1
  s_waitcnt lgkmcnt(8)
  v_mfma_f32_32x32x16_bf16 v[144:159], a[88:91], v[128:131], v[144:159]
  v_exp_f32 v32, v32
  v_exp_f32 v33, v33
  v_exp_f32 v34, v34
  v_exp_f32 v35, v35
  v_cvt_pk_bf16_f32 v136, v32, v33
  v_exp_f32 v36, v36
  v_mfma_f32_32x32x16_bf16 v[144:159], a[92:95], v[132:135], v[144:159]
  v_exp_f32 v37, v37
  v_cvt_pk_bf16_f32 v137, v34, v35
  ds_read_b64_tr_b16 a[88:89], v21 offset:1280
  v_exp_f32 v38, v38
  v_exp_f32 v39, v39
  ds_read_b64_tr_b16 a[90:91], v21 offset:1344
  v_cvt_pk_bf16_f32 v138, v36, v37
  v_exp_f32 v40, v40
  ds_read_b64_tr_b16 a[92:93], v21 offset:1408
  v_mfma_f32_32x32x16_bf16 v[48:63], a[32:35], a[96:99], v[112:127]
  v_exp_f32 v41, v41
  v_cvt_pk_bf16_f32 v139, v38, v39
  ds_read_b64_tr_b16 a[94:95], v21 offset:1472
  v_exp_f32 v42, v42
  v_exp_f32 v43, v43
  v_cvt_pk_bf16_f32 v140, v40, v41
  v_exp_f32 v44, v44
  v_mfma_f32_32x32x16_bf16 v[48:63], a[36:39], a[100:103], v[48:63]
  v_exp_f32 v45, v45
  v_cvt_pk_bf16_f32 v141, v42, v43
  v_exp_f32 v46, v46
  v_exp_f32 v47, v47
  v_cvt_pk_bf16_f32 v142, v44, v45
  s_nop 0
  v_cvt_pk_bf16_f32 v143, v46, v47
  s_add_u32 s45, s42, 163840
  buffer_load_dwordx4 a[164:167], v244, s[52:55], s45 offen offset:0 sc1
  buffer_load_dwordx4 a[168:171], v244, s[52:55], s45 offen offset:1024 sc1
  s_waitcnt lgkmcnt(8)
  v_mfma_f32_32x32x16_bf16 v[144:159], a[72:75], v[136:139], v[144:159]
  v_exp_f32 v48, v48
  v_exp_f32 v49, v49
  v_exp_f32 v50, v50
  v_exp_f32 v51, v51
  v_cvt_pk_bf16_f32 v128, v48, v49
  v_exp_f32 v52, v52
  v_mfma_f32_32x32x16_bf16 v[144:159], a[76:79], v[140:143], v[144:159]
  v_exp_f32 v53, v53
  v_cvt_pk_bf16_f32 v129, v50, v51
  ds_read_b64_tr_b16 a[72:73], v21 offset:1536
  v_exp_f32 v54, v54
  v_exp_f32 v55, v55
  ds_read_b64_tr_b16 a[74:75], v21 offset:1600
  v_cvt_pk_bf16_f32 v130, v52, v53
  v_exp_f32 v56, v56
  ds_read_b64_tr_b16 a[76:77], v21 offset:1664
  v_mfma_f32_32x32x16_bf16 v[64:79], a[40:43], a[96:99], v[112:127]
  v_exp_f32 v57, v57
  v_cvt_pk_bf16_f32 v131, v54, v55
  ds_read_b64_tr_b16 a[78:79], v21 offset:1728
  v_exp_f32 v58, v58
  v_exp_f32 v59, v59
  v_cvt_pk_bf16_f32 v132, v56, v57
  v_exp_f32 v60, v60
  v_mfma_f32_32x32x16_bf16 v[64:79], a[44:47], a[100:103], v[64:79]
  v_exp_f32 v61, v61
  v_cvt_pk_bf16_f32 v133, v58, v59
  v_exp_f32 v62, v62
  v_exp_f32 v63, v63
  v_cvt_pk_bf16_f32 v134, v60, v61
  s_nop 0
  v_cvt_pk_bf16_f32 v135, v62, v63
  buffer_load_dwordx4 a[172:175], v244, s[52:55], s45 offen offset:2048 sc1
  buffer_load_dwordx4 a[176:179], v244, s[52:55], s45 offen offset:3072 sc1
  s_add_u32 s45, s45, 4096
  s_waitcnt lgkmcnt(8)
  v_mfma_f32_32x32x16_bf16 v[144:159], a[80:83], v[128:131], v[144:159]
  v_exp_f32 v64, v64
  v_exp_f32 v65, v65
  v_exp_f32 v66, v66
  v_exp_f32 v67, v67
  v_cvt_pk_bf16_f32 v136, v64, v65
  v_exp_f32 v68, v68
  v_mfma_f32_32x32x16_bf16 v[144:159], a[84:87], v[132:135], v[144:159]
  v_exp_f32 v69, v69
  v_cvt_pk_bf16_f32 v137, v66, v67
  ds_read_b64_tr_b16 a[80:81], v21 offset:1792
  v_exp_f32 v70, v70
  v_exp_f32 v71, v71
  ds_read_b64_tr_b16 a[82:83], v21 offset:1856
  v_cvt_pk_bf16_f32 v138, v68, v69
  v_exp_f32 v72, v72
  ds_read_b64_tr_b16 a[84:85], v21 offset:1920
  v_mfma_f32_32x32x16_bf16 v[32:47], a[48:51], a[96:99], v[112:127]
  v_exp_f32 v73, v73
  v_cvt_pk_bf16_f32 v139, v70, v71
  ds_read_b64_tr_b16 a[86:87], v21 offset:1984
  v_exp_f32 v74, v74
  v_exp_f32 v75, v75
  v_cvt_pk_bf16_f32 v140, v72, v73
  v_exp_f32 v76, v76
  v_mfma_f32_32x32x16_bf16 v[32:47], a[52:55], a[100:103], v[32:47]
  v_exp_f32 v77, v77
  v_cvt_pk_bf16_f32 v141, v74, v75
  v_exp_f32 v78, v78
  v_exp_f32 v79, v79
  v_cvt_pk_bf16_f32 v142, v76, v77
  s_nop 0
  v_cvt_pk_bf16_f32 v143, v78, v79
  buffer_load_dwordx4 a[180:183], v244, s[52:55], s45 offen sc1
  s_add_u32 s45, s42, 327680
  buffer_load_dwordx4 a[200:203], v244, s[52:55], s45 offen offset:0 sc1
  s_waitcnt lgkmcnt(8)
  v_mfma_f32_32x32x16_bf16 v[144:159], a[88:91], v[136:139], v[144:159]
  v_exp_f32 v32, v32
  v_exp_f32 v33, v33
  v_exp_f32 v34, v34
  v_exp_f32 v35, v35
  v_cvt_pk_bf16_f32 v128, v32, v33
  v_exp_f32 v36, v36
  v_mfma_f32_32x32x16_bf16 v[144:159], a[92:95], v[140:143], v[144:159]
  v_exp_f32 v37, v37
  v_cvt_pk_bf16_f32 v129, v34, v35
  ds_read_b64_tr_b16 a[88:89], v21 offset:2048
  v_exp_f32 v38, v38
  v_exp_f32 v39, v39
  ds_read_b64_tr_b16 a[90:91], v21 offset:2112
  v_cvt_pk_bf16_f32 v130, v36, v37
  v_exp_f32 v40, v40
  ds_read_b64_tr_b16 a[92:93], v21 offset:2176
  v_mfma_f32_32x32x16_bf16 v[48:63], a[56:59], a[96:99], v[112:127]
  v_exp_f32 v41, v41
  v_cvt_pk_bf16_f32 v131, v38, v39
  ds_read_b64_tr_b16 a[94:95], v21 offset:2240
  v_exp_f32 v42, v42
  v_exp_f32 v43, v43
  v_cvt_pk_bf16_f32 v132, v40, v41
  v_exp_f32 v44, v44
  v_mfma_f32_32x32x16_bf16 v[48:63], a[60:63], a[100:103], v[48:63]
  v_exp_f32 v45, v45
  v_cvt_pk_bf16_f32 v133, v42, v43
  v_exp_f32 v46, v46
  v_exp_f32 v47, v47
  v_cvt_pk_bf16_f32 v134, v44, v45
  s_nop 0
  v_cvt_pk_bf16_f32 v135, v46, v47
  buffer_load_dwordx4 a[204:207], v244, s[52:55], s45 offen offset:1024 sc1
  buffer_load_dwordx4 a[208:211], v244, s[52:55], s45 offen offset:2048 sc1
  buffer_load_dwordx4 a[212:215], v244, s[52:55], s45 offen offset:3072 sc1
  s_waitcnt lgkmcnt(8)
  v_mfma_f32_32x32x16_bf16 v[144:159], a[72:75], v[128:131], v[144:159]
  v_exp_f32 v48, v48
  v_exp_f32 v49, v49
  v_exp_f32 v50, v50
  v_exp_f32 v51, v51
  v_cvt_pk_bf16_f32 v136, v48, v49
  v_exp_f32 v52, v52
  v_exp_f32 v53, v53
  v_cvt_pk_bf16_f32 v137, v50, v51
  v_exp_f32 v54, v54
  v_exp_f32 v55, v55
  v_cvt_pk_bf16_f32 v138, v52, v53
  v_exp_f32 v56, v56
  v_mfma_f32_32x32x16_bf16 v[144:159], a[76:79], v[132:135], v[144:159]
  v_exp_f32 v57, v57
  v_cvt_pk_bf16_f32 v139, v54, v55
  v_exp_f32 v58, v58
  v_exp_f32 v59, v59
  v_cvt_pk_bf16_f32 v140, v56, v57
  v_exp_f32 v60, v60
  v_exp_f32 v61, v61
  v_cvt_pk_bf16_f32 v141, v58, v59
  v_exp_f32 v62, v62
  v_exp_f32 v63, v63
  v_cvt_pk_bf16_f32 v142, v60, v61
  s_nop 0
  v_cvt_pk_bf16_f32 v143, v62, v63
  s_add_u32 s45, s45, 4096
  buffer_load_dwordx4 a[216:219], v244, s[52:55], s45 offen sc1
  s_add_u32 s45, s42, 491520
  s_waitcnt lgkmcnt(4)
  v_mfma_f32_32x32x16_bf16 v[144:159], a[80:83], v[136:139], v[144:159]
  v_sub_f32 v96, v96, v27
  v_sub_f32 v97, v97, v27
  v_sub_f32 v98, v98, v27
  v_sub_f32 v99, v99, v27
  v_sub_f32 v100, v100, v27
  v_sub_f32 v101, v101, v27
  v_sub_f32 v102, v102, v27
  v_sub_f32 v103, v103, v27
  v_sub_f32 v104, v104, v27
  v_sub_f32 v105, v105, v27
  v_sub_f32 v106, v106, v27
  v_sub_f32 v107, v107, v27
  v_sub_f32 v108, v108, v27
  v_sub_f32 v109, v109, v27
  v_sub_f32 v110, v110, v27
  v_sub_f32 v111, v111, v27
  v_exp_f32 v96, v96
  v_exp_f32 v97, v97
  v_exp_f32 v98, v98
  v_exp_f32 v99, v99
  v_cvt_pk_bf16_f32 v128, v96, v97
  v_exp_f32 v100, v100
  v_exp_f32 v101, v101
  v_mfma_f32_32x32x16_bf16 v[144:159], a[84:87], v[140:143], v[144:159]
  v_cvt_pk_bf16_f32 v129, v98, v99
  v_exp_f32 v102, v102
  v_exp_f32 v103, v103
  v_cvt_pk_bf16_f32 v130, v100, v101
  v_exp_f32 v104, v104
  v_exp_f32 v105, v105
  v_cvt_pk_bf16_f32 v131, v102, v103
  v_exp_f32 v106, v106
  v_exp_f32 v107, v107
  v_cvt_pk_bf16_f32 v132, v104, v105
  v_exp_f32 v108, v108
  v_exp_f32 v109, v109
  v_cvt_pk_bf16_f32 v133, v106, v107
  v_exp_f32 v110, v110
  v_exp_f32 v111, v111
  v_cvt_pk_bf16_f32 v134, v108, v109
  s_nop 0
  v_cvt_pk_bf16_f32 v135, v110, v111
  buffer_load_dwordx4 a[236:239], v244, s[52:55], s45 offen offset:0 sc1
  buffer_load_dwordx4 a[240:243], v244, s[52:55], s45 offen offset:1024 sc1
  buffer_load_dwordx4 a[244:247], v244, s[52:55], s45 offen offset:2048 sc1
  s_nop 1
  s_waitcnt lgkmcnt(0)
  v_mfma_f32_32x32x16_bf16 v[144:159], a[88:91], v[128:131], v[144:159]
  v_mfma_f32_32x32x16_bf16 v[144:159], a[92:95], v[132:135], v[144:159]
  v_mov_b32 v27, 0xf149f2ca
  v_mfma_f32_32x32x16_bf16 v[80:95], a[8:11], a[104:107], v[176:191]
  v_mfma_f32_32x32x16_bf16 v[80:95], a[12:15], a[108:111], v[80:95]
  buffer_load_dwordx4 a[248:251], v244, s[52:55], s45 offen offset:3072 sc1
  s_add_u32 s45, s45, 4096
  v_mfma_f32_32x32x16_bf16 v[48:63], a[16:19], a[104:107], 0
  v_mfma_f32_32x32x16_bf16 v[48:63], a[20:23], a[108:111], v[48:63]
  buffer_load_dwordx4 a[252:255], v244, s[52:55], s45 offen sc1
  s_add_u32 s45, s42, 655360
  v_mfma_f32_32x32x16_bf16 v[64:79], a[24:27], a[104:107], 0
  v_mfma_f32_32x32x16_bf16 v[64:79], a[28:31], a[108:111], v[64:79]
  v_max3_f32 v27, v80, v81, v27
  v_max3_f32 v27, v82, v83, v27
  v_max3_f32 v27, v84, v85, v27
  v_max3_f32 v27, v86, v87, v27
  v_max3_f32 v27, v88, v89, v27
  v_max3_f32 v27, v90, v91, v27
  v_max3_f32 v27, v92, v93, v27
  v_max3_f32 v27, v94, v95, v27
  buffer_load_dwordx4 v[224:227], v244, s[52:55], s45 offen offset:0 sc1
  buffer_load_dwordx4 v[228:231], v244, s[52:55], s45 offen offset:1024 sc1
  v_mfma_f32_32x32x16_bf16 v[32:47], a[32:35], a[104:107], 0
  v_mfma_f32_32x32x16_bf16 v[32:47], a[36:39], a[108:111], v[32:47]
  v_max3_f32 v27, v48, v49, v27
  v_max3_f32 v27, v50, v51, v27
  v_max3_f32 v27, v52, v53, v27
  v_max3_f32 v27, v54, v55, v27
  v_max3_f32 v27, v56, v57, v27
  v_max3_f32 v27, v58, v59, v27
  v_max3_f32 v27, v60, v61, v27
  v_max3_f32 v27, v62, v63, v27
  buffer_load_dwordx4 v[232:235], v244, s[52:55], s45 offen offset:2048 sc1
  buffer_load_dwordx4 v[236:239], v244, s[52:55], s45 offen offset:3072 sc1
  v_mfma_f32_32x32x16_bf16 v[48:63], a[40:43], a[104:107], 0
  v_mfma_f32_32x32x16_bf16 v[48:63], a[44:47], a[108:111], v[48:63]
  v_max3_f32 v27, v64, v65, v27
  v_max3_f32 v27, v66, v67, v27
  v_max3_f32 v27, v68, v69, v27
  v_max3_f32 v27, v70, v71, v27
  v_max3_f32 v27, v72, v73, v27
  v_max3_f32 v27, v74, v75, v27
  v_max3_f32 v27, v76, v77, v27
  v_max3_f32 v27, v78, v79, v27
  s_add_u32 s45, s45, 4096
  buffer_load_dwordx4 v[240:243], v244, s[52:55], s45 offen sc1
  v_mfma_f32_32x32x16_bf16 v[64:79], a[48:51], a[104:107], 0
  v_mfma_f32_32x32x16_bf16 v[64:79], a[52:55], a[108:111], v[64:79]
  v_max3_f32 v27, v32, v33, v27
  v_max3_f32 v27, v34, v35, v27
  v_max3_f32 v27, v36, v37, v27
  v_max3_f32 v27, v38, v39, v27
  v_max3_f32 v27, v40, v41, v27
  v_max3_f32 v27, v42, v43, v27
  v_max3_f32 v27, v44, v45, v27
  v_max3_f32 v27, v46, v47, v27
  s_mov_b32 s15, 23003136
  buffer_load_dwordx4 v[248:251], v246, s[52:55], s15 offen offset:0 sc1
  v_mfma_f32_32x32x16_bf16 v[32:47], a[56:59], a[104:107], 0
  v_mfma_f32_32x32x16_bf16 v[32:47], a[60:63], a[108:111], v[32:47]
  v_max3_f32 v27, v48, v49, v27
  v_max3_f32 v27, v50, v51, v27
  v_max3_f32 v27, v52, v53, v27
  v_max3_f32 v27, v54, v55, v27
  v_max3_f32 v27, v56, v57, v27
  v_max3_f32 v27, v58, v59, v27
  v_max3_f32 v27, v60, v61, v27
  v_max3_f32 v27, v62, v63, v27
  v_mfma_f32_32x32x16_bf16 v[48:63], a[64:67], a[104:107], 0
  v_mfma_f32_32x32x16_bf16 v[48:63], a[68:71], a[108:111], v[48:63]
  v_max3_f32 v27, v64, v65, v27
  v_max3_f32 v27, v66, v67, v27
  v_max3_f32 v27, v68, v69, v27
  v_max3_f32 v27, v70, v71, v27
  v_max3_f32 v27, v72, v73, v27
  v_max3_f32 v27, v74, v75, v27
  v_max3_f32 v27, v76, v77, v27
  v_max3_f32 v27, v78, v79, v27
  v_mfma_f32_32x32x16_bf16 v[96:111], a[0:3], a[104:107], v[192:207]
  v_mfma_f32_32x32x16_bf16 v[96:111], a[4:7], a[108:111], v[96:111]
  v_max3_f32 v27, v32, v33, v27
  v_max3_f32 v27, v34, v35, v27
  v_max3_f32 v27, v36, v37, v27
  v_max3_f32 v27, v38, v39, v27
  v_max3_f32 v27, v40, v41, v27
  v_max3_f32 v27, v42, v43, v27
  v_max3_f32 v27, v44, v45, v27
  v_max3_f32 v27, v46, v47, v27
  s_waitcnt vmcnt(0)
  v_xor_b32 v248, s101, v248
  v_xor_b32 v249, s101, v249
  v_xor_b32 v250, s101, v250
  v_xor_b32 v251, s101, v251
  v_or_b32 v248, v248, v249
  v_or_b32 v248, v248, v250
  v_or_b32 v248, v248, v251
  v_cmp_ne_u32 vcc, 0, v248
  s_cbranch_vccz pollok_17
  s_mov_b32 s14, 200000
pollspin_18:
  s_sleep 2
  s_mov_b32 s15, 23003136
  buffer_load_dwordx4 v[248:251], v246, s[52:55], s15 offen offset:0 sc1
  s_waitcnt vmcnt(0)
  v_xor_b32 v248, s101, v248
  v_xor_b32 v249, s101, v249
  v_xor_b32 v250, s101, v250
  v_xor_b32 v251, s101, v251
  v_or_b32 v248, v248, v249
  v_or_b32 v248, v248, v250
  v_or_b32 v248, v248, v251
  v_cmp_ne_u32 vcc, 0, v248
  s_cbranch_vccz pollok_17
  s_sub_u32 s14, s14, 1
  s_cmp_lg_u32 s14, 0
  s_cbranch_scc1 pollspin_18
pollok_17:
  ds_read_b64_tr_b16 a[72:73], v21 offset:256
  ds_read_b64_tr_b16 a[74:75], v21 offset:320
  ds_read_b64_tr_b16 a[76:77], v21 offset:384
  ds_read_b64_tr_b16 a[78:79], v21 offset:448
  ds_read_b64_tr_b16 a[80:81], v21 offset:512
  ds_read_b64_tr_b16 a[82:83], v21 offset:576
  ds_read_b64_tr_b16 a[84:85], v21 offset:640
  ds_read_b64_tr_b16 a[86:87], v21 offset:704
  v_max3_f32 v27, v48, v49, v27
  v_max3_f32 v27, v50, v51, v27
  v_max3_f32 v27, v52, v53, v27
  v_max3_f32 v27, v54, v55, v27
  v_max3_f32 v27, v56, v57, v27
  v_max3_f32 v27, v58, v59, v27
  v_max3_f32 v27, v60, v61, v27
  v_max3_f32 v27, v62, v63, v27
  s_nop 1
  v_max3_f32 v27, v96, v97, v27
  v_max3_f32 v27, v98, v99, v27
  v_max3_f32 v27, v100, v101, v27
  v_max3_f32 v27, v102, v103, v27
  v_max3_f32 v27, v104, v105, v27
  v_max3_f32 v27, v106, v107, v27
  v_max3_f32 v27, v108, v109, v27
  v_max3_f32 v27, v110, v111, v27
  v_mov_b32 v28, v27
  s_nop 1
  v_permlane32_swap_b32 v27, v28
  s_nop 1
  v_max_f32 v27, v27, v28
  v_sub_f32 v112, 0, v27
  v_sub_f32 v113, 0, v27
  v_sub_f32 v114, 0, v27
  v_sub_f32 v115, 0, v27
  v_sub_f32 v116, 0, v27
  v_sub_f32 v117, 0, v27
  v_sub_f32 v118, 0, v27
  v_sub_f32 v119, 0, v27
  v_sub_f32 v120, 0, v27
  v_sub_f32 v121, 0, v27
  v_sub_f32 v122, 0, v27
  v_sub_f32 v123, 0, v27
  v_sub_f32 v124, 0, v27
  v_sub_f32 v125, 0, v27
  v_sub_f32 v126, 0, v27
  v_sub_f32 v127, 0, v27
  s_nop 1
  v_mfma_f32_32x32x16_bf16 v[48:63], a[16:19], a[104:107], v[112:127]
  v_mfma_f32_32x32x16_bf16 v[48:63], a[20:23], a[108:111], v[48:63]
  v_sub_f32 v80, v80, v27
  v_sub_f32 v81, v81, v27
  ds_read_b64_tr_b16 a[88:89], v21 offset:768
  v_sub_f32 v82, v82, v27
  v_sub_f32 v83, v83, v27
  ds_read_b64_tr_b16 a[90:91], v21 offset:832
  v_sub_f32 v84, v84, v27
  v_sub_f32 v85, v85, v27
  ds_read_b64_tr_b16 a[92:93], v21 offset:896
  v_sub_f32 v86, v86, v27
  v_sub_f32 v87, v87, v27
  ds_read_b64_tr_b16 a[94:95], v21 offset:960
  v_sub_f32 v88, v88, v27
  v_sub_f32 v89, v89, v27
  v_sub_f32 v90, v90, v27
  v_sub_f32 v91, v91, v27
  v_sub_f32 v92, v92, v27
  v_sub_f32 v93, v93, v27
  v_sub_f32 v94, v94, v27
  v_sub_f32 v95, v95, v27
  v_exp_f32 v80, v80
  v_exp_f32 v81, v81
  v_exp_f32 v82, v82
  v_exp_f32 v83, v83
  v_cvt_pk_bf16_f32 v128, v80, v81
  v_exp_f32 v84, v84
  v_exp_f32 v85, v85
  v_cvt_pk_bf16_f32 v129, v82, v83
  v_exp_f32 v86, v86
  v_exp_f32 v87, v87
  v_cvt_pk_bf16_f32 v130, v84, v85
  v_exp_f32 v88, v88
  v_exp_f32 v89, v89
  v_cvt_pk_bf16_f32 v131, v86, v87
  v_exp_f32 v90, v90
  v_exp_f32 v91, v91
  v_cvt_pk_bf16_f32 v132, v88, v89
  v_exp_f32 v92, v92
  v_exp_f32 v93, v93
  v_cvt_pk_bf16_f32 v133, v90, v91
  v_exp_f32 v94, v94
  v_exp_f32 v95, v95
  v_cvt_pk_bf16_f32 v134, v92, v93
  s_nop 0
  v_cvt_pk_bf16_f32 v135, v94, v95
  s_add_u32 s46, s40, 0
  buffer_load_dwordx4 a[112:115], v244, s[52:55], s46 offen sc1
  s_add_u32 s46, s40, 55296
  s_waitcnt lgkmcnt(8)
  v_mfma_f32_32x32x16_bf16 v[160:175], a[72:75], v[128:131], 0
  v_exp_f32 v48, v48
  v_exp_f32 v49, v49
  v_exp_f32 v50, v50
  v_exp_f32 v51, v51
  v_cvt_pk_bf16_f32 v136, v48, v49
  v_exp_f32 v52, v52
  v_mfma_f32_32x32x16_bf16 v[160:175], a[76:79], v[132:135], v[160:175]
  v_exp_f32 v53, v53
  v_cvt_pk_bf16_f32 v137, v50, v51
  ds_read_b64_tr_b16 a[72:73], v21 offset:1024
  v_exp_f32 v54, v54
  v_exp_f32 v55, v55
  ds_read_b64_tr_b16 a[74:75], v21 offset:1088
  v_cvt_pk_bf16_f32 v138, v52, v53
  v_exp_f32 v56, v56
  ds_read_b64_tr_b16 a[76:77], v21 offset:1152
  v_mfma_f32_32x32x16_bf16 v[64:79], a[24:27], a[104:107], v[112:127]
  v_exp_f32 v57, v57
  v_cvt_pk_bf16_f32 v139, v54, v55
  ds_read_b64_tr_b16 a[78:79], v21 offset:1216
  v_exp_f32 v58, v58
  v_exp_f32 v59, v59
  v_cvt_pk_bf16_f32 v140, v56, v57
  v_exp_f32 v60, v60
  v_mfma_f32_32x32x16_bf16 v[64:79], a[28:31], a[108:111], v[64:79]
  v_exp_f32 v61, v61
  v_cvt_pk_bf16_f32 v141, v58, v59
  v_exp_f32 v62, v62
  v_exp_f32 v63, v63
  v_cvt_pk_bf16_f32 v142, v60, v61
  s_nop 0
  v_cvt_pk_bf16_f32 v143, v62, v63
  buffer_load_dwordx4 a[116:119], v244, s[52:55], s46 offen sc1
  s_add_u32 s46, s40, 110592
  buffer_load_dwordx4 a[120:123], v244, s[52:55], s46 offen sc1
  s_waitcnt lgkmcnt(8)
  v_mfma_f32_32x32x16_bf16 v[160:175], a[80:83], v[136:139], v[160:175]
  v_exp_f32 v64, v64
  v_exp_f32 v65, v65
  v_exp_f32 v66, v66
  v_exp_f32 v67, v67
  v_cvt_pk_bf16_f32 v128, v64, v65
  v_exp_f32 v68, v68
  v_mfma_f32_32x32x16_bf16 v[160:175], a[84:87], v[140:143], v[160:175]
  v_exp_f32 v69, v69
  v_cvt_pk_bf16_f32 v129, v66, v67
  ds_read_b64_tr_b16 a[80:81], v21 offset:1280
  v_exp_f32 v70, v70
  v_exp_f32 v71, v71
  ds_read_b64_tr_b16 a[82:83], v21 offset:1344
  v_cvt_pk_bf16_f32 v130, v68, v69
  v_exp_f32 v72, v72
  ds_read_b64_tr_b16 a[84:85], v21 offset:1408
  v_mfma_f32_32x32x16_bf16 v[32:47], a[32:35], a[104:107], v[112:127]
  v_exp_f32 v73, v73
  v_cvt_pk_bf16_f32 v131, v70, v71
  ds_read_b64_tr_b16 a[86:87], v21 offset:1472
  v_exp_f32 v74, v74
  v_exp_f32 v75, v75
  v_cvt_pk_bf16_f32 v132, v72, v73
  v_exp_f32 v76, v76
  v_mfma_f32_32x32x16_bf16 v[32:47], a[36:39], a[108:111], v[32:47]
  v_exp_f32 v77, v77
  v_cvt_pk_bf16_f32 v133, v74, v75
  v_exp_f32 v78, v78
  v_exp_f32 v79, v79
  v_cvt_pk_bf16_f32 v134, v76, v77
  s_nop 0
  v_cvt_pk_bf16_f32 v135, v78, v79
  s_add_u32 s46, s40, 165888
  buffer_load_dwordx4 a[124:127], v244, s[52:55], s46 offen sc1
  s_add_u32 s46, s40, 4096
  s_waitcnt lgkmcnt(8)
  v_mfma_f32_32x32x16_bf16 v[160:175], a[88:91], v[128:131], v[160:175]
  v_exp_f32 v32, v32
  v_exp_f32 v33, v33
  v_exp_f32 v34, v34
  v_exp_f32 v35, v35
  v_cvt_pk_bf16_f32 v136, v32, v33
  v_exp_f32 v36, v36
  v_mfma_f32_32x32x16_bf16 v[160:175], a[92:95], v[132:135], v[160:175]
  v_exp_f32 v37, v37
  v_cvt_pk_bf16_f32 v137, v34, v35
  ds_read_b64_tr_b16 a[88:89], v21 offset:1536
  v_exp_f32 v38, v38
  v_exp_f32 v39, v39
  ds_read_b64_tr_b16 a[90:91], v21 offset:1600
  v_cvt_pk_bf16_f32 v138, v36, v37
  v_exp_f32 v40, v40
  ds_read_b64_tr_b16 a[92:93], v21 offset:1664
  v_mfma_f32_32x32x16_bf16 v[48:63], a[40:43], a[104:107], v[112:127]
  v_exp_f32 v41, v41
  v_cvt_pk_bf16_f32 v139, v38, v39
  ds_read_b64_tr_b16 a[94:95], v21 offset:1728
  v_exp_f32 v42, v42
  v_exp_f32 v43, v43
  v_cvt_pk_bf16_f32 v140, v40, v41
  v_exp_f32 v44, v44
  v_mfma_f32_32x32x16_bf16 v[48:63], a[44:47], a[108:111], v[48:63]
  v_exp_f32 v45, v45
  v_cvt_pk_bf16_f32 v141, v42, v43
  v_exp_f32 v46, v46
  v_exp_f32 v47, v47
  v_cvt_pk_bf16_f32 v142, v44, v45
  s_nop 0
  v_cvt_pk_bf16_f32 v143, v46, v47
  buffer_load_dwordx4 a[148:151], v244, s[52:55], s46 offen sc1
  s_add_u32 s46, s40, 59392
  buffer_load_dwordx4 a[152:155], v244, s[52:55], s46 offen sc1
  s_waitcnt lgkmcnt(8)
  v_mfma_f32_32x32x16_bf16 v[160:175], a[72:75], v[136:139], v[160:175]
  v_exp_f32 v48, v48
  v_exp_f32 v49, v49
  v_exp_f32 v50, v50
  v_exp_f32 v51, v51
  v_cvt_pk_bf16_f32 v128, v48, v49
  v_exp_f32 v52, v52
  v_mfma_f32_32x32x16_bf16 v[160:175], a[76:79], v[140:143], v[160:175]
  v_exp_f32 v53, v53
  v_cvt_pk_bf16_f32 v129, v50, v51
  ds_read_b64_tr_b16 a[72:73], v21 offset:1792
  v_exp_f32 v54, v54
  v_exp_f32 v55, v55
  ds_read_b64_tr_b16 a[74:75], v21 offset:1856
  v_cvt_pk_bf16_f32 v130, v52, v53
  v_exp_f32 v56, v56
  ds_read_b64_tr_b16 a[76:77], v21 offset:1920
  v_mfma_f32_32x32x16_bf16 v[64:79], a[48:51], a[104:107], v[112:127]
  v_exp_f32 v57, v57
  v_cvt_pk_bf16_f32 v131, v54, v55
  ds_read_b64_tr_b16 a[78:79], v21 offset:1984
  v_exp_f32 v58, v58
  v_exp_f32 v59, v59
  v_cvt_pk_bf16_f32 v132, v56, v57
  v_exp_f32 v60, v60
  v_mfma_f32_32x32x16_bf16 v[64:79], a[52:55], a[108:111], v[64:79]
  v_exp_f32 v61, v61
  v_cvt_pk_bf16_f32 v133, v58, v59
  v_exp_f32 v62, v62
  v_exp_f32 v63, v63
  v_cvt_pk_bf16_f32 v134, v60, v61
  s_nop 0
  v_cvt_pk_bf16_f32 v135, v62, v63
  s_add_u32 s46, s40, 114688
  buffer_load_dwordx4 a[156:159], v244, s[52:55], s46 offen sc1
  s_add_u32 s46, s40, 169984
  s_waitcnt lgkmcnt(8)
  v_mfma_f32_32x32x16_bf16 v[160:175], a[80:83], v[128:131], v[160:175]
  v_exp_f32 v64, v64
  v_exp_f32 v65, v65
  v_exp_f32 v66, v66
  v_exp_f32 v67, v67
  v_cvt_pk_bf16_f32 v136, v64, v65
  v_exp_f32 v68, v68
  v_mfma_f32_32x32x16_bf16 v[160:175], a[84:87], v[132:135], v[160:175]
  v_exp_f32 v69, v69
  v_cvt_pk_bf16_f32 v137, v66, v67
  ds_read_b64_tr_b16 a[80:81], v21 offset:2048
  v_exp_f32 v70, v70
  v_exp_f32 v71, v71
  ds_read_b64_tr_b16 a[82:83], v21 offset:2112
  v_cvt_pk_bf16_f32 v138, v68, v69
  v_exp_f32 v72, v72
  ds_read_b64_tr_b16 a[84:85], v21 offset:2176
  v_mfma_f32_32x32x16_bf16 v[32:47], a[56:59], a[104:107], v[112:127]
  v_exp_f32 v73, v73
  v_cvt_pk_bf16_f32 v139, v70, v71
  ds_read_b64_tr_b16 a[86:87], v21 offset:2240
  v_exp_f32 v74, v74
  v_exp_f32 v75, v75
  v_cvt_pk_bf16_f32 v140, v72, v73
  v_exp_f32 v76, v76
  v_mfma_f32_32x32x16_bf16 v[32:47], a[60:63], a[108:111], v[32:47]
  v_exp_f32 v77, v77
  v_cvt_pk_bf16_f32 v141, v74, v75
  v_exp_f32 v78, v78
  v_exp_f32 v79, v79
  v_cvt_pk_bf16_f32 v142, v76, v77
  s_nop 0
  v_cvt_pk_bf16_f32 v143, v78, v79
  buffer_load_dwordx4 a[160:163], v244, s[52:55], s46 offen sc1
  s_add_u32 s46, s40, 8192
  buffer_load_dwordx4 a[184:187], v244, s[52:55], s46 offen sc1
  s_waitcnt lgkmcnt(8)
  v_mfma_f32_32x32x16_bf16 v[160:175], a[88:91], v[136:139], v[160:175]
  v_exp_f32 v32, v32
  v_exp_f32 v33, v33
  v_exp_f32 v34, v34
  v_exp_f32 v35, v35
  v_cvt_pk_bf16_f32 v128, v32, v33
  v_exp_f32 v36, v36
  v_mfma_f32_32x32x16_bf16 v[160:175], a[92:95], v[140:143], v[160:175]
  v_exp_f32 v37, v37
  v_cvt_pk_bf16_f32 v129, v34, v35
  ds_read_b64_tr_b16 a[88:89], v21 offset:2304
  v_exp_f32 v38, v38
  v_exp_f32 v39, v39
  ds_read_b64_tr_b16 a[90:91], v21 offset:2368
  v_cvt_pk_bf16_f32 v130, v36, v37
  v_exp_f32 v40, v40
  ds_read_b64_tr_b16 a[92:93], v21 offset:2432
  v_mfma_f32_32x32x16_bf16 v[48:63], a[64:67], a[104:107], v[112:127]
  v_exp_f32 v41, v41
  v_cvt_pk_bf16_f32 v131, v38, v39
  ds_read_b64_tr_b16 a[94:95], v21 offset:2496
  v_exp_f32 v42, v42
  v_exp_f32 v43, v43
  v_cvt_pk_bf16_f32 v132, v40, v41
  v_exp_f32 v44, v44
  v_mfma_f32_32x32x16_bf16 v[48:63], a[68:71], a[108:111], v[48:63]
  v_exp_f32 v45, v45
  v_cvt_pk_bf16_f32 v133, v42, v43
  v_exp_f32 v46, v46
  v_exp_f32 v47, v47
  v_cvt_pk_bf16_f32 v134, v44, v45
  s_nop 0
  v_cvt_pk_bf16_f32 v135, v46, v47
  s_add_u32 s46, s40, 63488
  buffer_load_dwordx4 a[188:191], v244, s[52:55], s46 offen sc1
  s_add_u32 s46, s40, 118784
  s_waitcnt lgkmcnt(8)
  v_mfma_f32_32x32x16_bf16 v[160:175], a[72:75], v[128:131], v[160:175]
  v_exp_f32 v48, v48
  v_exp_f32 v49, v49
  v_exp_f32 v50, v50
  v_exp_f32 v51, v51
  v_cvt_pk_bf16_f32 v136, v48, v49
  v_exp_f32 v52, v52
  v_exp_f32 v53, v53
  v_cvt_pk_bf16_f32 v137, v50, v51
  v_exp_f32 v54, v54
  v_exp_f32 v55, v55
  v_cvt_pk_bf16_f32 v138, v52, v53
  v_exp_f32 v56, v56
  v_mfma_f32_32x32x16_bf16 v[160:175], a[76:79], v[132:135], v[160:175]
  v_exp_f32 v57, v57
  v_cvt_pk_bf16_f32 v139, v54, v55
  v_exp_f32 v58, v58
  v_exp_f32 v59, v59
  v_cvt_pk_bf16_f32 v140, v56, v57
  v_exp_f32 v60, v60
  v_exp_f32 v61, v61
  v_cvt_pk_bf16_f32 v141, v58, v59
  v_exp_f32 v62, v62
  v_exp_f32 v63, v63
  v_cvt_pk_bf16_f32 v142, v60, v61
  s_nop 0
  v_cvt_pk_bf16_f32 v143, v62, v63
  buffer_load_dwordx4 a[192:195], v244, s[52:55], s46 offen sc1
  s_add_u32 s46, s40, 174080
  buffer_load_dwordx4 a[196:199], v244, s[52:55], s46 offen sc1
  s_waitcnt lgkmcnt(4)
  v_mfma_f32_32x32x16_bf16 v[160:175], a[80:83], v[136:139], v[160:175]
  v_sub_f32 v96, v96, v27
  v_sub_f32 v97, v97, v27
  v_sub_f32 v98, v98, v27
  v_sub_f32 v99, v99, v27
  v_sub_f32 v100, v100, v27
  v_sub_f32 v101, v101, v27
  v_sub_f32 v102, v102, v27
  v_sub_f32 v103, v103, v27
  v_sub_f32 v104, v104, v27
  v_sub_f32 v105, v105, v27
  v_sub_f32 v106, v106, v27
  v_sub_f32 v107, v107, v27
  v_sub_f32 v108, v108, v27
  v_sub_f32 v109, v109, v27
  v_sub_f32 v110, v110, v27
  v_sub_f32 v111, v111, v27
  v_exp_f32 v96, v96
  v_exp_f32 v97, v97
  v_exp_f32 v98, v98
  v_exp_f32 v99, v99
  v_cvt_pk_bf16_f32 v128, v96, v97
  v_exp_f32 v100, v100
  v_exp_f32 v101, v101
  v_mfma_f32_32x32x16_bf16 v[160:175], a[84:87], v[140:143], v[160:175]
  v_cvt_pk_bf16_f32 v129, v98, v99
  v_exp_f32 v102, v102
  v_exp_f32 v103, v103
  v_cvt_pk_bf16_f32 v130, v100, v101
  v_exp_f32 v104, v104
  v_exp_f32 v105, v105
  v_cvt_pk_bf16_f32 v131, v102, v103
  v_exp_f32 v106, v106
  v_exp_f32 v107, v107
  v_cvt_pk_bf16_f32 v132, v104, v105
  v_exp_f32 v108, v108
  v_exp_f32 v109, v109
  v_cvt_pk_bf16_f32 v133, v106, v107
  v_exp_f32 v110, v110
  v_exp_f32 v111, v111
  v_cvt_pk_bf16_f32 v134, v108, v109
  s_nop 0
  v_cvt_pk_bf16_f32 v135, v110, v111
  s_add_u32 s46, s40, 12288
  buffer_load_dwordx4 a[220:223], v244, s[52:55], s46 offen sc1
  s_add_u32 s46, s40, 67584
  s_nop 1
  s_waitcnt lgkmcnt(0)
  v_mfma_f32_32x32x16_bf16 v[160:175], a[88:91], v[128:131], v[160:175]
  v_mfma_f32_32x32x16_bf16 v[160:175], a[92:95], v[132:135], v[160:175]
  buffer_load_dwordx4 a[224:227], v244, s[52:55], s46 offen sc1
  s_add_u32 s46, s40, 122880
  buffer_load_dwordx4 a[228:231], v244, s[52:55], s46 offen sc1
  s_add_u32 s46, s40, 178176
  buffer_load_dwordx4 a[232:235], v244, s[52:55], s46 offen sc1
  s_add_u32 s46, s40, 16384
  buffer_load_dwordx4 v[208:211], v244, s[52:55], s46 offen sc1
  s_add_u32 s46, s40, 71680
  buffer_load_dwordx4 v[212:215], v244, s[52:55], s46 offen sc1
  s_add_u32 s46, s40, 126976
  buffer_load_dwordx4 v[216:219], v244, s[52:55], s46 offen sc1
  s_add_u32 s46, s40, 182272
  buffer_load_dwordx4 v[220:223], v244, s[52:55], s46 offen sc1
  s_nop 13
  s_mul_i32 s11, s62, 5
  v_add_u32 v20, s11, v17
  v_lshrrev_b32 v19, 1, v20
  v_lshlrev_b32 v19, 8, v19
  v_and_b32 v20, 1, v20
  v_lshl_add_u32 v19, v20, 3, v19
  v_and_b32 v20, 1, v18
  v_mul_u32_u24 v20, 1280, v20
  v_add_u32 v19, v19, v20
  v_lshrrev_b32 v20, 1, v18
  v_lshl_add_u32 v19, v20, 4, v19
  s_mul_i32 s11, s63, 5120
  s_add_u32 s11, s11, 67584
  v_add_u32 v19, s11, v19
  v_mov_b32 v22, v152
  v_mov_b32 v23, v152
  s_nop 1
  v_permlane32_swap_b32 v22, v23
  s_nop 1
  v_rcp_f32 v23, v23
  s_nop 0
  v_mul_f32 v144, v23, v144
  v_mul_f32 v145, v23, v145
  v_mul_f32 v146, v23, v146
  v_mul_f32 v147, v23, v147
  v_mul_f32 v148, v23, v148
  v_mul_f32 v149, v23, v149
  v_mul_f32 v150, v23, v150
  v_mul_f32 v151, v23, v151
  v_mul_f32 v152, v23, v152
  v_mul_f32 v153, v23, v153
  v_mul_f32 v154, v23, v154
  v_mul_f32 v155, v23, v155
  v_cvt_pk_bf16_f32 v144, v144, v145
  v_cvt_pk_bf16_f32 v145, v146, v147
  v_cvt_pk_bf16_f32 v148, v148, v149
  v_cvt_pk_bf16_f32 v149, v150, v151
  v_cvt_pk_bf16_f32 v152, v152, v153
  v_cvt_pk_bf16_f32 v153, v154, v155
  ds_write_b64 v19, v[144:145] offset:0
  ds_write_b64 v19, v[148:149] offset:256
  s_mov_b32 exec_hi, 0
  ds_write_b64 v19, v[152:153] offset:512
  s_mov_b64 exec, -1
  v_mov_b32 v22, v168
  v_mov_b32 v23, v168
  s_nop 1
  v_permlane32_swap_b32 v22, v23
  s_nop 1
  v_rcp_f32 v23, v23
  s_nop 0
  v_mul_f32 v160, v23, v160
  v_mul_f32 v161, v23, v161
  v_mul_f32 v162, v23, v162
  v_mul_f32 v163, v23, v163
  v_mul_f32 v164, v23, v164
  v_mul_f32 v165, v23, v165
  v_mul_f32 v166, v23, v166
  v_mul_f32 v167, v23, v167
  v_mul_f32 v168, v23, v168
  v_mul_f32 v169, v23, v169
  v_mul_f32 v170, v23, v170
  v_mul_f32 v171, v23, v171
  v_cvt_pk_bf16_f32 v160, v160, v161
  v_cvt_pk_bf16_f32 v161, v162, v163
  v_cvt_pk_bf16_f32 v164, v164, v165
  v_cvt_pk_bf16_f32 v165, v166, v167
  v_cvt_pk_bf16_f32 v168, v168, v169
  v_cvt_pk_bf16_f32 v169, v170, v171
  ds_write_b64 v19, v[160:161] offset:2560
  ds_write_b64 v19, v[164:165] offset:2816
  s_mov_b32 exec_hi, 0
  ds_write_b64 v19, v[168:169] offset:3072
  s_mov_b64 exec, -1
  s_waitcnt lgkmcnt(0)
  s_barrier
  s_mul_i32 s11, s61, 163840
  s_mul_i32 s12, s60, 1280
  s_add_u32 s11, s11, s12
  s_add_u32 s11, s11, 16777216
  s_mov_b32 s12, 52429
  v_add_u32 v22, 0, v0
  v_lshlrev_b32 v25, 4, v22
  v_add_u32 v26, 67584, v25
  ds_read_b128 v[32:35], v26
  v_mul_lo_u32 v23, v22, s12
  v_lshrrev_b32 v23, 22, v23
  v_mul_u32_u24 v24, 19200, v23
  v_add_u32 v48, v24, v25
  v_add_u32 v22, 256, v0
  v_lshlrev_b32 v25, 4, v22
  v_add_u32 v26, 67584, v25
  ds_read_b128 v[36:39], v26
  v_mul_lo_u32 v23, v22, s12
  v_lshrrev_b32 v23, 22, v23
  v_mul_u32_u24 v24, 19200, v23
  v_add_u32 v49, v24, v25
  v_add_u32 v22, 512, v0
  v_lshlrev_b32 v25, 4, v22
  v_add_u32 v26, 67584, v25
  ds_read_b128 v[40:43], v26
  v_mul_lo_u32 v23, v22, s12
  v_lshrrev_b32 v23, 22, v23
  v_mul_u32_u24 v24, 19200, v23
  v_add_u32 v50, v24, v25
  s_waitcnt lgkmcnt(0)
  buffer_store_dwordx4 v[32:35], v48, s[52:55], s11 offen sc1
  buffer_store_dwordx4 v[36:39], v49, s[52:55], s11 offen sc1
  v_cmp_gt_u32 vcc, 128, v0
  s_and_saveexec_b64 s[72:73], vcc
  s_cbranch_execz p3st_19
  buffer_store_dwordx4 v[40:43], v50, s[52:55], s11 offen sc1
p3st_19:
  s_mov_b64 exec, s[72:73]
  v_add_u32 v246, 4096, v246
  s_add_u32 s45, s42, 819200
  buffer_load_dwordx4 a[16:19], v244, s[52:55], s45 offen offset:0 sc1
  buffer_load_dwordx4 a[20:23], v244, s[52:55], s45 offen offset:1024 sc1
  buffer_load_dwordx4 a[24:27], v244, s[52:55], s45 offen offset:2048 sc1
  buffer_load_dwordx4 a[28:31], v244, s[52:55], s45 offen offset:3072 sc1
  s_add_u32 s45, s45, 4096
  buffer_load_dwordx4 a[32:35], v244, s[52:55], s45 offen sc1
  s_add_u32 s46, s40, 20480
  buffer_load_dwordx4 a[0:3], v244, s[52:55], s46 offen sc1
  s_add_u32 s46, s40, 75776
  buffer_load_dwordx4 a[4:7], v244, s[52:55], s46 offen sc1
  s_add_u32 s46, s40, 131072
  buffer_load_dwordx4 a[8:11], v244, s[52:55], s46 offen sc1
  s_add_u32 s46, s40, 186368
  buffer_load_dwordx4 a[12:15], v244, s[52:55], s46 offen sc1
  v_mul_u32_u24 v24, 2560, v2
  v_lshl_add_u32 v24, v3, 3, v24
  buffer_load_dwordx2 v[184:185], v24, s[36:39], s43 offen offset:0
  buffer_load_dwordx2 v[186:187], v24, s[36:39], s43 offen offset:32
  buffer_load_dwordx2 v[188:189], v24, s[36:39], s43 offen offset:64
  buffer_load_dwordx2 v[190:191], v24, s[36:39], s43 offen offset:96
  buffer_load_dwordx2 v[192:193], v24, s[36:39], s43 offen offset:128
  s_waitcnt vmcnt(32)
  v_mfma_f32_16x16x32_bf16 v[64:67], a[128:131], a[112:115], 0
  v_mfma_f32_16x16x32_bf16 v[84:87], a[128:131], a[116:119], 0
  s_add_u32 s45, s42, 983040
  v_mfma_f32_16x16x32_bf16 v[104:107], a[128:131], a[120:123], 0
  buffer_load_dwordx4 a[52:55], v244, s[52:55], s45 offen offset:0 sc1
  v_mfma_f32_16x16x32_bf16 v[124:127], a[128:131], a[124:127], 0
  buffer_load_dwordx4 a[56:59], v244, s[52:55], s45 offen offset:1024 sc1
  v_mfma_f32_16x16x32_bf16 v[68:71], a[132:135], a[112:115], 0
  buffer_load_dwordx4 a[60:63], v244, s[52:55], s45 offen offset:2048 sc1
  v_mfma_f32_16x16x32_bf16 v[88:91], a[132:135], a[116:119], 0
  buffer_load_dwordx4 a[64:67], v244, s[52:55], s45 offen offset:3072 sc1
  v_mfma_f32_16x16x32_bf16 v[108:111], a[132:135], a[120:123], 0
  s_add_u32 s45, s45, 4096
  v_mfma_f32_16x16x32_bf16 v[128:131], a[132:135], a[124:127], 0
  buffer_load_dwordx4 a[68:71], v244, s[52:55], s45 offen sc1
  v_mfma_f32_16x16x32_bf16 v[72:75], a[136:139], a[112:115], 0
  s_add_u32 s46, s40, 24576
  v_mfma_f32_16x16x32_bf16 v[92:95], a[136:139], a[116:119], 0
  buffer_load_dwordx4 a[36:39], v244, s[52:55], s46 offen sc1
  v_mfma_f32_16x16x32_bf16 v[112:115], a[136:139], a[120:123], 0
  s_add_u32 s46, s40, 79872
  v_mfma_f32_16x16x32_bf16 v[132:135], a[136:139], a[124:127], 0
  buffer_load_dwordx4 a[40:43], v244, s[52:55], s46 offen sc1
  v_mfma_f32_16x16x32_bf16 v[76:79], a[140:143], a[112:115], 0
  s_add_u32 s46, s40, 135168
  v_mfma_f32_16x16x32_bf16 v[96:99], a[140:143], a[116:119], 0
  buffer_load_dwordx4 a[44:47], v244, s[52:55], s46 offen sc1
  v_mfma_f32_16x16x32_bf16 v[116:119], a[140:143], a[120:123], 0
  s_add_u32 s46, s40, 190464
  v_mfma_f32_16x16x32_bf16 v[136:139], a[140:143], a[124:127], 0
  buffer_load_dwordx4 a[48:51], v244, s[52:55], s46 offen sc1
  v_mfma_f32_16x16x32_bf16 v[80:83], a[144:147], a[112:115], 0
  v_mfma_f32_16x16x32_bf16 v[100:103], a[144:147], a[116:119], 0
  v_mfma_f32_16x16x32_bf16 v[120:123], a[144:147], a[120:123], 0
  v_mfma_f32_16x16x32_bf16 v[140:143], a[144:147], a[124:127], 0
  s_waitcnt vmcnt(37)
  v_mfma_f32_16x16x32_bf16 v[64:67], a[164:167], a[148:151], v[64:67]
  v_mfma_f32_16x16x32_bf16 v[84:87], a[164:167], a[152:155], v[84:87]
  s_add_u32 s45, s42, 1146880
  v_mfma_f32_16x16x32_bf16 v[104:107], a[164:167], a[156:159], v[104:107]
  buffer_load_dwordx4 a[128:131], v244, s[52:55], s45 offen offset:0 sc1
  v_mfma_f32_16x16x32_bf16 v[124:127], a[164:167], a[160:163], v[124:127]
  buffer_load_dwordx4 a[132:135], v244, s[52:55], s45 offen offset:1024 sc1
  v_mfma_f32_16x16x32_bf16 v[68:71], a[168:171], a[148:151], v[68:71]
  buffer_load_dwordx4 a[136:139], v244, s[52:55], s45 offen offset:2048 sc1
  v_mfma_f32_16x16x32_bf16 v[88:91], a[168:171], a[152:155], v[88:91]
  buffer_load_dwordx4 a[140:143], v244, s[52:55], s45 offen offset:3072 sc1
  v_mfma_f32_16x16x32_bf16 v[108:111], a[168:171], a[156:159], v[108:111]
  s_add_u32 s45, s45, 4096
  v_mfma_f32_16x16x32_bf16 v[128:131], a[168:171], a[160:163], v[128:131]
  buffer_load_dwordx4 a[144:147], v244, s[52:55], s45 offen sc1
  v_mfma_f32_16x16x32_bf16 v[72:75], a[172:175], a[148:151], v[72:75]
  s_add_u32 s46, s40, 28672
  v_mfma_f32_16x16x32_bf16 v[92:95], a[172:175], a[152:155], v[92:95]
  buffer_load_dwordx4 a[112:115], v244, s[52:55], s46 offen sc1
  v_mfma_f32_16x16x32_bf16 v[112:115], a[172:175], a[156:159], v[112:115]
  s_add_u32 s46, s40, 83968
  v_mfma_f32_16x16x32_bf16 v[132:135], a[172:175], a[160:163], v[132:135]
  buffer_load_dwordx4 a[116:119], v244, s[52:55], s46 offen sc1
  v_mfma_f32_16x16x32_bf16 v[76:79], a[176:179], a[148:151], v[76:79]
  s_add_u32 s46, s40, 139264
  v_mfma_f32_16x16x32_bf16 v[96:99], a[176:179], a[152:155], v[96:99]
  buffer_load_dwordx4 a[120:123], v244, s[52:55], s46 offen sc1
  v_mfma_f32_16x16x32_bf16 v[116:119], a[176:179], a[156:159], v[116:119]
  s_add_u32 s46, s40, 194560
  v_mfma_f32_16x16x32_bf16 v[136:139], a[176:179], a[160:163], v[136:139]
  buffer_load_dwordx4 a[124:127], v244, s[52:55], s46 offen sc1
  v_mfma_f32_16x16x32_bf16 v[80:83], a[180:183], a[148:151], v[80:83]
  v_mfma_f32_16x16x32_bf16 v[100:103], a[180:183], a[152:155], v[100:103]
  v_mfma_f32_16x16x32_bf16 v[120:123], a[180:183], a[156:159], v[120:123]
  v_mfma_f32_16x16x32_bf16 v[140:143], a[180:183], a[160:163], v[140:143]
  s_waitcnt vmcnt(42)
  v_mfma_f32_16x16x32_bf16 v[64:67], a[200:203], a[184:187], v[64:67]
  v_mfma_f32_16x16x32_bf16 v[84:87], a[200:203], a[188:191], v[84:87]
  s_add_u32 s45, s42, 1310720
  v_mfma_f32_16x16x32_bf16 v[104:107], a[200:203], a[192:195], v[104:107]
  buffer_load_dwordx4 a[164:167], v244, s[52:55], s45 offen offset:0 sc1
  v_mfma_f32_16x16x32_bf16 v[124:127], a[200:203], a[196:199], v[124:127]
  buffer_load_dwordx4 a[168:171], v244, s[52:55], s45 offen offset:1024 sc1
  v_mfma_f32_16x16x32_bf16 v[68:71], a[204:207], a[184:187], v[68:71]
  buffer_load_dwordx4 a[172:175], v244, s[52:55], s45 offen offset:2048 sc1
  v_mfma_f32_16x16x32_bf16 v[88:91], a[204:207], a[188:191], v[88:91]
  buffer_load_dwordx4 a[176:179], v244, s[52:55], s45 offen offset:3072 sc1
  v_mfma_f32_16x16x32_bf16 v[108:111], a[204:207], a[192:195], v[108:111]
  s_add_u32 s45, s45, 4096
  v_mfma_f32_16x16x32_bf16 v[128:131], a[204:207], a[196:199], v[128:131]
  buffer_load_dwordx4 a[180:183], v244, s[52:55], s45 offen sc1
  v_mfma_f32_16x16x32_bf16 v[72:75], a[208:211], a[184:187], v[72:75]
  s_add_u32 s46, s40, 32768
  v_mfma_f32_16x16x32_bf16 v[92:95], a[208:211], a[188:191], v[92:95]
  buffer_load_dwordx4 a[148:151], v244, s[52:55], s46 offen sc1
  v_mfma_f32_16x16x32_bf16 v[112:115], a[208:211], a[192:195], v[112:115]
  s_add_u32 s46, s40, 88064
  v_mfma_f32_16x16x32_bf16 v[132:135], a[208:211], a[196:199], v[132:135]
  buffer_load_dwordx4 a[152:155], v244, s[52:55], s46 offen sc1
  v_mfma_f32_16x16x32_bf16 v[76:79], a[212:215], a[184:187], v[76:79]
  s_add_u32 s46, s40, 143360
  v_mfma_f32_16x16x32_bf16 v[96:99], a[212:215], a[188:191], v[96:99]
  buffer_load_dwordx4 a[156:159], v244, s[52:55], s46 offen sc1
  v_mfma_f32_16x16x32_bf16 v[116:119], a[212:215], a[192:195], v[116:119]
  s_add_u32 s46, s40, 198656
  v_mfma_f32_16x16x32_bf16 v[136:139], a[212:215], a[196:199], v[136:139]
  buffer_load_dwordx4 a[160:163], v244, s[52:55], s46 offen sc1
  v_mfma_f32_16x16x32_bf16 v[80:83], a[216:219], a[184:187], v[80:83]
  v_mfma_f32_16x16x32_bf16 v[100:103], a[216:219], a[188:191], v[100:103]
  v_mfma_f32_16x16x32_bf16 v[120:123], a[216:219], a[192:195], v[120:123]
  v_mfma_f32_16x16x32_bf16 v[140:143], a[216:219], a[196:199], v[140:143]
  s_waitcnt vmcnt(47)
  s_lshl_b32 s15, s61, 8
  s_lshl_b32 s14, s60, 4
  s_add_u32 s15, s15, s14
  s_lshl_b32 s14, s6, 2
  s_add_u32 s15, s15, s14
  s_add_u32 s15, s15, 23011328
  v_mov_b32 v252, s101
  v_mov_b32 v253, 0
  s_mov_b64 exec, 1
  buffer_store_dword v252, v253, s[52:55], s15 offen sc1
  s_mov_b64 exec, -1
  v_mfma_f32_16x16x32_bf16 v[64:67], a[236:239], a[220:223], v[64:67]
  v_mfma_f32_16x16x32_bf16 v[84:87], a[236:239], a[224:227], v[84:87]
  s_add_u32 s45, s42, 1474560
  v_mfma_f32_16x16x32_bf16 v[104:107], a[236:239], a[228:231], v[104:107]
  buffer_load_dwordx4 a[200:203], v244, s[52:55], s45 offen offset:0 sc1
  v_mfma_f32_16x16x32_bf16 v[124:127], a[236:239], a[232:235], v[124:127]
  buffer_load_dwordx4 a[204:207], v244, s[52:55], s45 offen offset:1024 sc1
  v_mfma_f32_16x16x32_bf16 v[68:71], a[240:243], a[220:223], v[68:71]
  buffer_load_dwordx4 a[208:211], v244, s[52:55], s45 offen offset:2048 sc1
  v_mfma_f32_16x16x32_bf16 v[88:91], a[240:243], a[224:227], v[88:91]
  buffer_load_dwordx4 a[212:215], v244, s[52:55], s45 offen offset:3072 sc1
  v_mfma_f32_16x16x32_bf16 v[108:111], a[240:243], a[228:231], v[108:111]
  s_add_u32 s45, s45, 4096
  v_mfma_f32_16x16x32_bf16 v[128:131], a[240:243], a[232:235], v[128:131]
  buffer_load_dwordx4 a[216:219], v244, s[52:55], s45 offen sc1
  v_mfma_f32_16x16x32_bf16 v[72:75], a[244:247], a[220:223], v[72:75]
  s_add_u32 s46, s40, 36864
  v_mfma_f32_16x16x32_bf16 v[92:95], a[244:247], a[224:227], v[92:95]
  buffer_load_dwordx4 a[184:187], v244, s[52:55], s46 offen sc1
  v_mfma_f32_16x16x32_bf16 v[112:115], a[244:247], a[228:231], v[112:115]
  s_add_u32 s46, s40, 92160
  v_mfma_f32_16x16x32_bf16 v[132:135], a[244:247], a[232:235], v[132:135]
  buffer_load_dwordx4 a[188:191], v244, s[52:55], s46 offen sc1
  v_mfma_f32_16x16x32_bf16 v[76:79], a[248:251], a[220:223], v[76:79]
  s_add_u32 s46, s40, 147456
  v_mfma_f32_16x16x32_bf16 v[96:99], a[248:251], a[224:227], v[96:99]
  buffer_load_dwordx4 a[192:195], v244, s[52:55], s46 offen sc1
  v_mfma_f32_16x16x32_bf16 v[116:119], a[248:251], a[228:231], v[116:119]
  s_add_u32 s46, s40, 202752
  v_mfma_f32_16x16x32_bf16 v[136:139], a[248:251], a[232:235], v[136:139]
  buffer_load_dwordx4 a[196:199], v244, s[52:55], s46 offen sc1
  v_mfma_f32_16x16x32_bf16 v[80:83], a[252:255], a[220:223], v[80:83]
  v_mfma_f32_16x16x32_bf16 v[100:103], a[252:255], a[224:227], v[100:103]
  v_mfma_f32_16x16x32_bf16 v[120:123], a[252:255], a[228:231], v[120:123]
  v_mfma_f32_16x16x32_bf16 v[140:143], a[252:255], a[232:235], v[140:143]
  s_waitcnt vmcnt(53)
  v_mfma_f32_16x16x32_bf16 v[64:67], v[224:227], v[208:211], v[64:67]
  v_mfma_f32_16x16x32_bf16 v[84:87], v[224:227], v[212:215], v[84:87]
  s_add_u32 s45, s42, 1638400
  v_mfma_f32_16x16x32_bf16 v[104:107], v[224:227], v[216:219], v[104:107]
  buffer_load_dwordx4 a[236:239], v244, s[52:55], s45 offen offset:0 sc1
  v_mfma_f32_16x16x32_bf16 v[124:127], v[224:227], v[220:223], v[124:127]
  buffer_load_dwordx4 a[240:243], v244, s[52:55], s45 offen offset:1024 sc1
  v_mfma_f32_16x16x32_bf16 v[68:71], v[228:231], v[208:211], v[68:71]
  buffer_load_dwordx4 a[244:247], v244, s[52:55], s45 offen offset:2048 sc1
  v_mfma_f32_16x16x32_bf16 v[88:91], v[228:231], v[212:215], v[88:91]
  buffer_load_dwordx4 a[248:251], v244, s[52:55], s45 offen offset:3072 sc1
  v_mfma_f32_16x16x32_bf16 v[108:111], v[228:231], v[216:219], v[108:111]
  s_add_u32 s45, s45, 4096
  v_mfma_f32_16x16x32_bf16 v[128:131], v[228:231], v[220:223], v[128:131]
  buffer_load_dwordx4 a[252:255], v244, s[52:55], s45 offen sc1
  v_mfma_f32_16x16x32_bf16 v[72:75], v[232:235], v[208:211], v[72:75]
  s_add_u32 s46, s40, 40960
  v_mfma_f32_16x16x32_bf16 v[92:95], v[232:235], v[212:215], v[92:95]
  buffer_load_dwordx4 a[220:223], v244, s[52:55], s46 offen sc1
  v_mfma_f32_16x16x32_bf16 v[112:115], v[232:235], v[216:219], v[112:115]
  s_add_u32 s46, s40, 96256
  v_mfma_f32_16x16x32_bf16 v[132:135], v[232:235], v[220:223], v[132:135]
  buffer_load_dwordx4 a[224:227], v244, s[52:55], s46 offen sc1
  v_mfma_f32_16x16x32_bf16 v[76:79], v[236:239], v[208:211], v[76:79]
  s_add_u32 s46, s40, 151552
  v_mfma_f32_16x16x32_bf16 v[96:99], v[236:239], v[212:215], v[96:99]
  buffer_load_dwordx4 a[228:231], v244, s[52:55], s46 offen sc1
  v_mfma_f32_16x16x32_bf16 v[116:119], v[236:239], v[216:219], v[116:119]
  s_add_u32 s46, s40, 206848
  v_mfma_f32_16x16x32_bf16 v[136:139], v[236:239], v[220:223], v[136:139]
  buffer_load_dwordx4 a[232:235], v244, s[52:55], s46 offen sc1
  v_mfma_f32_16x16x32_bf16 v[80:83], v[240:243], v[208:211], v[80:83]
  v_mfma_f32_16x16x32_bf16 v[100:103], v[240:243], v[212:215], v[100:103]
  v_mfma_f32_16x16x32_bf16 v[120:123], v[240:243], v[216:219], v[120:123]
  v_mfma_f32_16x16x32_bf16 v[140:143], v[240:243], v[220:223], v[140:143]
  s_waitcnt vmcnt(55)
  s_waitcnt vmcnt(51)
  v_mfma_f32_16x16x32_bf16 v[64:67], a[16:19], a[0:3], v[64:67]
  v_mfma_f32_16x16x32_bf16 v[84:87], a[16:19], a[4:7], v[84:87]
  s_add_u32 s45, s42, 1802240
  v_mfma_f32_16x16x32_bf16 v[104:107], a[16:19], a[8:11], v[104:107]
  buffer_load_dwordx4 v[224:227], v244, s[52:55], s45 offen offset:0 sc1
  v_mfma_f32_16x16x32_bf16 v[124:127], a[16:19], a[12:15], v[124:127]
  buffer_load_dwordx4 v[228:231], v244, s[52:55], s45 offen offset:1024 sc1
  v_mfma_f32_16x16x32_bf16 v[68:71], a[20:23], a[0:3], v[68:71]
  buffer_load_dwordx4 v[232:235], v244, s[52:55], s45 offen offset:2048 sc1
  v_mfma_f32_16x16x32_bf16 v[88:91], a[20:23], a[4:7], v[88:91]
  buffer_load_dwordx4 v[236:239], v244, s[52:55], s45 offen offset:3072 sc1
  v_mfma_f32_16x16x32_bf16 v[108:111], a[20:23], a[8:11], v[108:111]
  s_add_u32 s45, s45, 4096
  v_mfma_f32_16x16x32_bf16 v[128:131], a[20:23], a[12:15], v[128:131]
  buffer_load_dwordx4 v[240:243], v244, s[52:55], s45 offen sc1
  v_mfma_f32_16x16x32_bf16 v[72:75], a[24:27], a[0:3], v[72:75]
  s_add_u32 s46, s40, 45056
  v_mfma_f32_16x16x32_bf16 v[92:95], a[24:27], a[4:7], v[92:95]
  buffer_load_dwordx4 v[208:211], v244, s[52:55], s46 offen sc1
  v_mfma_f32_16x16x32_bf16 v[112:115], a[24:27], a[8:11], v[112:115]
  s_add_u32 s46, s40, 100352
  v_mfma_f32_16x16x32_bf16 v[132:135], a[24:27], a[12:15], v[132:135]
  buffer_load_dwordx4 v[212:215], v244, s[52:55], s46 offen sc1
  v_mfma_f32_16x16x32_bf16 v[76:79], a[28:31], a[0:3], v[76:79]
  s_add_u32 s46, s40, 155648
  v_mfma_f32_16x16x32_bf16 v[96:99], a[28:31], a[4:7], v[96:99]
  buffer_load_dwordx4 v[216:219], v244, s[52:55], s46 offen sc1
  v_mfma_f32_16x16x32_bf16 v[116:119], a[28:31], a[8:11], v[116:119]
  s_add_u32 s46, s40, 210944
  v_mfma_f32_16x16x32_bf16 v[136:139], a[28:31], a[12:15], v[136:139]
  buffer_load_dwordx4 v[220:223], v244, s[52:55], s46 offen sc1
  v_mfma_f32_16x16x32_bf16 v[80:83], a[32:35], a[0:3], v[80:83]
  v_mfma_f32_16x16x32_bf16 v[100:103], a[32:35], a[4:7], v[100:103]
  v_mfma_f32_16x16x32_bf16 v[120:123], a[32:35], a[8:11], v[120:123]
  v_mfma_f32_16x16x32_bf16 v[140:143], a[32:35], a[12:15], v[140:143]
  s_waitcnt vmcnt(50)
  s_waitcnt vmcnt(46)
  s_mov_b32 s15, 23003136
  buffer_load_dwordx4 v[248:251], v246, s[52:55], s15 offen offset:0 sc1
  v_mfma_f32_16x16x32_bf16 v[64:67], a[52:55], a[36:39], v[64:67]
  v_mfma_f32_16x16x32_bf16 v[84:87], a[52:55], a[40:43], v[84:87]
  s_add_u32 s45, s42, 1966080
  v_mfma_f32_16x16x32_bf16 v[104:107], a[52:55], a[44:47], v[104:107]
  buffer_load_dwordx4 a[16:19], v244, s[52:55], s45 offen offset:0 sc1
  v_mfma_f32_16x16x32_bf16 v[124:127], a[52:55], a[48:51], v[124:127]
  buffer_load_dwordx4 a[20:23], v244, s[52:55], s45 offen offset:1024 sc1
  v_mfma_f32_16x16x32_bf16 v[68:71], a[56:59], a[36:39], v[68:71]
  buffer_load_dwordx4 a[24:27], v244, s[52:55], s45 offen offset:2048 sc1
  v_mfma_f32_16x16x32_bf16 v[88:91], a[56:59], a[40:43], v[88:91]
  buffer_load_dwordx4 a[28:31], v244, s[52:55], s45 offen offset:3072 sc1
  v_mfma_f32_16x16x32_bf16 v[108:111], a[56:59], a[44:47], v[108:111]
  s_add_u32 s45, s45, 4096
  v_mfma_f32_16x16x32_bf16 v[128:131], a[56:59], a[48:51], v[128:131]
  buffer_load_dwordx4 a[32:35], v244, s[52:55], s45 offen sc1
  v_mfma_f32_16x16x32_bf16 v[72:75], a[60:63], a[36:39], v[72:75]
  s_add_u32 s46, s40, 49152
  v_mfma_f32_16x16x32_bf16 v[92:95], a[60:63], a[40:43], v[92:95]
  buffer_load_dwordx4 a[0:3], v244, s[52:55], s46 offen sc1
  v_mfma_f32_16x16x32_bf16 v[112:115], a[60:63], a[44:47], v[112:115]
  s_add_u32 s46, s40, 104448
  v_mfma_f32_16x16x32_bf16 v[132:135], a[60:63], a[48:51], v[132:135]
  buffer_load_dwordx4 a[4:7], v244, s[52:55], s46 offen sc1
  v_mfma_f32_16x16x32_bf16 v[76:79], a[64:67], a[36:39], v[76:79]
  s_add_u32 s46, s40, 159744
  v_mfma_f32_16x16x32_bf16 v[96:99], a[64:67], a[40:43], v[96:99]
  buffer_load_dwordx4 a[8:11], v244, s[52:55], s46 offen sc1
  v_mfma_f32_16x16x32_bf16 v[116:119], a[64:67], a[44:47], v[116:119]
  s_add_u32 s46, s40, 215040
  v_mfma_f32_16x16x32_bf16 v[136:139], a[64:67], a[48:51], v[136:139]
  buffer_load_dwordx4 a[12:15], v244, s[52:55], s46 offen sc1
  v_mfma_f32_16x16x32_bf16 v[80:83], a[68:71], a[36:39], v[80:83]
  v_mfma_f32_16x16x32_bf16 v[100:103], a[68:71], a[40:43], v[100:103]
  v_mfma_f32_16x16x32_bf16 v[120:123], a[68:71], a[44:47], v[120:123]
  v_mfma_f32_16x16x32_bf16 v[140:143], a[68:71], a[48:51], v[140:143]
  s_waitcnt vmcnt(51)
  s_waitcnt vmcnt(47)
  v_mfma_f32_16x16x32_bf16 v[64:67], a[128:131], a[112:115], v[64:67]
  v_mfma_f32_16x16x32_bf16 v[84:87], a[128:131], a[116:119], v[84:87]
  s_cmp_lt_u32 s6, 2
  v_mfma_f32_16x16x32_bf16 v[104:107], a[128:131], a[120:123], v[104:107]
  s_cselect_b32 s45, 2129920, 0x40000000
  v_mfma_f32_16x16x32_bf16 v[124:127], a[128:131], a[124:127], v[124:127]
  s_add_u32 s45, s45, s42
  v_mfma_f32_16x16x32_bf16 v[68:71], a[132:135], a[112:115], v[68:71]
  buffer_load_dwordx4 a[52:55], v244, s[52:55], s45 offen offset:0 sc1
  v_mfma_f32_16x16x32_bf16 v[88:91], a[132:135], a[116:119], v[88:91]
  buffer_load_dwordx4 a[56:59], v244, s[52:55], s45 offen offset:1024 sc1
  v_mfma_f32_16x16x32_bf16 v[108:111], a[132:135], a[120:123], v[108:111]
  buffer_load_dwordx4 a[60:63], v244, s[52:55], s45 offen offset:2048 sc1
  v_mfma_f32_16x16x32_bf16 v[128:131], a[132:135], a[124:127], v[128:131]
  buffer_load_dwordx4 a[64:67], v244, s[52:55], s45 offen offset:3072 sc1
  v_mfma_f32_16x16x32_bf16 v[72:75], a[136:139], a[112:115], v[72:75]
  s_add_u32 s45, s45, 4096
  v_mfma_f32_16x16x32_bf16 v[92:95], a[136:139], a[116:119], v[92:95]
  buffer_load_dwordx4 a[68:71], v244, s[52:55], s45 offen sc1
  v_mfma_f32_16x16x32_bf16 v[112:115], a[136:139], a[120:123], v[112:115]
  s_cmp_lt_u32 s6, 2
  v_mfma_f32_16x16x32_bf16 v[132:135], a[136:139], a[124:127], v[132:135]
  s_cselect_b32 s46, 53248, 0x40000000
  v_mfma_f32_16x16x32_bf16 v[76:79], a[140:143], a[112:115], v[76:79]
  s_add_u32 s46, s46, s40
  v_mfma_f32_16x16x32_bf16 v[96:99], a[140:143], a[116:119], v[96:99]
  buffer_load_dwordx4 a[36:39], v244, s[52:55], s46 offen sc1
  v_mfma_f32_16x16x32_bf16 v[116:119], a[140:143], a[120:123], v[116:119]
  s_cmp_lt_u32 s6, 2
  v_mfma_f32_16x16x32_bf16 v[136:139], a[140:143], a[124:127], v[136:139]
  s_cselect_b32 s46, 108544, 0x40000000
  v_mfma_f32_16x16x32_bf16 v[80:83], a[144:147], a[112:115], v[80:83]
  s_add_u32 s46, s46, s40
  v_mfma_f32_16x16x32_bf16 v[100:103], a[144:147], a[116:119], v[100:103]
  buffer_load_dwordx4 a[40:43], v244, s[52:55], s46 offen sc1
  v_mfma_f32_16x16x32_bf16 v[120:123], a[144:147], a[120:123], v[120:123]
  s_cmp_lt_u32 s6, 2
  v_mfma_f32_16x16x32_bf16 v[140:143], a[144:147], a[124:127], v[140:143]
  s_cselect_b32 s46, 163840, 0x40000000
  s_add_u32 s46, s46, s40
  buffer_load_dwordx4 a[44:47], v244, s[52:55], s46 offen sc1
  s_cmp_lt_u32 s6, 2
  s_cselect_b32 s46, 219136, 0x40000000
  s_add_u32 s46, s46, s40
  buffer_load_dwordx4 a[48:51], v244, s[52:55], s46 offen sc1
  s_waitcnt vmcnt(51)
  s_waitcnt vmcnt(47)
  v_mfma_f32_16x16x32_bf16 v[64:67], a[164:167], a[148:151], v[64:67]
  v_mfma_f32_16x16x32_bf16 v[84:87], a[164:167], a[152:155], v[84:87]
  s_add_u32 s45, s42, 2211840
  v_mfma_f32_16x16x32_bf16 v[104:107], a[164:167], a[156:159], v[104:107]
  buffer_load_dwordx4 a[128:131], v244, s[52:55], s45 offen offset:0 sc1
  v_mfma_f32_16x16x32_bf16 v[124:127], a[164:167], a[160:163], v[124:127]
  buffer_load_dwordx4 a[132:135], v244, s[52:55], s45 offen offset:1024 sc1
  v_mfma_f32_16x16x32_bf16 v[68:71], a[168:171], a[148:151], v[68:71]
  buffer_load_dwordx4 a[136:139], v244, s[52:55], s45 offen offset:2048 sc1
  v_mfma_f32_16x16x32_bf16 v[88:91], a[168:171], a[152:155], v[88:91]
  buffer_load_dwordx4 a[140:143], v244, s[52:55], s45 offen offset:3072 sc1
  v_mfma_f32_16x16x32_bf16 v[108:111], a[168:171], a[156:159], v[108:111]
  s_add_u32 s45, s45, 4096
  v_mfma_f32_16x16x32_bf16 v[128:131], a[168:171], a[160:163], v[128:131]
  buffer_load_dwordx4 a[144:147], v244, s[52:55], s45 offen sc1
  v_mfma_f32_16x16x32_bf16 v[72:75], a[172:175], a[148:151], v[72:75]
  s_waitcnt vmcnt(23)
  v_xor_b32 v248, s101, v248
  v_xor_b32 v249, s101, v249
  v_xor_b32 v250, s101, v250
  v_xor_b32 v251, s101, v251
  v_or_b32 v248, v248, v249
  v_or_b32 v248, v248, v250
  v_or_b32 v248, v248, v251
  v_cmp_ne_u32 vcc, 0, v248
  s_cbranch_vccz pollok_20
  s_mov_b32 s14, 200000
pollspin_21:
  s_sleep 2
  s_mov_b32 s15, 23003136
  buffer_load_dwordx4 v[248:251], v246, s[52:55], s15 offen offset:0 sc1
  s_waitcnt vmcnt(0)
  v_xor_b32 v248, s101, v248
  v_xor_b32 v249, s101, v249
  v_xor_b32 v250, s101, v250
  v_xor_b32 v251, s101, v251
  v_or_b32 v248, v248, v249
  v_or_b32 v248, v248, v250
  v_or_b32 v248, v248, v251
  v_cmp_ne_u32 vcc, 0, v248
  s_cbranch_vccz pollok_20
  s_sub_u32 s14, s14, 1
  s_cmp_lg_u32 s14, 0
  s_cbranch_scc1 pollspin_21
pollok_20:
  v_mfma_f32_16x16x32_bf16 v[92:95], a[172:175], a[152:155], v[92:95]
  s_add_u32 s46, s41, 0
  v_mfma_f32_16x16x32_bf16 v[112:115], a[172:175], a[156:159], v[112:115]
  buffer_load_dwordx4 a[112:115], v244, s[52:55], s46 offen sc1
  v_mfma_f32_16x16x32_bf16 v[132:135], a[172:175], a[160:163], v[132:135]
  s_add_u32 s46, s41, 20480
  v_mfma_f32_16x16x32_bf16 v[76:79], a[176:179], a[148:151], v[76:79]
  buffer_load_dwordx4 a[116:119], v244, s[52:55], s46 offen sc1
  v_mfma_f32_16x16x32_bf16 v[96:99], a[176:179], a[152:155], v[96:99]
  s_add_u32 s46, s41, 40960
  v_mfma_f32_16x16x32_bf16 v[116:119], a[176:179], a[156:159], v[116:119]
  buffer_load_dwordx4 a[120:123], v244, s[52:55], s46 offen sc1
  v_mfma_f32_16x16x32_bf16 v[136:139], a[176:179], a[160:163], v[136:139]
  s_add_u32 s46, s41, 61440
  v_mfma_f32_16x16x32_bf16 v[80:83], a[180:183], a[148:151], v[80:83]
  buffer_load_dwordx4 a[124:127], v244, s[52:55], s46 offen sc1
  v_mfma_f32_16x16x32_bf16 v[100:103], a[180:183], a[152:155], v[100:103]
  v_mfma_f32_16x16x32_bf16 v[120:123], a[180:183], a[156:159], v[120:123]
  v_mfma_f32_16x16x32_bf16 v[140:143], a[180:183], a[160:163], v[140:143]
  v_mfma_f32_16x16x32_bf16 v[64:67], a[200:203], a[184:187], v[64:67]
  v_mfma_f32_16x16x32_bf16 v[84:87], a[200:203], a[188:191], v[84:87]
  s_add_u32 s45, s42, 2375680
  v_mfma_f32_16x16x32_bf16 v[104:107], a[200:203], a[192:195], v[104:107]
  buffer_load_dwordx4 a[164:167], v244, s[52:55], s45 offen offset:0 sc1
  v_mfma_f32_16x16x32_bf16 v[124:127], a[200:203], a[196:199], v[124:127]
  buffer_load_dwordx4 a[168:171], v244, s[52:55], s45 offen offset:1024 sc1
  v_mfma_f32_16x16x32_bf16 v[68:71], a[204:207], a[184:187], v[68:71]
  buffer_load_dwordx4 a[172:175], v244, s[52:55], s45 offen offset:2048 sc1
  v_mfma_f32_16x16x32_bf16 v[88:91], a[204:207], a[188:191], v[88:91]
  buffer_load_dwordx4 a[176:179], v244, s[52:55], s45 offen offset:3072 sc1
  v_mfma_f32_16x16x32_bf16 v[108:111], a[204:207], a[192:195], v[108:111]
  s_add_u32 s45, s45, 4096
  v_mfma_f32_16x16x32_bf16 v[128:131], a[204:207], a[196:199], v[128:131]
  buffer_load_dwordx4 a[180:183], v244, s[52:55], s45 offen sc1
  v_mfma_f32_16x16x32_bf16 v[72:75], a[208:211], a[184:187], v[72:75]
  s_add_u32 s46, s41, 4096
  v_mfma_f32_16x16x32_bf16 v[92:95], a[208:211], a[188:191], v[92:95]
  buffer_load_dwordx4 a[148:151], v244, s[52:55], s46 offen sc1
  v_mfma_f32_16x16x32_bf16 v[112:115], a[208:211], a[192:195], v[112:115]
  s_add_u32 s46, s41, 24576
  v_mfma_f32_16x16x32_bf16 v[132:135], a[208:211], a[196:199], v[132:135]
  buffer_load_dwordx4 a[152:155], v244, s[52:55], s46 offen sc1
  v_mfma_f32_16x16x32_bf16 v[76:79], a[212:215], a[184:187], v[76:79]
  s_add_u32 s46, s41, 45056
  v_mfma_f32_16x16x32_bf16 v[96:99], a[212:215], a[188:191], v[96:99]
  buffer_load_dwordx4 a[156:159], v244, s[52:55], s46 offen sc1
  v_mfma_f32_16x16x32_bf16 v[116:119], a[212:215], a[192:195], v[116:119]
  s_add_u32 s46, s41, 65536
  v_mfma_f32_16x16x32_bf16 v[136:139], a[212:215], a[196:199], v[136:139]
  buffer_load_dwordx4 a[160:163], v244, s[52:55], s46 offen sc1
  v_mfma_f32_16x16x32_bf16 v[80:83], a[216:219], a[184:187], v[80:83]
  v_mfma_f32_16x16x32_bf16 v[100:103], a[216:219], a[188:191], v[100:103]
  v_mfma_f32_16x16x32_bf16 v[120:123], a[216:219], a[192:195], v[120:123]
  v_mfma_f32_16x16x32_bf16 v[140:143], a[216:219], a[196:199], v[140:143]
  v_mfma_f32_16x16x32_bf16 v[64:67], a[236:239], a[220:223], v[64:67]
  v_mfma_f32_16x16x32_bf16 v[84:87], a[236:239], a[224:227], v[84:87]
  s_add_u32 s45, s42, 2539520
  v_mfma_f32_16x16x32_bf16 v[104:107], a[236:239], a[228:231], v[104:107]
  buffer_load_dwordx4 a[200:203], v244, s[52:55], s45 offen offset:0 sc1
  v_mfma_f32_16x16x32_bf16 v[124:127], a[236:239], a[232:235], v[124:127]
  buffer_load_dwordx4 a[204:207], v244, s[52:55], s45 offen offset:1024 sc1
  v_mfma_f32_16x16x32_bf16 v[68:71], a[240:243], a[220:223], v[68:71]
  buffer_load_dwordx4 a[208:211], v244, s[52:55], s45 offen offset:2048 sc1
  v_mfma_f32_16x16x32_bf16 v[88:91], a[240:243], a[224:227], v[88:91]
  buffer_load_dwordx4 a[212:215], v244, s[52:55], s45 offen offset:3072 sc1
  v_mfma_f32_16x16x32_bf16 v[108:111], a[240:243], a[228:231], v[108:111]
  s_add_u32 s45, s45, 4096
  v_mfma_f32_16x16x32_bf16 v[128:131], a[240:243], a[232:235], v[128:131]
  buffer_load_dwordx4 a[216:219], v244, s[52:55], s45 offen sc1
  v_mfma_f32_16x16x32_bf16 v[72:75], a[244:247], a[220:223], v[72:75]
  s_add_u32 s46, s41, 8192
  v_mfma_f32_16x16x32_bf16 v[92:95], a[244:247], a[224:227], v[92:95]
  buffer_load_dwordx4 a[184:187], v244, s[52:55], s46 offen sc1
  v_mfma_f32_16x16x32_bf16 v[112:115], a[244:247], a[228:231], v[112:115]
  s_add_u32 s46, s41, 28672
  v_mfma_f32_16x16x32_bf16 v[132:135], a[244:247], a[232:235], v[132:135]
  buffer_load_dwordx4 a[188:191], v244, s[52:55], s46 offen sc1
  v_mfma_f32_16x16x32_bf16 v[76:79], a[248:251], a[220:223], v[76:79]
  s_add_u32 s46, s41, 49152
  v_mfma_f32_16x16x32_bf16 v[96:99], a[248:251], a[224:227], v[96:99]
  buffer_load_dwordx4 a[192:195], v244, s[52:55], s46 offen sc1
  v_mfma_f32_16x16x32_bf16 v[116:119], a[248:251], a[228:231], v[116:119]
  s_add_u32 s46, s41, 69632
  v_mfma_f32_16x16x32_bf16 v[136:139], a[248:251], a[232:235], v[136:139]
  buffer_load_dwordx4 a[196:199], v244, s[52:55], s46 offen sc1
  v_mfma_f32_16x16x32_bf16 v[80:83], a[252:255], a[220:223], v[80:83]
  v_mfma_f32_16x16x32_bf16 v[100:103], a[252:255], a[224:227], v[100:103]
  v_mfma_f32_16x16x32_bf16 v[120:123], a[252:255], a[228:231], v[120:123]
  v_mfma_f32_16x16x32_bf16 v[140:143], a[252:255], a[232:235], v[140:143]
  v_mfma_f32_16x16x32_bf16 v[64:67], v[224:227], v[208:211], v[64:67]
  v_mfma_f32_16x16x32_bf16 v[84:87], v[224:227], v[212:215], v[84:87]
  s_add_u32 s45, s42, 2703360
  v_mfma_f32_16x16x32_bf16 v[104:107], v[224:227], v[216:219], v[104:107]
  buffer_load_dwordx4 a[236:239], v244, s[52:55], s45 offen offset:0 sc1
  v_mfma_f32_16x16x32_bf16 v[124:127], v[224:227], v[220:223], v[124:127]
  buffer_load_dwordx4 a[240:243], v244, s[52:55], s45 offen offset:1024 sc1
  v_mfma_f32_16x16x32_bf16 v[68:71], v[228:231], v[208:211], v[68:71]
  buffer_load_dwordx4 a[244:247], v244, s[52:55], s45 offen offset:2048 sc1
  v_mfma_f32_16x16x32_bf16 v[88:91], v[228:231], v[212:215], v[88:91]
  buffer_load_dwordx4 a[248:251], v244, s[52:55], s45 offen offset:3072 sc1
  v_mfma_f32_16x16x32_bf16 v[108:111], v[228:231], v[216:219], v[108:111]
  s_add_u32 s45, s45, 4096
  v_mfma_f32_16x16x32_bf16 v[128:131], v[228:231], v[220:223], v[128:131]
  buffer_load_dwordx4 a[252:255], v244, s[52:55], s45 offen sc1
  v_mfma_f32_16x16x32_bf16 v[72:75], v[232:235], v[208:211], v[72:75]
  s_add_u32 s46, s41, 12288
  v_mfma_f32_16x16x32_bf16 v[92:95], v[232:235], v[212:215], v[92:95]
  buffer_load_dwordx4 a[220:223], v244, s[52:55], s46 offen sc1
  v_mfma_f32_16x16x32_bf16 v[112:115], v[232:235], v[216:219], v[112:115]
  s_add_u32 s46, s41, 32768
  v_mfma_f32_16x16x32_bf16 v[132:135], v[232:235], v[220:223], v[132:135]
  buffer_load_dwordx4 a[224:227], v244, s[52:55], s46 offen sc1
  v_mfma_f32_16x16x32_bf16 v[76:79], v[236:239], v[208:211], v[76:79]
  s_add_u32 s46, s41, 53248
  v_mfma_f32_16x16x32_bf16 v[96:99], v[236:239], v[212:215], v[96:99]
  buffer_load_dwordx4 a[228:231], v244, s[52:55], s46 offen sc1
  v_mfma_f32_16x16x32_bf16 v[116:119], v[236:239], v[216:219], v[116:119]
  s_add_u32 s46, s41, 73728
  v_mfma_f32_16x16x32_bf16 v[136:139], v[236:239], v[220:223], v[136:139]
  buffer_load_dwordx4 a[232:235], v244, s[52:55], s46 offen sc1
  v_mfma_f32_16x16x32_bf16 v[80:83], v[240:243], v[208:211], v[80:83]
  v_mfma_f32_16x16x32_bf16 v[100:103], v[240:243], v[212:215], v[100:103]
  v_mfma_f32_16x16x32_bf16 v[120:123], v[240:243], v[216:219], v[120:123]
  v_mfma_f32_16x16x32_bf16 v[140:143], v[240:243], v[220:223], v[140:143]
  s_waitcnt vmcnt(49)
  s_waitcnt vmcnt(45)
  v_mfma_f32_16x16x32_bf16 v[64:67], a[16:19], a[0:3], v[64:67]
  v_mfma_f32_16x16x32_bf16 v[84:87], a[16:19], a[4:7], v[84:87]
  s_add_u32 s45, s42, 2867200
  v_mfma_f32_16x16x32_bf16 v[104:107], a[16:19], a[8:11], v[104:107]
  buffer_load_dwordx4 v[224:227], v244, s[52:55], s45 offen offset:0 sc1
  v_mfma_f32_16x16x32_bf16 v[124:127], a[16:19], a[12:15], v[124:127]
  buffer_load_dwordx4 v[228:231], v244, s[52:55], s45 offen offset:1024 sc1
  v_mfma_f32_16x16x32_bf16 v[68:71], a[20:23], a[0:3], v[68:71]
  buffer_load_dwordx4 v[232:235], v244, s[52:55], s45 offen offset:2048 sc1
  v_mfma_f32_16x16x32_bf16 v[88:91], a[20:23], a[4:7], v[88:91]
  buffer_load_dwordx4 v[236:239], v244, s[52:55], s45 offen offset:3072 sc1
  v_mfma_f32_16x16x32_bf16 v[108:111], a[20:23], a[8:11], v[108:111]
  s_add_u32 s45, s45, 4096
  v_mfma_f32_16x16x32_bf16 v[128:131], a[20:23], a[12:15], v[128:131]
  buffer_load_dwordx4 v[240:243], v244, s[52:55], s45 offen sc1
  v_mfma_f32_16x16x32_bf16 v[72:75], a[24:27], a[0:3], v[72:75]
  s_add_u32 s46, s41, 16384
  v_mfma_f32_16x16x32_bf16 v[92:95], a[24:27], a[4:7], v[92:95]
  buffer_load_dwordx4 v[208:211], v244, s[52:55], s46 offen sc1
  v_mfma_f32_16x16x32_bf16 v[112:115], a[24:27], a[8:11], v[112:115]
  s_add_u32 s46, s41, 36864
  v_mfma_f32_16x16x32_bf16 v[132:135], a[24:27], a[12:15], v[132:135]
  buffer_load_dwordx4 v[212:215], v244, s[52:55], s46 offen sc1
  v_mfma_f32_16x16x32_bf16 v[76:79], a[28:31], a[0:3], v[76:79]
  s_add_u32 s46, s41, 57344
  v_mfma_f32_16x16x32_bf16 v[96:99], a[28:31], a[4:7], v[96:99]
  buffer_load_dwordx4 v[216:219], v244, s[52:55], s46 offen sc1
  v_mfma_f32_16x16x32_bf16 v[116:119], a[28:31], a[8:11], v[116:119]
  s_add_u32 s46, s41, 77824
  v_mfma_f32_16x16x32_bf16 v[136:139], a[28:31], a[12:15], v[136:139]
  buffer_load_dwordx4 v[220:223], v244, s[52:55], s46 offen sc1
  v_mfma_f32_16x16x32_bf16 v[80:83], a[32:35], a[0:3], v[80:83]
  v_mfma_f32_16x16x32_bf16 v[100:103], a[32:35], a[4:7], v[100:103]
  v_mfma_f32_16x16x32_bf16 v[120:123], a[32:35], a[8:11], v[120:123]
  v_mfma_f32_16x16x32_bf16 v[140:143], a[32:35], a[12:15], v[140:143]
  s_waitcnt vmcnt(49)
  s_waitcnt vmcnt(45)
  v_mfma_f32_16x16x32_bf16 v[64:67], a[52:55], a[36:39], v[64:67]
  v_mfma_f32_16x16x32_bf16 v[84:87], a[52:55], a[40:43], v[84:87]
  v_mfma_f32_16x16x32_bf16 v[104:107], a[52:55], a[44:47], v[104:107]
  v_mfma_f32_16x16x32_bf16 v[124:127], a[52:55], a[48:51], v[124:127]
  v_mfma_f32_16x16x32_bf16 v[68:71], a[56:59], a[36:39], v[68:71]
  v_mfma_f32_16x16x32_bf16 v[88:91], a[56:59], a[40:43], v[88:91]
  v_mfma_f32_16x16x32_bf16 v[108:111], a[56:59], a[44:47], v[108:111]
  v_mfma_f32_16x16x32_bf16 v[128:131], a[56:59], a[48:51], v[128:131]
  v_mfma_f32_16x16x32_bf16 v[72:75], a[60:63], a[36:39], v[72:75]
  v_mfma_f32_16x16x32_bf16 v[92:95], a[60:63], a[40:43], v[92:95]
  v_mfma_f32_16x16x32_bf16 v[112:115], a[60:63], a[44:47], v[112:115]
  v_mfma_f32_16x16x32_bf16 v[132:135], a[60:63], a[48:51], v[132:135]
  v_mfma_f32_16x16x32_bf16 v[76:79], a[64:67], a[36:39], v[76:79]
  v_mfma_f32_16x16x32_bf16 v[96:99], a[64:67], a[40:43], v[96:99]
  v_mfma_f32_16x16x32_bf16 v[116:119], a[64:67], a[44:47], v[116:119]
  v_mfma_f32_16x16x32_bf16 v[136:139], a[64:67], a[48:51], v[136:139]
  v_mfma_f32_16x16x32_bf16 v[80:83], a[68:71], a[36:39], v[80:83]
  v_mfma_f32_16x16x32_bf16 v[100:103], a[68:71], a[40:43], v[100:103]
  v_mfma_f32_16x16x32_bf16 v[120:123], a[68:71], a[44:47], v[120:123]
  v_mfma_f32_16x16x32_bf16 v[140:143], a[68:71], a[48:51], v[140:143]
  s_waitcnt vmcnt(40)
  s_waitcnt vmcnt(36)
  v_mfma_f32_16x16x32_bf16 v[64:67], a[128:131], a[112:115], v[64:67]
  v_mfma_f32_16x16x32_bf16 v[84:87], a[128:131], a[116:119], v[84:87]
  v_mfma_f32_16x16x32_bf16 v[104:107], a[128:131], a[120:123], v[104:107]
  v_mfma_f32_16x16x32_bf16 v[124:127], a[128:131], a[124:127], v[124:127]
  v_mfma_f32_16x16x32_bf16 v[68:71], a[132:135], a[112:115], v[68:71]
  v_mfma_f32_16x16x32_bf16 v[88:91], a[132:135], a[116:119], v[88:91]
  v_mfma_f32_16x16x32_bf16 v[108:111], a[132:135], a[120:123], v[108:111]
  v_mfma_f32_16x16x32_bf16 v[128:131], a[132:135], a[124:127], v[128:131]
  v_mfma_f32_16x16x32_bf16 v[72:75], a[136:139], a[112:115], v[72:75]
  v_mfma_f32_16x16x32_bf16 v[92:95], a[136:139], a[116:119], v[92:95]
  v_mfma_f32_16x16x32_bf16 v[112:115], a[136:139], a[120:123], v[112:115]
  v_mfma_f32_16x16x32_bf16 v[132:135], a[136:139], a[124:127], v[132:135]
  v_mfma_f32_16x16x32_bf16 v[76:79], a[140:143], a[112:115], v[76:79]
  v_mfma_f32_16x16x32_bf16 v[96:99], a[140:143], a[116:119], v[96:99]
  v_mfma_f32_16x16x32_bf16 v[116:119], a[140:143], a[120:123], v[116:119]
  v_mfma_f32_16x16x32_bf16 v[136:139], a[140:143], a[124:127], v[136:139]
  v_mfma_f32_16x16x32_bf16 v[80:83], a[144:147], a[112:115], v[80:83]
  v_mfma_f32_16x16x32_bf16 v[100:103], a[144:147], a[116:119], v[100:103]
  v_mfma_f32_16x16x32_bf16 v[120:123], a[144:147], a[120:123], v[120:123]
  v_mfma_f32_16x16x32_bf16 v[140:143], a[144:147], a[124:127], v[140:143]
  s_waitcnt vmcnt(31)
  s_waitcnt vmcnt(27)
  v_mfma_f32_16x16x32_bf16 v[64:67], a[164:167], a[148:151], v[64:67]
  v_mfma_f32_16x16x32_bf16 v[84:87], a[164:167], a[152:155], v[84:87]
  v_mfma_f32_16x16x32_bf16 v[104:107], a[164:167], a[156:159], v[104:107]
  v_mfma_f32_16x16x32_bf16 v[124:127], a[164:167], a[160:163], v[124:127]
  v_mfma_f32_16x16x32_bf16 v[68:71], a[168:171], a[148:151], v[68:71]
  v_mfma_f32_16x16x32_bf16 v[88:91], a[168:171], a[152:155], v[88:91]
  v_mfma_f32_16x16x32_bf16 v[108:111], a[168:171], a[156:159], v[108:111]
  v_mfma_f32_16x16x32_bf16 v[128:131], a[168:171], a[160:163], v[128:131]
  v_mfma_f32_16x16x32_bf16 v[72:75], a[172:175], a[148:151], v[72:75]
  v_mfma_f32_16x16x32_bf16 v[92:95], a[172:175], a[152:155], v[92:95]
  v_mfma_f32_16x16x32_bf16 v[112:115], a[172:175], a[156:159], v[112:115]
  v_mfma_f32_16x16x32_bf16 v[132:135], a[172:175], a[160:163], v[132:135]
  v_mfma_f32_16x16x32_bf16 v[76:79], a[176:179], a[148:151], v[76:79]
  v_mfma_f32_16x16x32_bf16 v[96:99], a[176:179], a[152:155], v[96:99]
  v_mfma_f32_16x16x32_bf16 v[116:119], a[176:179], a[156:159], v[116:119]
  v_mfma_f32_16x16x32_bf16 v[136:139], a[176:179], a[160:163], v[136:139]
  v_mfma_f32_16x16x32_bf16 v[80:83], a[180:183], a[148:151], v[80:83]
  v_mfma_f32_16x16x32_bf16 v[100:103], a[180:183], a[152:155], v[100:103]
  v_mfma_f32_16x16x32_bf16 v[120:123], a[180:183], a[156:159], v[120:123]
  v_mfma_f32_16x16x32_bf16 v[140:143], a[180:183], a[160:163], v[140:143]
  s_waitcnt vmcnt(22)
  s_waitcnt vmcnt(18)
  v_mfma_f32_16x16x32_bf16 v[64:67], a[200:203], a[184:187], v[64:67]
  v_mfma_f32_16x16x32_bf16 v[84:87], a[200:203], a[188:191], v[84:87]
  v_mfma_f32_16x16x32_bf16 v[104:107], a[200:203], a[192:195], v[104:107]
  v_mfma_f32_16x16x32_bf16 v[124:127], a[200:203], a[196:199], v[124:127]
  v_mfma_f32_16x16x32_bf16 v[68:71], a[204:207], a[184:187], v[68:71]
  v_mfma_f32_16x16x32_bf16 v[88:91], a[204:207], a[188:191], v[88:91]
  v_mfma_f32_16x16x32_bf16 v[108:111], a[204:207], a[192:195], v[108:111]
  v_mfma_f32_16x16x32_bf16 v[128:131], a[204:207], a[196:199], v[128:131]
  v_mfma_f32_16x16x32_bf16 v[72:75], a[208:211], a[184:187], v[72:75]
  v_mfma_f32_16x16x32_bf16 v[92:95], a[208:211], a[188:191], v[92:95]
  v_mfma_f32_16x16x32_bf16 v[112:115], a[208:211], a[192:195], v[112:115]
  v_mfma_f32_16x16x32_bf16 v[132:135], a[208:211], a[196:199], v[132:135]
  v_mfma_f32_16x16x32_bf16 v[76:79], a[212:215], a[184:187], v[76:79]
  v_mfma_f32_16x16x32_bf16 v[96:99], a[212:215], a[188:191], v[96:99]
  v_mfma_f32_16x16x32_bf16 v[116:119], a[212:215], a[192:195], v[116:119]
  v_mfma_f32_16x16x32_bf16 v[136:139], a[212:215], a[196:199], v[136:139]
  v_mfma_f32_16x16x32_bf16 v[80:83], a[216:219], a[184:187], v[80:83]
  v_mfma_f32_16x16x32_bf16 v[100:103], a[216:219], a[188:191], v[100:103]
  v_mfma_f32_16x16x32_bf16 v[120:123], a[216:219], a[192:195], v[120:123]
  v_mfma_f32_16x16x32_bf16 v[140:143], a[216:219], a[196:199], v[140:143]
  s_waitcnt vmcnt(13)
  s_waitcnt vmcnt(9)
  v_mfma_f32_16x16x32_bf16 v[64:67], a[236:239], a[220:223], v[64:67]
  v_mfma_f32_16x16x32_bf16 v[84:87], a[236:239], a[224:227], v[84:87]
  v_mfma_f32_16x16x32_bf16 v[104:107], a[236:239], a[228:231], v[104:107]
  v_mfma_f32_16x16x32_bf16 v[124:127], a[236:239], a[232:235], v[124:127]
  v_mfma_f32_16x16x32_bf16 v[68:71], a[240:243], a[220:223], v[68:71]
  v_mfma_f32_16x16x32_bf16 v[88:91], a[240:243], a[224:227], v[88:91]
  v_mfma_f32_16x16x32_bf16 v[108:111], a[240:243], a[228:231], v[108:111]
  v_mfma_f32_16x16x32_bf16 v[128:131], a[240:243], a[232:235], v[128:131]
  v_mfma_f32_16x16x32_bf16 v[72:75], a[244:247], a[220:223], v[72:75]
  v_mfma_f32_16x16x32_bf16 v[92:95], a[244:247], a[224:227], v[92:95]
  v_mfma_f32_16x16x32_bf16 v[112:115], a[244:247], a[228:231], v[112:115]
  v_mfma_f32_16x16x32_bf16 v[132:135], a[244:247], a[232:235], v[132:135]
  v_mfma_f32_16x16x32_bf16 v[76:79], a[248:251], a[220:223], v[76:79]
  v_mfma_f32_16x16x32_bf16 v[96:99], a[248:251], a[224:227], v[96:99]
  v_mfma_f32_16x16x32_bf16 v[116:119], a[248:251], a[228:231], v[116:119]
  v_mfma_f32_16x16x32_bf16 v[136:139], a[248:251], a[232:235], v[136:139]
  v_mfma_f32_16x16x32_bf16 v[80:83], a[252:255], a[220:223], v[80:83]
  v_mfma_f32_16x16x32_bf16 v[100:103], a[252:255], a[224:227], v[100:103]
  v_mfma_f32_16x16x32_bf16 v[120:123], a[252:255], a[228:231], v[120:123]
  v_mfma_f32_16x16x32_bf16 v[140:143], a[252:255], a[232:235], v[140:143]
  s_waitcnt vmcnt(4)
  s_waitcnt vmcnt(0)
  v_mfma_f32_16x16x32_bf16 v[64:67], v[224:227], v[208:211], v[64:67]
  v_mfma_f32_16x16x32_bf16 v[84:87], v[224:227], v[212:215], v[84:87]
  v_mfma_f32_16x16x32_bf16 v[104:107], v[224:227], v[216:219], v[104:107]
  v_mfma_f32_16x16x32_bf16 v[124:127], v[224:227], v[220:223], v[124:127]
  v_mfma_f32_16x16x32_bf16 v[68:71], v[228:231], v[208:211], v[68:71]
  v_mfma_f32_16x16x32_bf16 v[88:91], v[228:231], v[212:215], v[88:91]
  v_mfma_f32_16x16x32_bf16 v[108:111], v[228:231], v[216:219], v[108:111]
  v_mfma_f32_16x16x32_bf16 v[128:131], v[228:231], v[220:223], v[128:131]
  v_mfma_f32_16x16x32_bf16 v[72:75], v[232:235], v[208:211], v[72:75]
  v_mfma_f32_16x16x32_bf16 v[92:95], v[232:235], v[212:215], v[92:95]
  v_mfma_f32_16x16x32_bf16 v[112:115], v[232:235], v[216:219], v[112:115]
  v_mfma_f32_16x16x32_bf16 v[132:135], v[232:235], v[220:223], v[132:135]
  v_mfma_f32_16x16x32_bf16 v[76:79], v[236:239], v[208:211], v[76:79]
  v_mfma_f32_16x16x32_bf16 v[96:99], v[236:239], v[212:215], v[96:99]
  v_mfma_f32_16x16x32_bf16 v[116:119], v[236:239], v[216:219], v[116:119]
  v_mfma_f32_16x16x32_bf16 v[136:139], v[236:239], v[220:223], v[136:139]
  v_mfma_f32_16x16x32_bf16 v[80:83], v[240:243], v[208:211], v[80:83]
  v_mfma_f32_16x16x32_bf16 v[100:103], v[240:243], v[212:215], v[100:103]
  v_mfma_f32_16x16x32_bf16 v[120:123], v[240:243], v[216:219], v[120:123]
  v_mfma_f32_16x16x32_bf16 v[140:143], v[240:243], v[220:223], v[140:143]
  s_nop 7
  s_mul_i32 s12, s6, 20480
  v_add_u32 v25, s12, v244
  ds_write_b128 v25, v[64:67] offset:0
  ds_write_b128 v25, v[68:71] offset:1024
  ds_write_b128 v25, v[72:75] offset:2048
  ds_write_b128 v25, v[76:79] offset:3072
  ds_write_b128 v25, v[80:83] offset:4096
  ds_write_b128 v25, v[84:87] offset:5120
  ds_write_b128 v25, v[88:91] offset:6144
  ds_write_b128 v25, v[92:95] offset:7168
  ds_write_b128 v25, v[96:99] offset:8192
  ds_write_b128 v25, v[100:103] offset:9216
  ds_write_b128 v25, v[104:107] offset:10240
  ds_write_b128 v25, v[108:111] offset:11264
  ds_write_b128 v25, v[112:115] offset:12288
  ds_write_b128 v25, v[116:119] offset:13312
  ds_write_b128 v25, v[120:123] offset:14336
  ds_write_b128 v25, v[124:127] offset:15360
  ds_write_b128 v25, v[128:131] offset:16384
  ds_write_b128 v25, v[132:135] offset:17408
  ds_write_b128 v25, v[136:139] offset:18432
  ds_write_b128 v25, v[140:143] offset:19456
  s_waitcnt lgkmcnt(0)
  s_barrier
  s_mul_i32 s12, s6, 5120
  v_add_u32 v25, s12, v244
  v_add_u32 v26, 40960, v25
  ds_read_b128 v[64:67], v25 offset:0
  ds_read_b128 v[68:71], v25 offset:1024
  ds_read_b128 v[72:75], v25 offset:2048
  ds_read_b128 v[76:79], v25 offset:3072
  ds_read_b128 v[80:83], v25 offset:4096
  ds_read_b128 v[84:87], v25 offset:20480
  ds_read_b128 v[88:91], v25 offset:21504
  ds_read_b128 v[92:95], v25 offset:22528
  ds_read_b128 v[96:99], v25 offset:23552
  ds_read_b128 v[100:103], v25 offset:24576
  ds_read_b128 v[104:107], v26 offset:0
  ds_read_b128 v[108:111], v26 offset:1024
  ds_read_b128 v[112:115], v26 offset:2048
  ds_read_b128 v[116:119], v26 offset:3072
  ds_read_b128 v[120:123], v26 offset:4096
  ds_read_b128 v[124:127], v26 offset:20480
  ds_read_b128 v[128:131], v26 offset:21504
  ds_read_b128 v[132:135], v26 offset:22528
  ds_read_b128 v[136:139], v26 offset:23552
  ds_read_b128 v[140:143], v26 offset:24576
  s_waitcnt lgkmcnt(0)
  v_add_f32 v64, v64, v84
  v_add_f32 v104, v104, v124
  v_add_f32 v65, v65, v85
  v_add_f32 v105, v105, v125
  v_add_f32 v66, v66, v86
  v_add_f32 v106, v106, v126
  v_add_f32 v67, v67, v87
  v_add_f32 v107, v107, v127
  v_add_f32 v64, v64, v104
  v_add_f32 v65, v65, v105
  v_add_f32 v66, v66, v106
  v_add_f32 v67, v67, v107
  v_lshlrev_b32 v28, 16, v184
  v_and_b32 v29, 0xffff0000, v184
  v_lshlrev_b32 v30, 16, v185
  v_and_b32 v31, 0xffff0000, v185
  v_add_f32 v64, v64, v28
  v_add_f32 v65, v65, v29
  v_add_f32 v66, v66, v30
  v_add_f32 v67, v67, v31
  v_cvt_pk_bf16_f32 v184, v64, v65
  v_cvt_pk_bf16_f32 v185, v66, v67
  buffer_store_dwordx2 v[184:185], v24, s[64:67], s43 offen offset:0
  v_add_f32 v68, v68, v88
  v_add_f32 v108, v108, v128
  v_add_f32 v69, v69, v89
  v_add_f32 v109, v109, v129
  v_add_f32 v70, v70, v90
  v_add_f32 v110, v110, v130
  v_add_f32 v71, v71, v91
  v_add_f32 v111, v111, v131
  v_add_f32 v68, v68, v108
  v_add_f32 v69, v69, v109
  v_add_f32 v70, v70, v110
  v_add_f32 v71, v71, v111
  v_lshlrev_b32 v28, 16, v186
  v_and_b32 v29, 0xffff0000, v186
  v_lshlrev_b32 v30, 16, v187
  v_and_b32 v31, 0xffff0000, v187
  v_add_f32 v68, v68, v28
  v_add_f32 v69, v69, v29
  v_add_f32 v70, v70, v30
  v_add_f32 v71, v71, v31
  v_cvt_pk_bf16_f32 v186, v68, v69
  v_cvt_pk_bf16_f32 v187, v70, v71
  buffer_store_dwordx2 v[186:187], v24, s[64:67], s43 offen offset:32
  v_add_f32 v72, v72, v92
  v_add_f32 v112, v112, v132
  v_add_f32 v73, v73, v93
  v_add_f32 v113, v113, v133
  v_add_f32 v74, v74, v94
  v_add_f32 v114, v114, v134
  v_add_f32 v75, v75, v95
  v_add_f32 v115, v115, v135
  v_add_f32 v72, v72, v112
  v_add_f32 v73, v73, v113
  v_add_f32 v74, v74, v114
  v_add_f32 v75, v75, v115
  v_lshlrev_b32 v28, 16, v188
  v_and_b32 v29, 0xffff0000, v188
  v_lshlrev_b32 v30, 16, v189
  v_and_b32 v31, 0xffff0000, v189
  v_add_f32 v72, v72, v28
  v_add_f32 v73, v73, v29
  v_add_f32 v74, v74, v30
  v_add_f32 v75, v75, v31
  v_cvt_pk_bf16_f32 v188, v72, v73
  v_cvt_pk_bf16_f32 v189, v74, v75
  buffer_store_dwordx2 v[188:189], v24, s[64:67], s43 offen offset:64
  v_add_f32 v76, v76, v96
  v_add_f32 v116, v116, v136
  v_add_f32 v77, v77, v97
  v_add_f32 v117, v117, v137
  v_add_f32 v78, v78, v98
  v_add_f32 v118, v118, v138
  v_add_f32 v79, v79, v99
  v_add_f32 v119, v119, v139
  v_add_f32 v76, v76, v116
  v_add_f32 v77, v77, v117
  v_add_f32 v78, v78, v118
  v_add_f32 v79, v79, v119
  v_lshlrev_b32 v28, 16, v190
  v_and_b32 v29, 0xffff0000, v190
  v_lshlrev_b32 v30, 16, v191
  v_and_b32 v31, 0xffff0000, v191
  v_add_f32 v76, v76, v28
  v_add_f32 v77, v77, v29
  v_add_f32 v78, v78, v30
  v_add_f32 v79, v79, v31
  v_cvt_pk_bf16_f32 v190, v76, v77
  v_cvt_pk_bf16_f32 v191, v78, v79
  buffer_store_dwordx2 v[190:191], v24, s[64:67], s43 offen offset:96
  v_add_f32 v80, v80, v100
  v_add_f32 v120, v120, v140
  v_add_f32 v81, v81, v101
  v_add_f32 v121, v121, v141
  v_add_f32 v82, v82, v102
  v_add_f32 v122, v122, v142
  v_add_f32 v83, v83, v103
  v_add_f32 v123, v123, v143
  v_add_f32 v80, v80, v120
  v_add_f32 v81, v81, v121
  v_add_f32 v82, v82, v122
  v_add_f32 v83, v83, v123
  v_lshlrev_b32 v28, 16, v192
  v_and_b32 v29, 0xffff0000, v192
  v_lshlrev_b32 v30, 16, v193
  v_and_b32 v31, 0xffff0000, v193
  v_add_f32 v80, v80, v28
  v_add_f32 v81, v81, v29
  v_add_f32 v82, v82, v30
  v_add_f32 v83, v83, v31
  v_cvt_pk_bf16_f32 v192, v80, v81
  v_cvt_pk_bf16_f32 v193, v82, v83
  buffer_store_dwordx2 v[192:193], v24, s[64:67], s43 offen offset:128
  s_waitcnt vmcnt(0) lgkmcnt(0)
parallel_sum__sliding_block__glu_gated_bilinear__prompt_kernel_end:
  s_endpgm
L_codeend:
.section .rodata,"a"
.p2align 6
.amdhsa_kernel parallel_sum__sliding_block__glu_gated_bilinear__prompt_kernel
  .amdhsa_next_free_vgpr 512
  .amdhsa_next_free_sgpr 102
  .amdhsa_accum_offset 256
  .amdhsa_group_segment_fixed_size 0
  .amdhsa_kernarg_size 80
  .amdhsa_user_sgpr_count 2
  .amdhsa_user_sgpr_kernarg_segment_ptr 1
  .amdhsa_system_sgpr_workgroup_id_x 1
.end_amdhsa_kernel
```
